```python
import torch

def _softmax(x, axis=-1):
    return torch.softmax(x, dim=axis)

def _gelu(x):
    return torch.nn.functional.gelu(x, approximate='tanh')

def _silu(x):
    return torch.nn.functional.silu(x)

def _sigmoid(x):
    return torch.sigmoid(x)

def _layernorm(x, axis=-1, eps=1e-05):
    m = x.mean(dim=axis, keepdim=True)
    v = x.var(dim=axis, keepdim=True, unbiased=False)
    return (x - m) / torch.sqrt(v + eps)

def _scatter_add(tgt, idx, src, axis=0):
    return tgt.clone().index_add_(axis, idx, src)

def _segment_sum(src, seg, n):
    out = torch.zeros((n,) + src.shape[1:], dtype=src.dtype)
    return out.index_add_(0, seg, src)

def _pad(x, pw):
    flat = tuple((v for pair in reversed(pw) for v in pair))
    return torch.nn.functional.pad(x, flat)
kernel_name = 'sequential_preLN__memory_aug_recurrent_mem_tr__mixer_s_mlp__prompt'

def setup_inputs():

    _w = lambda a: (lambda t: t.to(torch.bfloat16) if t.is_floating_point() else t)(torch.as_tensor(a))

    def _A_setup():
        B, S, Dm = (1, 2048, 512)
        H, Dh = (32, 128)
        M, seg = (8, 32)
        seg = min(seg, S)
        S = S // seg * seg
        return {'x': _w((lambda *s: torch.randn(*s, dtype=torch.bfloat16) * 0.05)(B, S, Dm)), 'mem0': _w((lambda *s: torch.randn(*s, dtype=torch.bfloat16) * 0.2)(B, M, Dm)), 'Wq': _w((lambda *s: torch.randn(*s, dtype=torch.bfloat16) * 1.6)(Dm, H, Dh) * Dm ** (-0.5)), 'Wk': _w((lambda *s: torch.randn(*s, dtype=torch.bfloat16) * 1.6)(Dm, H, Dh) * Dm ** (-0.5)), 'Wv': _w((lambda *s: torch.randn(*s, dtype=torch.bfloat16) * 0.2)(Dm, H, Dh) * Dm ** (-0.5)), 'Wo': _w((lambda *s: torch.randn(*s, dtype=torch.bfloat16) * 0.2)(H, Dh, Dm) * (H * Dh) ** (-0.5)), 'seg_len': seg}
    _A_in = _A_setup()

    def _B_setup():
        B, S, D, F = (1, 2048, 512, 1792)
        return {'x': _w((lambda *s: torch.randn(*s, dtype=torch.bfloat16) * 0.05)(B, S, D)), 'w1': _w((lambda *s: torch.randn(*s, dtype=torch.bfloat16) * 0.8)(D, D) * D ** (-0.5)), 'w2': _w((lambda *s: torch.randn(*s, dtype=torch.bfloat16) * 0.8)(D, D) * D ** (-0.5)), 'w3': _w((lambda *s: torch.randn(*s, dtype=torch.bfloat16) * 0.8)(D, F) * D ** (-0.5)), 'w4': _w((lambda *s: torch.randn(*s, dtype=torch.bfloat16) * 0.8)(F, D) * F ** (-0.5))}
    _B_in = _B_setup()
    return {'A_x': _A_in['x'], 'A_mem0': _A_in['mem0'], 'A_Wq': _A_in['Wq'], 'A_Wk': _A_in['Wk'], 'A_Wv': _A_in['Wv'], 'A_Wo': _A_in['Wo'], 'A_seg_len': _A_in['seg_len'], 'B_x': _B_in['x'], 'B_w1': _B_in['w1'], 'B_w2': _B_in['w2'], 'B_w3': _B_in['w3'], 'B_w4': _B_in['w4']}

def reference(A_x, A_mem0, A_Wq, A_Wk, A_Wv, A_Wo, A_seg_len, B_x, B_w1, B_w2, B_w3, B_w4):

    def _A_ref(x, mem0, Wq, Wk, Wv, Wo, seg_len):
        B, S, Dm = x.shape
        H, Dh = (Wq.shape[1], Wq.shape[2])
        M = mem0.shape[1]
        scale = Dh ** (-0.5)
        n_seg = S // seg_len
        L = M + seg_len
        idx = torch.arange(L)
        mask = (idx[:, None] < M) | (idx[:, None] >= idx[None, :])
        mem = mem0
        outs = []
        for s in range(n_seg):
            xs = x[:, s * seg_len:(s + 1) * seg_len, :].clone()
            h = torch.concatenate([mem, xs], axis=1)
            q = torch.einsum('btd,dhe->bhte', h, Wq)
            k = torch.einsum('btd,dhe->bhte', h, Wk)
            v = torch.einsum('btd,dhe->bhte', h, Wv)
            scores = torch.einsum('bhqe,bhke->bhqk', q, k) * scale
            scores = torch.where(mask[None, None], scores, -1000000000.0)
            p = _softmax(scores, axis=-1)
            o = torch.einsum('bhqk,bhke->bhqe', p, v)
            o = torch.einsum('bhte,hed->btd', o, Wo)
            mem = o[:, :M, :].clone()
            outs.append(o[:, M:, :])
        return torch.concatenate(outs, axis=1)

    def _B_ref(x, w1, w2, w3, w4):
        B, S, D = x.shape
        h = _gelu(_layernorm(x, axis=-1) @ w1)
        c = D // 4
        g0 = _pad(h[:, :, 0 * c:1 * c], ((0, 0), (1, 0), (0, 0)))[:, :S, :]
        g1 = _pad(h[:, :, 1 * c:2 * c], ((0, 0), (0, 1), (0, 0)))[:, 1:, :]
        g2 = _pad(h[:, :, 2 * c:3 * c], ((0, 0), (2, 0), (0, 0)))[:, :S, :]
        g3 = _pad(h[:, :, 3 * c:], ((0, 0), (0, 2), (0, 0)))[:, 2:, :]
        hs = torch.concatenate([g0, g1, g2, g3], axis=-1) @ w2
        x1 = x + hs
        h2 = _gelu(_layernorm(x1, axis=-1) @ w3) @ w4
        return x1 + h2
    x = A_x
    h = x + _A_ref(_layernorm(x, axis=-1), A_mem0, A_Wq, A_Wk, A_Wv, A_Wo, A_seg_len)
    h2 = h + _B_ref(_layernorm(h, axis=-1), B_w1, B_w2, B_w3, B_w4)
    return h2
```

```asm
; @launch kernel=mega_kernel grid=(256,1,1) block=(256,1,1) lds=163840
.amdgcn_target "amdgcn-amd-amdhsa--gfx950"
.text
.globl mega_kernel
.p2align 8
.type mega_kernel,@function
mega_kernel:
  s_cmp_ge_u32 s2, 256
  s_cbranch_scc1 mega_kernel_end
  s_load_dwordx4 s[4:7], s[0:1], 16
  s_load_dwordx4 s[8:11], s[0:1], 32
  s_load_dwordx2 s[12:13], s[0:1], 112
  s_load_dwordx2 s[50:51], s[0:1], 104
  s_load_dwordx2 s[56:57], s[0:1], 8
  s_getreg_b32 s16, hwreg(HW_REG_XCC_ID, 0, 4)
  v_lshrrev_b32 v20, 6, v0
  v_and_b32 v0, 63, v0
  s_nop 0
  v_readfirstlane_b32 s18, v20
  s_waitcnt lgkmcnt(0)
  s_mov_b64 s[58:59], s[50:51]

  s_cmp_eq_u32 s18, 0
  s_cbranch_scc0 mega_kernel_tf1
  s_and_b32 s52, s16, 3
  s_lshl_b32 s52, s52, 6
  s_lshr_b32 s53, s16, 2
  s_lshl_b32 s53, s53, 2
  s_add_u32 s52, s52, s53
  v_mov_b32 v20, s52
  v_mov_b32 v21, 1
  v_cmp_eq_u32 vcc, 0, v0
  s_and_saveexec_b64 s[62:63], vcc
  global_atomic_add v22, v20, v21, s[58:59] sc0
  s_mov_b64 exec, s[62:63]
mega_kernel_tf1:

  s_cmp_eq_u32 s18, 0
  s_cbranch_scc0 mega_kernel_tf_wait
  s_waitcnt vmcnt(0)
  v_readfirstlane_b32 s53, v22
  s_nop 3
  s_mov_b32 s55, s53
  s_lshl_b32 s52, s16, 8
  s_add_u32 s52, s52, s53
  s_cmp_lt_u32 s52, 32
  s_cbranch_scc1 mega_kernel_tf_bc
mega_kernel_tf_full:
  v_and_b32 v20, 3, v0
  v_lshlrev_b32 v20, 6, v20
  v_bfe_u32 v21, v0, 2, 1
  v_lshl_add_u32 v20, v21, 2, v20
  s_mov_b32 s60, 0
mega_kernel_tf_spin:
  global_load_dword v22, v20, s[58:59] sc1
  s_add_u32 s60, s60, 1
  s_cmp_gt_u32 s60, 50000000
  s_cbranch_scc1 mega_kernel_fail
  s_waitcnt vmcnt(0)

  v_readlane_b32 s40, v22, 0
  v_readlane_b32 s41, v22, 1
  v_readlane_b32 s42, v22, 2
  v_readlane_b32 s43, v22, 3
  v_readlane_b32 s44, v22, 4
  v_readlane_b32 s45, v22, 5
  v_readlane_b32 s46, v22, 6
  v_readlane_b32 s47, v22, 7
  s_nop 3
  s_mov_b32 s54, 0
  s_add_u32 s54, s54, s40
  s_add_u32 s54, s54, s41
  s_add_u32 s54, s54, s42
  s_add_u32 s54, s54, s43
  s_add_u32 s54, s54, s44
  s_add_u32 s54, s54, s45
  s_add_u32 s54, s54, s46
  s_add_u32 s54, s54, s47
  s_cmp_ge_u32 s54, 256
  s_cbranch_scc1 mega_kernel_tf_got
  s_sleep 2
  s_branch mega_kernel_tf_spin
mega_kernel_tf_got:
  s_mov_b32 s54, 8

  s_cmp_ge_u32 s47, 32
  s_cselect_b32 s54, 7, s54
  s_cmp_ge_u32 s46, 32
  s_cselect_b32 s54, 6, s54
  s_cmp_ge_u32 s45, 32
  s_cselect_b32 s54, 5, s54
  s_cmp_ge_u32 s44, 32
  s_cselect_b32 s54, 4, s54
  s_cmp_ge_u32 s43, 32
  s_cselect_b32 s54, 3, s54
  s_cmp_ge_u32 s42, 32
  s_cselect_b32 s54, 2, s54
  s_cmp_ge_u32 s41, 32
  s_cselect_b32 s54, 1, s54
  s_cmp_ge_u32 s40, 32
  s_cselect_b32 s54, 0, s54
  s_add_u32 s55, s53, 256
  s_cmp_lt_u32 0, s16
  s_cselect_b32 s52, s40, 0
  s_add_u32 s55, s55, s52
  s_cmp_lt_u32 1, s16
  s_cselect_b32 s52, s41, 0
  s_add_u32 s55, s55, s52
  s_cmp_lt_u32 2, s16
  s_cselect_b32 s52, s42, 0
  s_add_u32 s55, s55, s52
  s_cmp_lt_u32 3, s16
  s_cselect_b32 s52, s43, 0
  s_add_u32 s55, s55, s52
  s_cmp_lt_u32 4, s16
  s_cselect_b32 s52, s44, 0
  s_add_u32 s55, s55, s52
  s_cmp_lt_u32 5, s16
  s_cselect_b32 s52, s45, 0
  s_add_u32 s55, s55, s52
  s_cmp_lt_u32 6, s16
  s_cselect_b32 s52, s46, 0
  s_add_u32 s55, s55, s52
  s_cmp_lt_u32 7, s16
  s_cselect_b32 s52, s47, 0
  s_add_u32 s55, s55, s52
  s_cmp_le_u32 s54, s16
  s_cselect_b32 s52, 32, 0
  s_sub_u32 s55, s55, s52
  s_cmp_eq_u32 s54, s16
  s_cbranch_scc0 mega_kernel_tf_bc
  s_cmp_lt_u32 s53, 32
  s_cselect_b32 s55, s53, s55
mega_kernel_tf_bc:
  v_mov_b32 v20, 24576
  v_mov_b32 v21, s55
  ds_write_b32 v20, v21
  s_waitcnt lgkmcnt(0)
mega_kernel_tf_wait:
  s_barrier
  v_mov_b32 v20, 24576
  ds_read_b32 v21, v20
  s_waitcnt lgkmcnt(0)
  v_readfirstlane_b32 s17, v21
  s_nop 3

  s_cmp_gt_u32 s17, 31
  s_cbranch_scc1 mega_kernel_worker

  v_lshlrev_b32 v2, 4, v0
  v_and_b32 v20, 15, v0
  v_lshrrev_b32 v21, 4, v0
  v_mov_b32 v22, 0x44444444
  v_mov_b32 v23, 0xeeeeeeee
  v_and_b32 v24, 2, v0
  v_cmp_eq_u32 vcc, 0, v24
  s_nop 1
  v_cndmask_b32 v1, v23, v22, vcc
  s_mov_b64 s[42:43], vcc
  s_lshl_b32 s50, s18, 15
  s_add_u32 s50, s50, 32768
  v_add_u32 v3, s50, v2
  s_lshl_b32 s51, s18, 5
  v_add_u32 v22, s51, v20
  v_lshlrev_b32 v22, 5, v22
  v_lshl_add_u32 v22, v21, 3, v22
  v_lshrrev_b32 v23, 3, v20
  v_lshlrev_b32 v23, 7, v23
  v_xor_b32 v22, v22, v23
  v_add_u32 v4, 24576, v22
  v_lshrrev_b32 v22, 2, v20
  v_lshl_add_u32 v22, v21, 3, v22
  v_lshlrev_b32 v22, 5, v22
  v_and_b32 v23, 3, v20
  v_lshl_add_u32 v22, v23, 3, v22
  v_and_b32 v23, 1, v21
  v_lshl_add_u32 v22, v23, 7, v22
  v_add_u32 v5, 24576, v22
  v_lshrrev_b32 v22, 1, v20
  v_and_b32 v22, 1, v22
  s_lshl_b32 s51, s18, 1
  v_add_u32 v22, s51, v22
  v_lshlrev_b32 v22, 8, v22
  v_and_b32 v23, 13, v20
  v_lshrrev_b32 v24, 1, v21
  v_lshl_add_u32 v23, v24, 1, v23
  v_lshl_add_u32 v22, v23, 4, v22
  v_and_b32 v23, 1, v21
  v_lshl_add_u32 v22, v23, 3, v22
  v_add_u32 v6, 0, v22
  v_lshrrev_b32 v22, 2, v20
  v_lshlrev_b32 v22, 15, v22
  v_and_b32 v23, 3, v20
  v_lshl_add_u32 v23, v21, 2, v23
  v_lshl_add_u32 v22, v23, 4, v22
  s_lshl_b32 s51, s18, 13
  s_lshr_b32 s52, s17, 1
  s_lshl_b32 s52, s52, 8
  s_add_u32 s51, s51, s52
  v_add_u32 v7, s51, v22
  v_and_b32 v22, 1, v20
  v_lshl_add_u32 v22, v21, 2, v22
  v_lshrrev_b32 v23, 2, v20
  v_and_b32 v23, 1, v23
  v_lshl_add_u32 v22, v23, 1, v22
  v_lshlrev_b32 v22, 4, v22
  v_lshrrev_b32 v23, 1, v20
  v_and_b32 v23, 1, v23
  v_lshl_add_u32 v22, v23, 3, v22
  s_lshl_b32 s51, s17, 8
  v_add_u32 v8, s51, v22
  v_mov_b32 v12, 0x3f803f80
  v_mov_b32 v13, 0x3f803f80
  v_mov_b32 v14, 0x3f803f80
  v_mov_b32 v15, 0x3f803f80
  v_mov_b32 v11, 0
  v_and_b32 v22, 7, v20
  v_lshrrev_b32 v23, 1, v22
  v_and_b32 v22, 1, v22
  v_lshlrev_b32 v22, 4, v22
  v_mov_b32 v24, 0x3f80
  v_lshlrev_b32 v24, v22, v24

  v_cmp_eq_u32 vcc, 0, v23
  s_nop 1
  v_cndmask_b32 v16, v11, v24, vcc
  v_cmp_eq_u32 vcc, 1, v23
  s_nop 1
  v_cndmask_b32 v17, v11, v24, vcc
  v_cmp_eq_u32 vcc, 2, v23
  s_nop 1
  v_cndmask_b32 v18, v11, v24, vcc
  v_cmp_eq_u32 vcc, 3, v23
  s_nop 1
  v_cndmask_b32 v19, v11, v24, vcc
  s_add_u32 s20, s12, 65011712
  s_addc_u32 s21, s13, 0
  s_and_b32 s21, s21, 0xffff
  s_mov_b32 s22, 0x80000
  s_mov_b32 s23, 0x00020000
  s_add_u32 s24, s12, 66060288
  s_addc_u32 s25, s13, 0
  s_and_b32 s25, s25, 0xffff
  s_mov_b32 s26, 0x8000
  s_mov_b32 s27, 0x00020000
  s_lshl_b32 s50, s17, 19
  s_lshl_b32 s51, s18, 11
  s_add_u32 s50, s50, s51
  s_add_u32 s52, s50, 2097152

  s_add_u32 s28, s12, s52
  s_addc_u32 s29, s13, 0
  s_add_u32 s52, s50, 18874368
  s_add_u32 s30, s12, s52
  s_addc_u32 s31, s13, 0
  s_add_u32 s68, s51, 8192
  s_add_u32 s69, s51, 16384
  s_lshl_b32 s50, s17, 12
  s_lshl_b32 s51, s18, 10
  s_add_u32 s50, s50, s51
  s_add_u32 s50, s50, 56623104
  s_add_u32 s32, s12, s50
  s_addc_u32 s33, s13, 0
  s_mov_b32 s49, 0x3e0293ee

  v_lshrrev_b32 v26, 2, v0
  v_lshrrev_b32 v27, 2, v26
  v_lshlrev_b32 v27, 4, v27
  v_and_b32 v26, 3, v26
  v_add_u32 v26, v26, v27
  v_lshlrev_b32 v26, 13, v26
  v_and_b32 v27, 3, v0
  v_lshl_add_u32 v22, v27, 4, v26
  v_lshlrev_b32 v26, 10, v21
  s_lshl_b32 s51, s17, 3
  v_add_u32 v27, s51, v20
  v_and_b32 v27, 15, v27
  v_and_b32 v28, 1, v21
  v_lshlrev_b32 v28, 1, v28
  v_xor_b32 v27, v27, v28
  v_lshl_add_u32 v23, v27, 4, v26
  v_xor_b32 v22, 64, v23
  v_xor_b32 v108, 0x80, v23
  v_xor_b32 v109, 0xc0, v23
  v_lshrrev_b32 v26, 2, v20
  v_and_b32 v27, 1, v26
  v_lshrrev_b32 v26, 1, v26
  v_lshl_add_u32 v26, v26, 3, v27
  v_and_b32 v27, 1, v21
  v_lshl_add_u32 v26, v27, 2, v26
  v_lshrrev_b32 v27, 1, v21
  v_lshl_add_u32 v28, v27, 4, v26
  v_lshlrev_b32 v28, 6, v28
  v_and_b32 v29, 3, v20
  v_lshl_add_u32 v28, v29, 3, v28
  s_lshl_b32 s50, s18, 15
  s_add_u32 s50, s50, 32768
  v_add_u32 v24, s50, v28
  v_lshl_add_u32 v30, v29, 3, v24
  v_lshlrev_b32 v28, 12, v27
  v_lshl_add_u32 v28, v26, 8, v28
  v_lshl_add_u32 v28, v29, 3, v28
  v_add_u32 v25, s50, v28
  v_bfe_u32 v28, v20, 2, 1
  v_lshl_add_u32 v25, v28, 5, v25
  v_and_b32 v28, 1, v21
  v_lshl_add_u32 v25, v28, 6, v25
  v_lshrrev_b32 v28, 3, v20
  v_lshl_add_u32 v25, v28, 7, v25
  s_lshl_b32 s51, s17, 8
  s_lshl_b32 s52, s18, 6
  s_add_u32 s51, s51, s52
  s_add_u32 s4, s4, s51
  s_addc_u32 s5, s5, 0
  s_add_u32 s6, s6, s51
  s_addc_u32 s7, s7, 0
  s_add_u32 s8, s8, s51
  s_addc_u32 s9, s9, 0
  s_lshl_b32 s51, s17, 17
  s_lshl_b32 s52, s18, 8
  s_add_u32 s51, s51, s52
  s_add_u32 s10, s10, s51
  s_addc_u32 s11, s11, 0

  s_lshl_b32 s51, s18, 6
  s_sub_u32 s4, s4, s51
  s_subb_u32 s5, s5, 0
  s_sub_u32 s6, s6, s51
  s_subb_u32 s7, s7, 0
  s_sub_u32 s8, s8, s51
  s_subb_u32 s9, s9, 0
  v_and_b32 v27, 1, v21
  v_lshlrev_b32 v27, 1, v27
  v_xor_b32 v27, v27, v20
  v_lshlrev_b32 v26, 13, v21
  v_lshl_add_u32 v96, v27, 4, v26
  v_xor_b32 v97, 64, v96
  v_xor_b32 v98, 0x80, v96
  v_xor_b32 v99, 0xc0, v96
  v_lshrrev_b32 v26, 1, v21
  v_lshlrev_b32 v26, 14, v26
  v_and_b32 v27, 1, v21
  v_lshl_add_u32 v26, v27, 12, v26
  v_lshlrev_b32 v28, 6, v27
  v_lshrrev_b32 v27, 3, v20
  v_lshl_add_u32 v26, v27, 13, v26
  v_lshl_add_u32 v28, v27, 7, v28
  v_bfe_u32 v27, v20, 2, 1
  v_lshl_add_u32 v26, v27, 8, v26
  v_lshl_add_u32 v28, v27, 5, v28
  v_add_u32 v26, 32768, v26
  v_and_b32 v27, 3, v20
  v_lshlrev_b32 v29, 3, v27
  v_add_u32 v29, s51, v29
  v_xor_b32 v29, v29, v28
  v_add_u32 v100, v26, v29
  v_xor_b32 v101, 32, v100
  v_lshlrev_b32 v29, 4, v27
  v_add_u32 v29, s51, v29
  v_xor_b32 v29, v29, v28
  v_add_u32 v102, v26, v29

  s_lshl_b32 s54, s18, 20
  s_lshl_b32 s55, s18, 14
  s_add_u32 s55, s55, 32768
  s_lshl_b32 s72, s18, 13
  v_subrev_u32 v24, s50, v25
  v_add_u32 v24, s72, v24
  s_add_u32 s52, s10, 0
  s_addc_u32 s53, s11, 0
  s_add_u32 m0, s72, 0
  s_nop 0
  global_load_lds_dwordx4 v23, s[52:53]
  s_add_u32 s52, s10, 8192
  s_addc_u32 s53, s11, 0
  s_add_u32 m0, s72, 1024
  s_nop 0
  global_load_lds_dwordx4 v22, s[52:53]
  s_add_u32 s52, s10, 16384
  s_addc_u32 s53, s11, 0
  s_add_u32 m0, s72, 2048
  s_nop 0
  global_load_lds_dwordx4 v108, s[52:53]
  s_add_u32 s52, s10, 24576
  s_addc_u32 s53, s11, 0
  s_add_u32 m0, s72, 3072
  s_nop 0
  global_load_lds_dwordx4 v109, s[52:53]
  s_add_u32 s52, s10, 4096
  s_addc_u32 s53, s11, 0
  s_add_u32 m0, s72, 4096
  s_nop 0
  global_load_lds_dwordx4 v23, s[52:53]
  s_add_u32 s52, s10, 12288
  s_addc_u32 s53, s11, 0
  s_add_u32 m0, s72, 5120
  s_nop 0
  global_load_lds_dwordx4 v22, s[52:53]
  s_add_u32 s52, s10, 20480
  s_addc_u32 s53, s11, 0
  s_add_u32 m0, s72, 6144
  s_nop 0
  global_load_lds_dwordx4 v108, s[52:53]
  s_add_u32 s52, s10, 28672
  s_addc_u32 s53, s11, 0
  s_add_u32 m0, s72, 7168
  s_nop 0
  global_load_lds_dwordx4 v109, s[52:53]
  s_add_u32 s52, s10, 32768
  s_addc_u32 s53, s11, 0
  global_load_dwordx4 v[32:35], v23, s[52:53]
  s_add_u32 s52, s10, 40960
  s_addc_u32 s53, s11, 0
  global_load_dwordx4 v[36:39], v22, s[52:53]
  s_add_u32 s52, s10, 49152
  s_addc_u32 s53, s11, 0
  global_load_dwordx4 v[40:43], v108, s[52:53]
  s_add_u32 s52, s10, 57344
  s_addc_u32 s53, s11, 0
  global_load_dwordx4 v[44:47], v109, s[52:53]
  s_add_u32 s52, s10, 36864
  s_addc_u32 s53, s11, 0
  global_load_dwordx4 v[48:51], v23, s[52:53]
  s_add_u32 s52, s10, 45056
  s_addc_u32 s53, s11, 0
  global_load_dwordx4 v[52:55], v22, s[52:53]
  s_add_u32 s52, s10, 53248
  s_addc_u32 s53, s11, 0
  global_load_dwordx4 v[56:59], v108, s[52:53]
  s_add_u32 s52, s10, 61440
  s_addc_u32 s53, s11, 0
  global_load_dwordx4 v[60:63], v109, s[52:53]
  s_add_u32 s52, s10, 65536
  s_addc_u32 s53, s11, 0
  global_load_dwordx4 v[64:67], v23, s[52:53]
  s_add_u32 s52, s10, 73728
  s_addc_u32 s53, s11, 0
  global_load_dwordx4 v[68:71], v22, s[52:53]
  s_add_u32 s52, s10, 81920
  s_addc_u32 s53, s11, 0
  global_load_dwordx4 v[72:75], v108, s[52:53]
  s_add_u32 s52, s10, 90112
  s_addc_u32 s53, s11, 0
  global_load_dwordx4 v[76:79], v109, s[52:53]
  s_add_u32 s52, s10, 69632
  s_addc_u32 s53, s11, 0
  global_load_dwordx4 v[80:83], v23, s[52:53]
  s_add_u32 s52, s10, 77824
  s_addc_u32 s53, s11, 0
  global_load_dwordx4 v[84:87], v22, s[52:53]
  s_add_u32 s52, s10, 86016
  s_addc_u32 s53, s11, 0
  global_load_dwordx4 v[88:91], v108, s[52:53]
  s_add_u32 s52, s10, 94208
  s_addc_u32 s53, s11, 0
  global_load_dwordx4 v[92:95], v109, s[52:53]
  s_add_u32 s52, s10, 98304
  s_addc_u32 s53, s11, 0
  global_load_dwordx4 v[112:115], v23, s[52:53]
  s_add_u32 s52, s10, 106496
  s_addc_u32 s53, s11, 0
  global_load_dwordx4 v[116:119], v22, s[52:53]
  s_add_u32 s52, s10, 114688
  s_addc_u32 s53, s11, 0
  global_load_dwordx4 v[120:123], v108, s[52:53]
  s_add_u32 s52, s10, 122880
  s_addc_u32 s53, s11, 0
  global_load_dwordx4 v[124:127], v109, s[52:53]
  v_and_b32 v26, 1, v20
  v_lshl_add_u32 v26, v21, 1, v26
  v_lshlrev_b32 v26, 10, v26
  v_bfe_u32 v27, v20, 1, 2
  v_lshl_add_u32 v26, v27, 5, v26
  s_and_b32 s72, s17, 3
  s_lshl_b32 s72, s72, 8
  s_lshr_b32 s73, s17, 4
  s_lshl_b32 s73, s73, 7
  s_add_u32 s72, s72, s73
  s_bfe_u32 s73, s17, 0x20002
  s_lshl_b32 s73, s73, 3
  s_add_u32 s72, s72, s73
  v_add_u32 v26, s72, v26
  global_load_dwordx2 v[106:107], v26, s[56:57]

  s_add_u32 s52, s4, s54
  s_addc_u32 s53, s5, 0
  s_add_u32 s52, s52, 0
  s_addc_u32 s53, s53, 0
  s_add_u32 m0, s55, 0
  s_nop 0
  global_load_lds_dwordx4 v96, s[52:53]
  s_add_u32 s52, s52, 32768
  s_addc_u32 s53, s53, 0
  s_add_u32 m0, s55, 1024
  s_nop 0
  global_load_lds_dwordx4 v96, s[52:53]
  s_add_u32 s52, s52, 32768
  s_addc_u32 s53, s53, 0
  s_add_u32 m0, s55, 2048
  s_nop 0
  global_load_lds_dwordx4 v96, s[52:53]
  s_add_u32 s52, s52, 32768
  s_addc_u32 s53, s53, 0
  s_add_u32 m0, s55, 3072
  s_nop 0
  global_load_lds_dwordx4 v96, s[52:53]
  s_add_u32 s52, s52, 32768
  s_addc_u32 s53, s53, 0
  s_add_u32 m0, s55, 4096
  s_nop 0
  global_load_lds_dwordx4 v97, s[52:53]
  s_add_u32 s52, s52, 32768
  s_addc_u32 s53, s53, 0
  s_add_u32 m0, s55, 5120
  s_nop 0
  global_load_lds_dwordx4 v97, s[52:53]
  s_add_u32 s52, s52, 32768
  s_addc_u32 s53, s53, 0
  s_add_u32 m0, s55, 6144
  s_nop 0
  global_load_lds_dwordx4 v97, s[52:53]
  s_add_u32 s52, s52, 32768
  s_addc_u32 s53, s53, 0
  s_add_u32 m0, s55, 7168
  s_nop 0
  global_load_lds_dwordx4 v97, s[52:53]
  s_add_u32 s52, s52, 32768
  s_addc_u32 s53, s53, 0
  s_add_u32 m0, s55, 8192
  s_nop 0
  global_load_lds_dwordx4 v98, s[52:53]
  s_add_u32 s52, s52, 32768
  s_addc_u32 s53, s53, 0
  s_add_u32 m0, s55, 9216
  s_nop 0
  global_load_lds_dwordx4 v98, s[52:53]
  s_add_u32 s52, s52, 32768
  s_addc_u32 s53, s53, 0
  s_add_u32 m0, s55, 10240
  s_nop 0
  global_load_lds_dwordx4 v98, s[52:53]
  s_add_u32 s52, s52, 32768
  s_addc_u32 s53, s53, 0
  s_add_u32 m0, s55, 11264
  s_nop 0
  global_load_lds_dwordx4 v98, s[52:53]
  s_add_u32 s52, s52, 32768
  s_addc_u32 s53, s53, 0
  s_add_u32 m0, s55, 12288
  s_nop 0
  global_load_lds_dwordx4 v99, s[52:53]
  s_add_u32 s52, s52, 32768
  s_addc_u32 s53, s53, 0
  s_add_u32 m0, s55, 13312
  s_nop 0
  global_load_lds_dwordx4 v99, s[52:53]
  s_add_u32 s52, s52, 32768
  s_addc_u32 s53, s53, 0
  s_add_u32 m0, s55, 14336
  s_nop 0
  global_load_lds_dwordx4 v99, s[52:53]
  s_add_u32 s52, s52, 32768
  s_addc_u32 s53, s53, 0
  s_add_u32 m0, s55, 15360
  s_nop 0
  global_load_lds_dwordx4 v99, s[52:53]
  s_add_u32 s52, s52, 32768
  s_addc_u32 s53, s53, 0
  s_add_u32 s52, s4, s54
  s_addc_u32 s53, s5, 0
  s_add_u32 s52, s52, 524288
  s_addc_u32 s53, s53, 0
  s_add_u32 m0, s55, 65536
  s_nop 0
  global_load_lds_dwordx4 v96, s[52:53]
  s_add_u32 s52, s52, 32768
  s_addc_u32 s53, s53, 0
  s_add_u32 m0, s55, 66560
  s_nop 0
  global_load_lds_dwordx4 v96, s[52:53]
  s_add_u32 s52, s52, 32768
  s_addc_u32 s53, s53, 0
  s_add_u32 m0, s55, 67584
  s_nop 0
  global_load_lds_dwordx4 v96, s[52:53]
  s_add_u32 s52, s52, 32768
  s_addc_u32 s53, s53, 0
  s_add_u32 m0, s55, 68608
  s_nop 0
  global_load_lds_dwordx4 v96, s[52:53]
  s_add_u32 s52, s52, 32768
  s_addc_u32 s53, s53, 0
  s_add_u32 m0, s55, 69632
  s_nop 0
  global_load_lds_dwordx4 v97, s[52:53]
  s_add_u32 s52, s52, 32768
  s_addc_u32 s53, s53, 0
  s_add_u32 m0, s55, 70656
  s_nop 0
  global_load_lds_dwordx4 v97, s[52:53]
  s_add_u32 s52, s52, 32768
  s_addc_u32 s53, s53, 0
  s_add_u32 m0, s55, 71680
  s_nop 0
  global_load_lds_dwordx4 v97, s[52:53]
  s_add_u32 s52, s52, 32768
  s_addc_u32 s53, s53, 0
  s_add_u32 m0, s55, 72704
  s_nop 0
  global_load_lds_dwordx4 v97, s[52:53]
  s_add_u32 s52, s52, 32768
  s_addc_u32 s53, s53, 0
  s_add_u32 m0, s55, 73728
  s_nop 0
  global_load_lds_dwordx4 v98, s[52:53]
  s_add_u32 s52, s52, 32768
  s_addc_u32 s53, s53, 0
  s_add_u32 m0, s55, 74752
  s_nop 0
  global_load_lds_dwordx4 v98, s[52:53]
  s_add_u32 s52, s52, 32768
  s_addc_u32 s53, s53, 0
  s_add_u32 m0, s55, 75776
  s_nop 0
  global_load_lds_dwordx4 v98, s[52:53]
  s_add_u32 s52, s52, 32768
  s_addc_u32 s53, s53, 0
  s_add_u32 m0, s55, 76800
  s_nop 0
  global_load_lds_dwordx4 v98, s[52:53]
  s_add_u32 s52, s52, 32768
  s_addc_u32 s53, s53, 0
  s_add_u32 m0, s55, 77824
  s_nop 0
  global_load_lds_dwordx4 v99, s[52:53]
  s_add_u32 s52, s52, 32768
  s_addc_u32 s53, s53, 0
  s_add_u32 m0, s55, 78848
  s_nop 0
  global_load_lds_dwordx4 v99, s[52:53]
  s_add_u32 s52, s52, 32768
  s_addc_u32 s53, s53, 0
  s_add_u32 m0, s55, 79872
  s_nop 0
  global_load_lds_dwordx4 v99, s[52:53]
  s_add_u32 s52, s52, 32768
  s_addc_u32 s53, s53, 0
  s_add_u32 m0, s55, 80896
  s_nop 0
  global_load_lds_dwordx4 v99, s[52:53]
  s_add_u32 s52, s52, 32768
  s_addc_u32 s53, s53, 0
  s_waitcnt vmcnt(16)
  s_barrier
  s_xor_b32 s52, s18, 0
  s_lshl_b32 s52, s52, 10
  s_add_u32 s52, s52, 0
  v_add_u32 v104, s52, v100
  v_add_u32 v105, s52, v101
  ds_read_b64_tr_b16 a[0:1], v104 offset:0
  ds_read_b64_tr_b16 a[2:3], v104 offset:512
  ds_read_b64_tr_b16 a[4:5], v104 offset:32768
  ds_read_b64_tr_b16 a[6:7], v104 offset:33280
  ds_read_b64_tr_b16 a[64:65], v105 offset:0
  ds_read_b64_tr_b16 a[66:67], v105 offset:512
  ds_read_b64_tr_b16 a[68:69], v105 offset:32768
  ds_read_b64_tr_b16 a[70:71], v105 offset:33280
  s_xor_b32 s52, s18, 1
  s_lshl_b32 s52, s52, 10
  s_add_u32 s52, s52, 0
  v_add_u32 v104, s52, v100
  v_add_u32 v105, s52, v101
  ds_read_b64_tr_b16 a[8:9], v104 offset:0
  ds_read_b64_tr_b16 a[10:11], v104 offset:512
  ds_read_b64_tr_b16 a[12:13], v104 offset:32768
  ds_read_b64_tr_b16 a[14:15], v104 offset:33280
  ds_read_b64_tr_b16 a[72:73], v105 offset:0
  ds_read_b64_tr_b16 a[74:75], v105 offset:512
  ds_read_b64_tr_b16 a[76:77], v105 offset:32768
  ds_read_b64_tr_b16 a[78:79], v105 offset:33280
  s_xor_b32 s52, s18, 2
  s_lshl_b32 s52, s52, 10
  s_add_u32 s52, s52, 0
  v_add_u32 v104, s52, v100
  v_add_u32 v105, s52, v101
  ds_read_b64_tr_b16 a[16:17], v104 offset:0
  ds_read_b64_tr_b16 a[18:19], v104 offset:512
  ds_read_b64_tr_b16 a[20:21], v104 offset:32768
  ds_read_b64_tr_b16 a[22:23], v104 offset:33280
  ds_read_b64_tr_b16 a[80:81], v105 offset:0
  ds_read_b64_tr_b16 a[82:83], v105 offset:512
  ds_read_b64_tr_b16 a[84:85], v105 offset:32768
  ds_read_b64_tr_b16 a[86:87], v105 offset:33280
  s_xor_b32 s52, s18, 3
  s_lshl_b32 s52, s52, 10
  s_add_u32 s52, s52, 0
  v_add_u32 v104, s52, v100
  v_add_u32 v105, s52, v101
  ds_read_b64_tr_b16 a[24:25], v104 offset:0
  ds_read_b64_tr_b16 a[26:27], v104 offset:512
  ds_read_b64_tr_b16 a[28:29], v104 offset:32768
  ds_read_b64_tr_b16 a[30:31], v104 offset:33280
  ds_read_b64_tr_b16 a[88:89], v105 offset:0
  ds_read_b64_tr_b16 a[90:91], v105 offset:512
  ds_read_b64_tr_b16 a[92:93], v105 offset:32768
  ds_read_b64_tr_b16 a[94:95], v105 offset:33280
  s_waitcnt lgkmcnt(0)
  s_barrier
  v_and_b32 v110, 3, v0
  v_lshlrev_b32 v110, 6, v110
  v_bfe_u32 v111, v0, 2, 1
  v_lshl_add_u32 v110, v111, 2, v110
  global_load_dword v111, v110, s[58:59] sc1
  s_add_u32 s52, s6, s54
  s_addc_u32 s53, s7, 0
  s_add_u32 s52, s52, 0
  s_addc_u32 s53, s53, 0
  s_add_u32 m0, s55, 0
  s_nop 0
  global_load_lds_dwordx4 v96, s[52:53]
  s_add_u32 s52, s52, 32768
  s_addc_u32 s53, s53, 0
  s_add_u32 m0, s55, 1024
  s_nop 0
  global_load_lds_dwordx4 v96, s[52:53]
  s_add_u32 s52, s52, 32768
  s_addc_u32 s53, s53, 0
  s_add_u32 m0, s55, 2048
  s_nop 0
  global_load_lds_dwordx4 v96, s[52:53]
  s_add_u32 s52, s52, 32768
  s_addc_u32 s53, s53, 0
  s_add_u32 m0, s55, 3072
  s_nop 0
  global_load_lds_dwordx4 v96, s[52:53]
  s_add_u32 s52, s52, 32768
  s_addc_u32 s53, s53, 0
  s_add_u32 m0, s55, 4096
  s_nop 0
  global_load_lds_dwordx4 v97, s[52:53]
  s_add_u32 s52, s52, 32768
  s_addc_u32 s53, s53, 0
  s_add_u32 m0, s55, 5120
  s_nop 0
  global_load_lds_dwordx4 v97, s[52:53]
  s_add_u32 s52, s52, 32768
  s_addc_u32 s53, s53, 0
  s_add_u32 m0, s55, 6144
  s_nop 0
  global_load_lds_dwordx4 v97, s[52:53]
  s_add_u32 s52, s52, 32768
  s_addc_u32 s53, s53, 0
  s_add_u32 m0, s55, 7168
  s_nop 0
  global_load_lds_dwordx4 v97, s[52:53]
  s_add_u32 s52, s52, 32768
  s_addc_u32 s53, s53, 0
  s_add_u32 m0, s55, 8192
  s_nop 0
  global_load_lds_dwordx4 v98, s[52:53]
  s_add_u32 s52, s52, 32768
  s_addc_u32 s53, s53, 0
  s_add_u32 m0, s55, 9216
  s_nop 0
  global_load_lds_dwordx4 v98, s[52:53]
  s_add_u32 s52, s52, 32768
  s_addc_u32 s53, s53, 0
  s_add_u32 m0, s55, 10240
  s_nop 0
  global_load_lds_dwordx4 v98, s[52:53]
  s_add_u32 s52, s52, 32768
  s_addc_u32 s53, s53, 0
  s_add_u32 m0, s55, 11264
  s_nop 0
  global_load_lds_dwordx4 v98, s[52:53]
  s_add_u32 s52, s52, 32768
  s_addc_u32 s53, s53, 0
  s_add_u32 m0, s55, 12288
  s_nop 0
  global_load_lds_dwordx4 v99, s[52:53]
  s_add_u32 s52, s52, 32768
  s_addc_u32 s53, s53, 0
  s_add_u32 m0, s55, 13312
  s_nop 0
  global_load_lds_dwordx4 v99, s[52:53]
  s_add_u32 s52, s52, 32768
  s_addc_u32 s53, s53, 0
  s_add_u32 m0, s55, 14336
  s_nop 0
  global_load_lds_dwordx4 v99, s[52:53]
  s_add_u32 s52, s52, 32768
  s_addc_u32 s53, s53, 0
  s_add_u32 m0, s55, 15360
  s_nop 0
  global_load_lds_dwordx4 v99, s[52:53]
  s_add_u32 s52, s52, 32768
  s_addc_u32 s53, s53, 0
  s_waitcnt vmcnt(16)
  s_mov_b32 s60, 0
  s_cmp_eq_u32 s16, 0
  s_cbranch_scc0 mega_kernel_vf_ok
  s_branch mega_kernel_vf_ev
mega_kernel_vf_spin:
  global_load_dword v111, v110, s[58:59] sc1
  s_add_u32 s60, s60, 1
  s_cmp_gt_u32 s60, 50000000
  s_cbranch_scc1 mega_kernel_fail
  s_waitcnt vmcnt(0)
mega_kernel_vf_ev:

  v_readlane_b32 s72, v111, 0
  v_readlane_b32 s73, v111, 1
  v_readlane_b32 s74, v111, 2
  v_readlane_b32 s75, v111, 3
  v_readlane_b32 s76, v111, 4
  v_readlane_b32 s77, v111, 5
  v_readlane_b32 s78, v111, 6
  v_readlane_b32 s79, v111, 7
  s_nop 3
  s_cmp_ge_u32 s72, 32
  s_cbranch_scc1 mega_kernel_vf_ok
  s_mov_b32 s61, 0
  s_add_u32 s61, s61, s72
  s_add_u32 s61, s61, s73
  s_add_u32 s61, s61, s74
  s_add_u32 s61, s61, s75
  s_add_u32 s61, s61, s76
  s_add_u32 s61, s61, s77
  s_add_u32 s61, s61, s78
  s_add_u32 s61, s61, s79
  s_cmp_ge_u32 s61, 256
  s_cbranch_scc0 mega_kernel_vf_spin
  s_load_dwordx4 s[4:7], s[0:1], 16
  s_load_dwordx4 s[8:11], s[0:1], 32
  s_mov_b32 s53, s17
  s_waitcnt vmcnt(0) lgkmcnt(0)
  s_barrier
  s_cmp_eq_u32 s18, 0
  s_cbranch_scc1 mega_kernel_tf_full
  s_branch mega_kernel_tf_wait
mega_kernel_vf_ok:

  s_barrier
  v_mov_b32 v28, -1
  v_mov_b32 v29, -1
  v_mov_b32 v30, -1
  v_mov_b32 v31, -1
  s_lshr_b32 s72, s18, 1
  s_lshl_b32 s72, s72, 18
  s_lshl_b32 s73, s17, 13
  s_add_u32 s72, s72, s73
  s_and_b32 s73, s18, 1
  s_lshl_b32 s73, s73, 12
  s_add_u32 s72, s72, s73
  buffer_store_dwordx4 v[28:31], v2, s[20:23], s72 offen
  buffer_store_dwordx4 v[28:31], v2, s[20:23], s72 offen offset:1024
  buffer_store_dwordx4 v[28:31], v2, s[20:23], s72 offen offset:2048
  buffer_store_dwordx4 v[28:31], v2, s[20:23], s72 offen offset:3072
  s_add_u32 s72, s18, 1
  s_and_b32 s72, s72, 3
  s_lshl_b32 s72, s72, 13
  s_cmp_eq_u32 s18, 3
  s_cbranch_scc0 mega_kernel_in1
  v_min_u32 v28, -2, v106
  v_min_u32 v29, -2, v107
mega_kernel_in1:
  buffer_store_dwordx2 v[28:29], v8, s[24:27], s72 offen

  s_xor_b32 s52, s18, 0
  s_lshl_b32 s52, s52, 10
  s_add_u32 s52, s52, 65536
  v_add_u32 v104, s52, v100
  v_add_u32 v105, s52, v101
  ds_read_b64_tr_b16 a[32:33], v104 offset:0
  ds_read_b64_tr_b16 a[34:35], v104 offset:512
  ds_read_b64_tr_b16 a[36:37], v104 offset:32768
  ds_read_b64_tr_b16 a[38:39], v104 offset:33280
  ds_read_b64_tr_b16 a[96:97], v105 offset:0
  ds_read_b64_tr_b16 a[98:99], v105 offset:512
  ds_read_b64_tr_b16 a[100:101], v105 offset:32768
  ds_read_b64_tr_b16 a[102:103], v105 offset:33280
  s_xor_b32 s52, s18, 1
  s_lshl_b32 s52, s52, 10
  s_add_u32 s52, s52, 65536
  v_add_u32 v104, s52, v100
  v_add_u32 v105, s52, v101
  ds_read_b64_tr_b16 a[40:41], v104 offset:0
  ds_read_b64_tr_b16 a[42:43], v104 offset:512
  ds_read_b64_tr_b16 a[44:45], v104 offset:32768
  ds_read_b64_tr_b16 a[46:47], v104 offset:33280
  ds_read_b64_tr_b16 a[104:105], v105 offset:0
  ds_read_b64_tr_b16 a[106:107], v105 offset:512
  ds_read_b64_tr_b16 a[108:109], v105 offset:32768
  ds_read_b64_tr_b16 a[110:111], v105 offset:33280
  s_xor_b32 s52, s18, 2
  s_lshl_b32 s52, s52, 10
  s_add_u32 s52, s52, 65536
  v_add_u32 v104, s52, v100
  v_add_u32 v105, s52, v101
  ds_read_b64_tr_b16 a[48:49], v104 offset:0
  ds_read_b64_tr_b16 a[50:51], v104 offset:512
  ds_read_b64_tr_b16 a[52:53], v104 offset:32768
  ds_read_b64_tr_b16 a[54:55], v104 offset:33280
  ds_read_b64_tr_b16 a[112:113], v105 offset:0
  ds_read_b64_tr_b16 a[114:115], v105 offset:512
  ds_read_b64_tr_b16 a[116:117], v105 offset:32768
  ds_read_b64_tr_b16 a[118:119], v105 offset:33280
  s_xor_b32 s52, s18, 3
  s_lshl_b32 s52, s52, 10
  s_add_u32 s52, s52, 65536
  v_add_u32 v104, s52, v100
  v_add_u32 v105, s52, v101
  ds_read_b64_tr_b16 a[56:57], v104 offset:0
  ds_read_b64_tr_b16 a[58:59], v104 offset:512
  ds_read_b64_tr_b16 a[60:61], v104 offset:32768
  ds_read_b64_tr_b16 a[62:63], v104 offset:33280
  ds_read_b64_tr_b16 a[120:121], v105 offset:0
  ds_read_b64_tr_b16 a[122:123], v105 offset:512
  ds_read_b64_tr_b16 a[124:125], v105 offset:32768
  ds_read_b64_tr_b16 a[126:127], v105 offset:33280
  s_waitcnt lgkmcnt(0)
  s_barrier
  s_add_u32 s52, s6, s54
  s_addc_u32 s53, s7, 0
  s_add_u32 s52, s52, 524288
  s_addc_u32 s53, s53, 0
  s_add_u32 m0, s55, 65536
  s_nop 0
  global_load_lds_dwordx4 v96, s[52:53]
  s_add_u32 s52, s52, 32768
  s_addc_u32 s53, s53, 0
  s_add_u32 m0, s55, 66560
  s_nop 0
  global_load_lds_dwordx4 v96, s[52:53]
  s_add_u32 s52, s52, 32768
  s_addc_u32 s53, s53, 0
  s_add_u32 m0, s55, 67584
  s_nop 0
  global_load_lds_dwordx4 v96, s[52:53]
  s_add_u32 s52, s52, 32768
  s_addc_u32 s53, s53, 0
  s_add_u32 m0, s55, 68608
  s_nop 0
  global_load_lds_dwordx4 v96, s[52:53]
  s_add_u32 s52, s52, 32768
  s_addc_u32 s53, s53, 0
  s_add_u32 m0, s55, 69632
  s_nop 0
  global_load_lds_dwordx4 v97, s[52:53]
  s_add_u32 s52, s52, 32768
  s_addc_u32 s53, s53, 0
  s_add_u32 m0, s55, 70656
  s_nop 0
  global_load_lds_dwordx4 v97, s[52:53]
  s_add_u32 s52, s52, 32768
  s_addc_u32 s53, s53, 0
  s_add_u32 m0, s55, 71680
  s_nop 0
  global_load_lds_dwordx4 v97, s[52:53]
  s_add_u32 s52, s52, 32768
  s_addc_u32 s53, s53, 0
  s_add_u32 m0, s55, 72704
  s_nop 0
  global_load_lds_dwordx4 v97, s[52:53]
  s_add_u32 s52, s52, 32768
  s_addc_u32 s53, s53, 0
  s_add_u32 m0, s55, 73728
  s_nop 0
  global_load_lds_dwordx4 v98, s[52:53]
  s_add_u32 s52, s52, 32768
  s_addc_u32 s53, s53, 0
  s_add_u32 m0, s55, 74752
  s_nop 0
  global_load_lds_dwordx4 v98, s[52:53]
  s_add_u32 s52, s52, 32768
  s_addc_u32 s53, s53, 0
  s_add_u32 m0, s55, 75776
  s_nop 0
  global_load_lds_dwordx4 v98, s[52:53]
  s_add_u32 s52, s52, 32768
  s_addc_u32 s53, s53, 0
  s_add_u32 m0, s55, 76800
  s_nop 0
  global_load_lds_dwordx4 v98, s[52:53]
  s_add_u32 s52, s52, 32768
  s_addc_u32 s53, s53, 0
  s_add_u32 m0, s55, 77824
  s_nop 0
  global_load_lds_dwordx4 v99, s[52:53]
  s_add_u32 s52, s52, 32768
  s_addc_u32 s53, s53, 0
  s_add_u32 m0, s55, 78848
  s_nop 0
  global_load_lds_dwordx4 v99, s[52:53]
  s_add_u32 s52, s52, 32768
  s_addc_u32 s53, s53, 0
  s_add_u32 m0, s55, 79872
  s_nop 0
  global_load_lds_dwordx4 v99, s[52:53]
  s_add_u32 s52, s52, 32768
  s_addc_u32 s53, s53, 0
  s_add_u32 m0, s55, 80896
  s_nop 0
  global_load_lds_dwordx4 v99, s[52:53]
  s_add_u32 s52, s52, 32768
  s_addc_u32 s53, s53, 0
  s_waitcnt vmcnt(16)
  s_barrier
  s_cmp_eq_u32 s18, 0
  s_cbranch_scc0 mega_kernel_tb1
  v_mov_b32 v28, 96
  v_mov_b32 v29, 1
  v_cmp_eq_u32 vcc, 0, v0
  s_and_saveexec_b64 s[62:63], vcc
  global_atomic_add v28, v29, s[58:59]
  s_mov_b64 exec, s[62:63]
mega_kernel_tb1:

  s_xor_b32 s52, s18, 0
  s_lshl_b32 s52, s52, 10
  s_add_u32 s52, s52, 0
  v_add_u32 v104, s52, v100
  v_add_u32 v105, s52, v101
  ds_read_b64_tr_b16 a[128:129], v104 offset:0
  ds_read_b64_tr_b16 a[130:131], v104 offset:512
  ds_read_b64_tr_b16 a[132:133], v104 offset:32768
  ds_read_b64_tr_b16 a[134:135], v104 offset:33280
  ds_read_b64_tr_b16 a[192:193], v105 offset:0
  ds_read_b64_tr_b16 a[194:195], v105 offset:512
  ds_read_b64_tr_b16 a[196:197], v105 offset:32768
  ds_read_b64_tr_b16 a[198:199], v105 offset:33280
  s_xor_b32 s52, s18, 1
  s_lshl_b32 s52, s52, 10
  s_add_u32 s52, s52, 0
  v_add_u32 v104, s52, v100
  v_add_u32 v105, s52, v101
  ds_read_b64_tr_b16 a[136:137], v104 offset:0
  ds_read_b64_tr_b16 a[138:139], v104 offset:512
  ds_read_b64_tr_b16 a[140:141], v104 offset:32768
  ds_read_b64_tr_b16 a[142:143], v104 offset:33280
  ds_read_b64_tr_b16 a[200:201], v105 offset:0
  ds_read_b64_tr_b16 a[202:203], v105 offset:512
  ds_read_b64_tr_b16 a[204:205], v105 offset:32768
  ds_read_b64_tr_b16 a[206:207], v105 offset:33280
  s_xor_b32 s52, s18, 2
  s_lshl_b32 s52, s52, 10
  s_add_u32 s52, s52, 0
  v_add_u32 v104, s52, v100
  v_add_u32 v105, s52, v101
  ds_read_b64_tr_b16 a[144:145], v104 offset:0
  ds_read_b64_tr_b16 a[146:147], v104 offset:512
  ds_read_b64_tr_b16 a[148:149], v104 offset:32768
  ds_read_b64_tr_b16 a[150:151], v104 offset:33280
  ds_read_b64_tr_b16 a[208:209], v105 offset:0
  ds_read_b64_tr_b16 a[210:211], v105 offset:512
  ds_read_b64_tr_b16 a[212:213], v105 offset:32768
  ds_read_b64_tr_b16 a[214:215], v105 offset:33280
  s_xor_b32 s52, s18, 3
  s_lshl_b32 s52, s52, 10
  s_add_u32 s52, s52, 0
  v_add_u32 v104, s52, v100
  v_add_u32 v105, s52, v101
  ds_read_b64_tr_b16 a[152:153], v104 offset:0
  ds_read_b64_tr_b16 a[154:155], v104 offset:512
  ds_read_b64_tr_b16 a[156:157], v104 offset:32768
  ds_read_b64_tr_b16 a[158:159], v104 offset:33280
  ds_read_b64_tr_b16 a[216:217], v105 offset:0
  ds_read_b64_tr_b16 a[218:219], v105 offset:512
  ds_read_b64_tr_b16 a[220:221], v105 offset:32768
  ds_read_b64_tr_b16 a[222:223], v105 offset:33280
  s_waitcnt lgkmcnt(0)
  s_barrier
  s_add_u32 s52, s8, s54
  s_addc_u32 s53, s9, 0
  s_add_u32 s52, s52, 0
  s_addc_u32 s53, s53, 0
  s_add_u32 m0, s55, 0
  s_nop 0
  global_load_lds_dwordx4 v96, s[52:53]
  s_add_u32 s52, s52, 32768
  s_addc_u32 s53, s53, 0
  s_add_u32 m0, s55, 1024
  s_nop 0
  global_load_lds_dwordx4 v96, s[52:53]
  s_add_u32 s52, s52, 32768
  s_addc_u32 s53, s53, 0
  s_add_u32 m0, s55, 2048
  s_nop 0
  global_load_lds_dwordx4 v96, s[52:53]
  s_add_u32 s52, s52, 32768
  s_addc_u32 s53, s53, 0
  s_add_u32 m0, s55, 3072
  s_nop 0
  global_load_lds_dwordx4 v96, s[52:53]
  s_add_u32 s52, s52, 32768
  s_addc_u32 s53, s53, 0
  s_add_u32 m0, s55, 4096
  s_nop 0
  global_load_lds_dwordx4 v97, s[52:53]
  s_add_u32 s52, s52, 32768
  s_addc_u32 s53, s53, 0
  s_add_u32 m0, s55, 5120
  s_nop 0
  global_load_lds_dwordx4 v97, s[52:53]
  s_add_u32 s52, s52, 32768
  s_addc_u32 s53, s53, 0
  s_add_u32 m0, s55, 6144
  s_nop 0
  global_load_lds_dwordx4 v97, s[52:53]
  s_add_u32 s52, s52, 32768
  s_addc_u32 s53, s53, 0
  s_add_u32 m0, s55, 7168
  s_nop 0
  global_load_lds_dwordx4 v97, s[52:53]
  s_add_u32 s52, s52, 32768
  s_addc_u32 s53, s53, 0
  s_add_u32 m0, s55, 8192
  s_nop 0
  global_load_lds_dwordx4 v98, s[52:53]
  s_add_u32 s52, s52, 32768
  s_addc_u32 s53, s53, 0
  s_add_u32 m0, s55, 9216
  s_nop 0
  global_load_lds_dwordx4 v98, s[52:53]
  s_add_u32 s52, s52, 32768
  s_addc_u32 s53, s53, 0
  s_add_u32 m0, s55, 10240
  s_nop 0
  global_load_lds_dwordx4 v98, s[52:53]
  s_add_u32 s52, s52, 32768
  s_addc_u32 s53, s53, 0
  s_add_u32 m0, s55, 11264
  s_nop 0
  global_load_lds_dwordx4 v98, s[52:53]
  s_add_u32 s52, s52, 32768
  s_addc_u32 s53, s53, 0
  s_add_u32 m0, s55, 12288
  s_nop 0
  global_load_lds_dwordx4 v99, s[52:53]
  s_add_u32 s52, s52, 32768
  s_addc_u32 s53, s53, 0
  s_add_u32 m0, s55, 13312
  s_nop 0
  global_load_lds_dwordx4 v99, s[52:53]
  s_add_u32 s52, s52, 32768
  s_addc_u32 s53, s53, 0
  s_add_u32 m0, s55, 14336
  s_nop 0
  global_load_lds_dwordx4 v99, s[52:53]
  s_add_u32 s52, s52, 32768
  s_addc_u32 s53, s53, 0
  s_add_u32 m0, s55, 15360
  s_nop 0
  global_load_lds_dwordx4 v99, s[52:53]
  s_add_u32 s52, s52, 32768
  s_addc_u32 s53, s53, 0
  s_waitcnt vmcnt(16)
  s_barrier
  s_xor_b32 s52, s18, 0
  s_lshl_b32 s52, s52, 10
  s_add_u32 s52, s52, 65536
  v_add_u32 v104, s52, v100
  v_add_u32 v105, s52, v101
  ds_read_b64_tr_b16 a[160:161], v104 offset:0
  ds_read_b64_tr_b16 a[162:163], v104 offset:512
  ds_read_b64_tr_b16 a[164:165], v104 offset:32768
  ds_read_b64_tr_b16 a[166:167], v104 offset:33280
  ds_read_b64_tr_b16 a[224:225], v105 offset:0
  ds_read_b64_tr_b16 a[226:227], v105 offset:512
  ds_read_b64_tr_b16 a[228:229], v105 offset:32768
  ds_read_b64_tr_b16 a[230:231], v105 offset:33280
  s_xor_b32 s52, s18, 1
  s_lshl_b32 s52, s52, 10
  s_add_u32 s52, s52, 65536
  v_add_u32 v104, s52, v100
  v_add_u32 v105, s52, v101
  ds_read_b64_tr_b16 a[168:169], v104 offset:0
  ds_read_b64_tr_b16 a[170:171], v104 offset:512
  ds_read_b64_tr_b16 a[172:173], v104 offset:32768
  ds_read_b64_tr_b16 a[174:175], v104 offset:33280
  ds_read_b64_tr_b16 a[232:233], v105 offset:0
  ds_read_b64_tr_b16 a[234:235], v105 offset:512
  ds_read_b64_tr_b16 a[236:237], v105 offset:32768
  ds_read_b64_tr_b16 a[238:239], v105 offset:33280
  s_xor_b32 s52, s18, 2
  s_lshl_b32 s52, s52, 10
  s_add_u32 s52, s52, 65536
  v_add_u32 v104, s52, v100
  v_add_u32 v105, s52, v101
  ds_read_b64_tr_b16 a[176:177], v104 offset:0
  ds_read_b64_tr_b16 a[178:179], v104 offset:512
  ds_read_b64_tr_b16 a[180:181], v104 offset:32768
  ds_read_b64_tr_b16 a[182:183], v104 offset:33280
  ds_read_b64_tr_b16 a[240:241], v105 offset:0
  ds_read_b64_tr_b16 a[242:243], v105 offset:512
  ds_read_b64_tr_b16 a[244:245], v105 offset:32768
  ds_read_b64_tr_b16 a[246:247], v105 offset:33280
  s_xor_b32 s52, s18, 3
  s_lshl_b32 s52, s52, 10
  s_add_u32 s52, s52, 65536
  v_add_u32 v104, s52, v100
  v_add_u32 v105, s52, v101
  ds_read_b64_tr_b16 a[184:185], v104 offset:0
  ds_read_b64_tr_b16 a[186:187], v104 offset:512
  ds_read_b64_tr_b16 a[188:189], v104 offset:32768
  ds_read_b64_tr_b16 a[190:191], v104 offset:33280
  ds_read_b64_tr_b16 a[248:249], v105 offset:0
  ds_read_b64_tr_b16 a[250:251], v105 offset:512
  ds_read_b64_tr_b16 a[252:253], v105 offset:32768
  ds_read_b64_tr_b16 a[254:255], v105 offset:33280
  s_waitcnt lgkmcnt(0)
  s_barrier
  s_add_u32 s52, s8, s54
  s_addc_u32 s53, s9, 0
  s_add_u32 s52, s52, 524288
  s_addc_u32 s53, s53, 0
  s_add_u32 m0, s55, 65536
  s_nop 0
  global_load_lds_dwordx4 v96, s[52:53]
  s_add_u32 s52, s52, 32768
  s_addc_u32 s53, s53, 0
  s_add_u32 m0, s55, 66560
  s_nop 0
  global_load_lds_dwordx4 v96, s[52:53]
  s_add_u32 s52, s52, 32768
  s_addc_u32 s53, s53, 0
  s_add_u32 m0, s55, 67584
  s_nop 0
  global_load_lds_dwordx4 v96, s[52:53]
  s_add_u32 s52, s52, 32768
  s_addc_u32 s53, s53, 0
  s_add_u32 m0, s55, 68608
  s_nop 0
  global_load_lds_dwordx4 v96, s[52:53]
  s_add_u32 s52, s52, 32768
  s_addc_u32 s53, s53, 0
  s_add_u32 m0, s55, 69632
  s_nop 0
  global_load_lds_dwordx4 v97, s[52:53]
  s_add_u32 s52, s52, 32768
  s_addc_u32 s53, s53, 0
  s_add_u32 m0, s55, 70656
  s_nop 0
  global_load_lds_dwordx4 v97, s[52:53]
  s_add_u32 s52, s52, 32768
  s_addc_u32 s53, s53, 0
  s_add_u32 m0, s55, 71680
  s_nop 0
  global_load_lds_dwordx4 v97, s[52:53]
  s_add_u32 s52, s52, 32768
  s_addc_u32 s53, s53, 0
  s_add_u32 m0, s55, 72704
  s_nop 0
  global_load_lds_dwordx4 v97, s[52:53]
  s_add_u32 s52, s52, 32768
  s_addc_u32 s53, s53, 0
  s_add_u32 m0, s55, 73728
  s_nop 0
  global_load_lds_dwordx4 v98, s[52:53]
  s_add_u32 s52, s52, 32768
  s_addc_u32 s53, s53, 0
  s_add_u32 m0, s55, 74752
  s_nop 0
  global_load_lds_dwordx4 v98, s[52:53]
  s_add_u32 s52, s52, 32768
  s_addc_u32 s53, s53, 0
  s_add_u32 m0, s55, 75776
  s_nop 0
  global_load_lds_dwordx4 v98, s[52:53]
  s_add_u32 s52, s52, 32768
  s_addc_u32 s53, s53, 0
  s_add_u32 m0, s55, 76800
  s_nop 0
  global_load_lds_dwordx4 v98, s[52:53]
  s_add_u32 s52, s52, 32768
  s_addc_u32 s53, s53, 0
  s_add_u32 m0, s55, 77824
  s_nop 0
  global_load_lds_dwordx4 v99, s[52:53]
  s_add_u32 s52, s52, 32768
  s_addc_u32 s53, s53, 0
  s_add_u32 m0, s55, 78848
  s_nop 0
  global_load_lds_dwordx4 v99, s[52:53]
  s_add_u32 s52, s52, 32768
  s_addc_u32 s53, s53, 0
  s_add_u32 m0, s55, 79872
  s_nop 0
  global_load_lds_dwordx4 v99, s[52:53]
  s_add_u32 s52, s52, 32768
  s_addc_u32 s53, s53, 0
  s_add_u32 m0, s55, 80896
  s_nop 0
  global_load_lds_dwordx4 v99, s[52:53]
  s_add_u32 s52, s52, 32768
  s_addc_u32 s53, s53, 0
  s_waitcnt vmcnt(16)
  s_barrier
  s_xor_b32 s52, s18, 0
  s_lshl_b32 s52, s52, 10
  s_add_u32 s52, s52, 0
  v_add_u32 v104, s52, v102
  ds_read_b64_tr_b16 v[128:129], v104 offset:0
  ds_read_b64_tr_b16 v[130:131], v104 offset:512
  ds_read_b64_tr_b16 v[132:133], v104 offset:32768
  ds_read_b64_tr_b16 v[134:135], v104 offset:33280
  ds_read_b64_tr_b16 v[192:193], v104 offset:8
  ds_read_b64_tr_b16 v[194:195], v104 offset:520
  ds_read_b64_tr_b16 v[196:197], v104 offset:32776
  ds_read_b64_tr_b16 v[198:199], v104 offset:33288
  s_xor_b32 s52, s18, 1
  s_lshl_b32 s52, s52, 10
  s_add_u32 s52, s52, 0
  v_add_u32 v104, s52, v102
  ds_read_b64_tr_b16 v[136:137], v104 offset:0
  ds_read_b64_tr_b16 v[138:139], v104 offset:512
  ds_read_b64_tr_b16 v[140:141], v104 offset:32768
  ds_read_b64_tr_b16 v[142:143], v104 offset:33280
  ds_read_b64_tr_b16 v[200:201], v104 offset:8
  ds_read_b64_tr_b16 v[202:203], v104 offset:520
  ds_read_b64_tr_b16 v[204:205], v104 offset:32776
  ds_read_b64_tr_b16 v[206:207], v104 offset:33288
  s_xor_b32 s52, s18, 2
  s_lshl_b32 s52, s52, 10
  s_add_u32 s52, s52, 0
  v_add_u32 v104, s52, v102
  ds_read_b64_tr_b16 v[144:145], v104 offset:0
  ds_read_b64_tr_b16 v[146:147], v104 offset:512
  ds_read_b64_tr_b16 v[148:149], v104 offset:32768
  ds_read_b64_tr_b16 v[150:151], v104 offset:33280
  ds_read_b64_tr_b16 v[208:209], v104 offset:8
  ds_read_b64_tr_b16 v[210:211], v104 offset:520
  ds_read_b64_tr_b16 v[212:213], v104 offset:32776
  ds_read_b64_tr_b16 v[214:215], v104 offset:33288
  s_xor_b32 s52, s18, 3
  s_lshl_b32 s52, s52, 10
  s_add_u32 s52, s52, 0
  v_add_u32 v104, s52, v102
  ds_read_b64_tr_b16 v[152:153], v104 offset:0
  ds_read_b64_tr_b16 v[154:155], v104 offset:512
  ds_read_b64_tr_b16 v[156:157], v104 offset:32768
  ds_read_b64_tr_b16 v[158:159], v104 offset:33280
  ds_read_b64_tr_b16 v[216:217], v104 offset:8
  ds_read_b64_tr_b16 v[218:219], v104 offset:520
  ds_read_b64_tr_b16 v[220:221], v104 offset:32776
  ds_read_b64_tr_b16 v[222:223], v104 offset:33288
  s_waitcnt lgkmcnt(0)
  s_barrier
  s_cmp_gt_u32 s18, 1
  s_cbranch_scc1 mega_kernel_wo1
  s_add_u32 s52, s10, 102400
  s_addc_u32 s53, s11, 0
  s_add_u32 m0, s50, 28672
  s_nop 0
  global_load_lds_dwordx4 v23, s[52:53]

  s_add_u32 s52, s10, 110592
  s_addc_u32 s53, s11, 0
  s_add_u32 m0, s50, 29696
  s_nop 0
  global_load_lds_dwordx4 v22, s[52:53]

  s_add_u32 s52, s10, 118784
  s_addc_u32 s53, s11, 0
  s_add_u32 m0, s50, 30720
  s_nop 0
  global_load_lds_dwordx4 v108, s[52:53]

  s_add_u32 s52, s10, 126976
  s_addc_u32 s53, s11, 0
  s_add_u32 m0, s50, 31744
  s_nop 0
  global_load_lds_dwordx4 v109, s[52:53]

  ds_write_b128 v3, v[32:35] offset:8192
  ds_write_b128 v3, v[36:39] offset:9216
  ds_write_b128 v3, v[40:43] offset:10240
  ds_write_b128 v3, v[44:47] offset:11264
  ds_write_b128 v3, v[48:51] offset:12288
  ds_write_b128 v3, v[52:55] offset:13312
  ds_write_b128 v3, v[56:59] offset:14336
  ds_write_b128 v3, v[60:63] offset:15360
  ds_write_b128 v3, v[64:67] offset:16384
  ds_write_b128 v3, v[68:71] offset:17408
  ds_write_b128 v3, v[72:75] offset:18432
  ds_write_b128 v3, v[76:79] offset:19456
  ds_write_b128 v3, v[80:83] offset:20480
  ds_write_b128 v3, v[84:87] offset:21504
  ds_write_b128 v3, v[88:91] offset:22528
  ds_write_b128 v3, v[92:95] offset:23552
  ds_write_b128 v3, v[112:115] offset:24576
  ds_write_b128 v3, v[116:119] offset:25600
  ds_write_b128 v3, v[120:123] offset:26624
  ds_write_b128 v3, v[124:127] offset:27648
mega_kernel_wo1:
  s_cmp_lt_u32 s18, 2
  s_cbranch_scc1 mega_kernel_wo0
  s_waitcnt vmcnt(0)
mega_kernel_wo0:
  s_waitcnt vmcnt(4)
  s_barrier
  s_xor_b32 s52, s18, 0
  s_lshl_b32 s52, s52, 10
  s_add_u32 s52, s52, 65536
  v_add_u32 v104, s52, v102
  ds_read_b64_tr_b16 v[160:161], v104 offset:0
  ds_read_b64_tr_b16 v[162:163], v104 offset:512
  ds_read_b64_tr_b16 v[164:165], v104 offset:32768
  ds_read_b64_tr_b16 v[166:167], v104 offset:33280
  ds_read_b64_tr_b16 v[224:225], v104 offset:8
  ds_read_b64_tr_b16 v[226:227], v104 offset:520
  ds_read_b64_tr_b16 v[228:229], v104 offset:32776
  ds_read_b64_tr_b16 v[230:231], v104 offset:33288
  s_xor_b32 s52, s18, 1
  s_lshl_b32 s52, s52, 10
  s_add_u32 s52, s52, 65536
  v_add_u32 v104, s52, v102
  ds_read_b64_tr_b16 v[168:169], v104 offset:0
  ds_read_b64_tr_b16 v[170:171], v104 offset:512
  ds_read_b64_tr_b16 v[172:173], v104 offset:32768
  ds_read_b64_tr_b16 v[174:175], v104 offset:33280
  ds_read_b64_tr_b16 v[232:233], v104 offset:8
  ds_read_b64_tr_b16 v[234:235], v104 offset:520
  ds_read_b64_tr_b16 v[236:237], v104 offset:32776
  ds_read_b64_tr_b16 v[238:239], v104 offset:33288
  s_xor_b32 s52, s18, 2
  s_lshl_b32 s52, s52, 10
  s_add_u32 s52, s52, 65536
  v_add_u32 v104, s52, v102
  ds_read_b64_tr_b16 v[176:177], v104 offset:0
  ds_read_b64_tr_b16 v[178:179], v104 offset:512
  ds_read_b64_tr_b16 v[180:181], v104 offset:32768
  ds_read_b64_tr_b16 v[182:183], v104 offset:33280
  ds_read_b64_tr_b16 v[240:241], v104 offset:8
  ds_read_b64_tr_b16 v[242:243], v104 offset:520
  ds_read_b64_tr_b16 v[244:245], v104 offset:32776
  ds_read_b64_tr_b16 v[246:247], v104 offset:33288
  s_xor_b32 s52, s18, 3
  s_lshl_b32 s52, s52, 10
  s_add_u32 s52, s52, 65536
  v_add_u32 v104, s52, v102
  ds_read_b64_tr_b16 v[184:185], v104 offset:0
  ds_read_b64_tr_b16 v[186:187], v104 offset:512
  ds_read_b64_tr_b16 v[188:189], v104 offset:32768
  ds_read_b64_tr_b16 v[190:191], v104 offset:33280
  ds_read_b64_tr_b16 v[248:249], v104 offset:8
  ds_read_b64_tr_b16 v[250:251], v104 offset:520
  ds_read_b64_tr_b16 v[252:253], v104 offset:32776
  ds_read_b64_tr_b16 v[254:255], v104 offset:33288
  s_waitcnt lgkmcnt(0)
  s_barrier
  s_cmp_lt_u32 s18, 2
  s_cbranch_scc1 mega_kernel_wo2
  s_add_u32 s52, s10, 102400
  s_addc_u32 s53, s11, 0
  s_add_u32 m0, s50, 28672
  s_nop 0
  global_load_lds_dwordx4 v23, s[52:53]

  s_add_u32 s52, s10, 110592
  s_addc_u32 s53, s11, 0
  s_add_u32 m0, s50, 29696
  s_nop 0
  global_load_lds_dwordx4 v22, s[52:53]

  s_add_u32 s52, s10, 118784
  s_addc_u32 s53, s11, 0
  s_add_u32 m0, s50, 30720
  s_nop 0
  global_load_lds_dwordx4 v108, s[52:53]

  s_add_u32 s52, s10, 126976
  s_addc_u32 s53, s11, 0
  s_add_u32 m0, s50, 31744
  s_nop 0
  global_load_lds_dwordx4 v109, s[52:53]

  ds_write_b128 v3, v[32:35] offset:8192
  ds_write_b128 v3, v[36:39] offset:9216
  ds_write_b128 v3, v[40:43] offset:10240
  ds_write_b128 v3, v[44:47] offset:11264
  ds_write_b128 v3, v[48:51] offset:12288
  ds_write_b128 v3, v[52:55] offset:13312
  ds_write_b128 v3, v[56:59] offset:14336
  ds_write_b128 v3, v[60:63] offset:15360
  ds_write_b128 v3, v[64:67] offset:16384
  ds_write_b128 v3, v[68:71] offset:17408
  ds_write_b128 v3, v[72:75] offset:18432
  ds_write_b128 v3, v[76:79] offset:19456
  ds_write_b128 v3, v[80:83] offset:20480
  ds_write_b128 v3, v[84:87] offset:21504
  ds_write_b128 v3, v[88:91] offset:22528
  ds_write_b128 v3, v[92:95] offset:23552
  ds_write_b128 v3, v[112:115] offset:24576
  ds_write_b128 v3, v[116:119] offset:25600
  ds_write_b128 v3, v[120:123] offset:26624
  ds_write_b128 v3, v[124:127] offset:27648
mega_kernel_wo2:
  s_waitcnt vmcnt(4) lgkmcnt(0)
  v_xor_b32 v104, 0, v25
  v_xor_b32 v105, 0, v24
  ds_read_b64_tr_b16 v[32:33], v105 offset:0
  ds_read_b64_tr_b16 v[34:35], v105 offset:512
  ds_read_b64_tr_b16 v[36:37], v104 offset:8192
  ds_read_b64_tr_b16 v[38:39], v104 offset:8704
  v_xor_b32 v104, 32, v25
  v_xor_b32 v105, 32, v24
  ds_read_b64_tr_b16 v[40:41], v105 offset:0
  ds_read_b64_tr_b16 v[42:43], v105 offset:512
  ds_read_b64_tr_b16 v[44:45], v104 offset:8192
  ds_read_b64_tr_b16 v[46:47], v104 offset:8704
  v_xor_b32 v104, 64, v25
  v_xor_b32 v105, 64, v24
  ds_read_b64_tr_b16 v[48:49], v105 offset:0
  ds_read_b64_tr_b16 v[50:51], v105 offset:512
  ds_read_b64_tr_b16 v[52:53], v104 offset:8192
  ds_read_b64_tr_b16 v[54:55], v104 offset:8704
  v_xor_b32 v104, 96, v25
  v_xor_b32 v105, 96, v24
  ds_read_b64_tr_b16 v[56:57], v105 offset:0
  ds_read_b64_tr_b16 v[58:59], v105 offset:512
  ds_read_b64_tr_b16 v[60:61], v104 offset:8192
  ds_read_b64_tr_b16 v[62:63], v104 offset:8704
  v_xor_b32 v104, 128, v25
  v_xor_b32 v105, 128, v24
  ds_read_b64_tr_b16 v[64:65], v105 offset:0
  ds_read_b64_tr_b16 v[66:67], v105 offset:512
  ds_read_b64_tr_b16 v[68:69], v104 offset:8192
  ds_read_b64_tr_b16 v[70:71], v104 offset:8704
  v_xor_b32 v104, 160, v25
  v_xor_b32 v105, 160, v24
  ds_read_b64_tr_b16 v[72:73], v105 offset:0
  ds_read_b64_tr_b16 v[74:75], v105 offset:512
  ds_read_b64_tr_b16 v[76:77], v104 offset:8192
  ds_read_b64_tr_b16 v[78:79], v104 offset:8704
  v_xor_b32 v104, 192, v25
  v_xor_b32 v105, 192, v24
  ds_read_b64_tr_b16 v[80:81], v105 offset:0
  ds_read_b64_tr_b16 v[82:83], v105 offset:512
  ds_read_b64_tr_b16 v[84:85], v104 offset:8192
  ds_read_b64_tr_b16 v[86:87], v104 offset:8704
  v_xor_b32 v104, 224, v25
  v_xor_b32 v105, 224, v24
  ds_read_b64_tr_b16 v[88:89], v105 offset:0
  ds_read_b64_tr_b16 v[90:91], v105 offset:512
  ds_read_b64_tr_b16 v[92:93], v104 offset:8192
  ds_read_b64_tr_b16 v[94:95], v104 offset:8704
  s_waitcnt lgkmcnt(0)
  ds_write_b128 v3, v[32:35] offset:0
  ds_write_b128 v3, v[36:39] offset:1024
  ds_write_b128 v3, v[40:43] offset:2048
  ds_write_b128 v3, v[44:47] offset:3072
  ds_write_b128 v3, v[48:51] offset:4096
  ds_write_b128 v3, v[52:55] offset:5120
  ds_write_b128 v3, v[56:59] offset:6144
  ds_write_b128 v3, v[60:63] offset:7168
  ds_write_b128 v3, v[64:67] offset:8192
  ds_write_b128 v3, v[68:71] offset:9216
  ds_write_b128 v3, v[72:75] offset:10240
  ds_write_b128 v3, v[76:79] offset:11264
  ds_write_b128 v3, a[8:11] offset:12288
  ds_write_b128 v3, a[12:15] offset:13312
  ds_write_b128 v3, a[40:43] offset:14336
  ds_write_b128 v3, a[44:47] offset:15360
  s_waitcnt lgkmcnt(0)
  v_accvgpr_write_b32 a8, v80
  v_accvgpr_write_b32 a9, v81
  v_accvgpr_write_b32 a10, v82
  v_accvgpr_write_b32 a11, v83
  v_accvgpr_write_b32 a12, v84
  v_accvgpr_write_b32 a13, v85
  v_accvgpr_write_b32 a14, v86
  v_accvgpr_write_b32 a15, v87
  v_accvgpr_write_b32 a40, v88
  v_accvgpr_write_b32 a41, v89
  v_accvgpr_write_b32 a42, v90
  v_accvgpr_write_b32 a43, v91
  v_accvgpr_write_b32 a44, v92
  v_accvgpr_write_b32 a45, v93
  v_accvgpr_write_b32 a46, v94
  v_accvgpr_write_b32 a47, v95
  s_waitcnt vmcnt(0) lgkmcnt(0)
  v_xor_b32 v104, 0, v25
  v_xor_b32 v105, 0, v24
  ds_read_b64_tr_b16 v[32:33], v104 offset:16384
  ds_read_b64_tr_b16 v[34:35], v104 offset:16896
  ds_read_b64_tr_b16 v[36:37], v104 offset:24576
  ds_read_b64_tr_b16 v[38:39], v104 offset:25088
  v_xor_b32 v104, 32, v25
  v_xor_b32 v105, 32, v24
  ds_read_b64_tr_b16 v[40:41], v104 offset:16384
  ds_read_b64_tr_b16 v[42:43], v104 offset:16896
  ds_read_b64_tr_b16 v[44:45], v104 offset:24576
  ds_read_b64_tr_b16 v[46:47], v104 offset:25088
  v_xor_b32 v104, 64, v25
  v_xor_b32 v105, 64, v24
  ds_read_b64_tr_b16 v[48:49], v104 offset:16384
  ds_read_b64_tr_b16 v[50:51], v104 offset:16896
  ds_read_b64_tr_b16 v[52:53], v104 offset:24576
  ds_read_b64_tr_b16 v[54:55], v104 offset:25088
  v_xor_b32 v104, 96, v25
  v_xor_b32 v105, 96, v24
  ds_read_b64_tr_b16 v[56:57], v104 offset:16384
  ds_read_b64_tr_b16 v[58:59], v104 offset:16896
  ds_read_b64_tr_b16 v[60:61], v104 offset:24576
  ds_read_b64_tr_b16 v[62:63], v104 offset:25088
  v_xor_b32 v104, 128, v25
  v_xor_b32 v105, 128, v24
  ds_read_b64_tr_b16 v[64:65], v104 offset:16384
  ds_read_b64_tr_b16 v[66:67], v104 offset:16896
  ds_read_b64_tr_b16 v[68:69], v104 offset:24576
  ds_read_b64_tr_b16 v[70:71], v104 offset:25088
  v_xor_b32 v104, 160, v25
  v_xor_b32 v105, 160, v24
  ds_read_b64_tr_b16 v[72:73], v104 offset:16384
  ds_read_b64_tr_b16 v[74:75], v104 offset:16896
  ds_read_b64_tr_b16 v[76:77], v104 offset:24576
  ds_read_b64_tr_b16 v[78:79], v104 offset:25088
  v_xor_b32 v104, 192, v25
  v_xor_b32 v105, 192, v24
  ds_read_b64_tr_b16 v[80:81], v104 offset:16384
  ds_read_b64_tr_b16 v[82:83], v104 offset:16896
  ds_read_b64_tr_b16 v[84:85], v104 offset:24576
  ds_read_b64_tr_b16 v[86:87], v104 offset:25088
  v_xor_b32 v104, 224, v25
  v_xor_b32 v105, 224, v24
  ds_read_b64_tr_b16 v[88:89], v104 offset:16384
  ds_read_b64_tr_b16 v[90:91], v104 offset:16896
  ds_read_b64_tr_b16 v[92:93], v104 offset:24576
  ds_read_b64_tr_b16 v[94:95], v104 offset:25088
  s_waitcnt lgkmcnt(0)
  ds_write_b128 v3, v[32:35] offset:16384
  ds_write_b128 v3, v[36:39] offset:17408
  ds_write_b128 v3, v[40:43] offset:18432
  ds_write_b128 v3, v[44:47] offset:19456
  ds_write_b128 v3, v[48:51] offset:20480
  ds_write_b128 v3, v[52:55] offset:21504
  ds_write_b128 v3, v[56:59] offset:22528
  ds_write_b128 v3, v[60:63] offset:23552
  ds_write_b128 v3, v[64:67] offset:24576
  ds_write_b128 v3, v[68:71] offset:25600
  ds_write_b128 v3, v[72:75] offset:26624
  ds_write_b128 v3, v[76:79] offset:27648
  ds_write_b128 v3, a[72:75] offset:28672
  ds_write_b128 v3, a[76:79] offset:29696
  ds_write_b128 v3, a[104:107] offset:30720
  ds_write_b128 v3, a[108:111] offset:31744
  s_waitcnt lgkmcnt(0)
  v_accvgpr_write_b32 a72, v80
  v_accvgpr_write_b32 a73, v81
  v_accvgpr_write_b32 a74, v82
  v_accvgpr_write_b32 a75, v83
  v_accvgpr_write_b32 a76, v84
  v_accvgpr_write_b32 a77, v85
  v_accvgpr_write_b32 a78, v86
  v_accvgpr_write_b32 a79, v87
  v_accvgpr_write_b32 a104, v88
  v_accvgpr_write_b32 a105, v89
  v_accvgpr_write_b32 a106, v90
  v_accvgpr_write_b32 a107, v91
  v_accvgpr_write_b32 a108, v92
  v_accvgpr_write_b32 a109, v93
  v_accvgpr_write_b32 a110, v94
  v_accvgpr_write_b32 a111, v95
  s_cmp_eq_u32 s18, 0
  s_cbranch_scc0 mega_kernel_kvok
  v_and_b32 v116, 1, v0
  v_lshlrev_b32 v118, 6, v116
  v_add_u32 v118, 32, v118
  v_mov_b32 v119, 128
  v_mov_b32 v120, 32
  v_cmp_eq_u32 vcc, 1, v116
  s_mov_b32 s60, 0
  v_cndmask_b32 v119, v119, v120, vcc
mega_kernel_tbw:
  global_load_dword v117, v118, s[58:59] sc1
  s_add_u32 s60, s60, 1
  s_cmp_gt_u32 s60, 50000000
  s_cbranch_scc1 mega_kernel_fail
  s_waitcnt vmcnt(0)
  v_cmp_lt_u32 vcc, v117, v119
  s_cbranch_vccnz mega_kernel_tbw

  s_add_u32 s72, s12, 66125824
  s_addc_u32 s73, s13, 0
  s_lshr_b32 s52, s17, 1
  s_lshl_b32 s52, s52, 6
  s_add_u32 s52, s52, 6400
  v_mov_b32 v116, s52
  s_mov_b32 s60, 0
mega_kernel_kvw:
  global_load_dword v117, v116, s[72:73] sc1
  s_add_u32 s60, s60, 1
  s_cmp_gt_u32 s60, 50000000
  s_cbranch_scc1 mega_kernel_fail
  s_waitcnt vmcnt(0)
  v_readfirstlane_b32 s52, v117
  s_nop 3
  s_cmp_ge_u32 s52, 14
  s_cbranch_scc1 mega_kernel_kvok
  s_sleep 4
  s_branch mega_kernel_kvw
mega_kernel_kvok:
  s_barrier

  s_lshl_b32 s52, s17, 7
  s_add_u32 s52, s52, 66127872
  s_add_u32 s34, s12, s52
  s_addc_u32 s35, s13, 0

  s_mov_b32 m0, s68
  s_nop 0
  global_load_lds_dwordx4 v2, s[28:29] sc1
  global_load_lds_dwordx4 v2, s[28:29] offset:1024 sc1
  s_add_u32 s28, s28, 8192
  s_addc_u32 s29, s29, 0
  s_mov_b32 m0, s69
  s_nop 0
  global_load_lds_dwordx4 v2, s[30:31] sc1
  global_load_lds_dwordx4 v2, s[30:31] offset:1024 sc1
  s_add_u32 s30, s30, 8192
  s_addc_u32 s31, s31, 0
  s_lshl_b32 s51, s18, 10
  v_add_u32 v9, s51, v2
  s_mov_b32 s44, s51
  s_add_u32 s45, s51, 4096
  s_mov_b32 s70, 0
  s_mov_b32 s19, -1
  s_and_b32 s50, s17, 1
  s_lshl_b32 s36, s50, 17
  s_xor_b32 s37, s36, 0x20000
  s_add_u32 s37, s37, 4096
  s_lshl_b32 s40, s17, 13
  s_add_u32 s41, s40, 4096
  s_mov_b32 s47, 0
  s_mov_b32 s48, 16384
  s_xor_b32 s36, s36, 0x40000
  s_xor_b32 s37, s37, 0x40000
  s_xor_b32 s40, s40, 0x40000
  s_xor_b32 s41, s41, 0x40000
  s_mov_b32 s61, 0

  v_xor_b32 v0, 0x80, v5
  s_branch mega_kernel_loop
  .p2align 6
  s_nop 0
mega_kernel_loop:
  s_cmp_eq_u32 s18, 1
  s_cbranch_scc0 mega_kernel_kd
  s_mov_b32 s52, 1280
  s_cmp_eq_u32 s19, 18
  s_cbranch_scc1 mega_kernel_kd0
  s_mov_b32 s52, 1664
  s_cmp_eq_u32 s19, 4
  s_cbranch_scc0 mega_kernel_kd
mega_kernel_kd0:
  s_add_u32 s50, s12, 66125824
  s_addc_u32 s51, s13, 0
  v_mov_b32 v20, s52
  s_mov_b32 s60, 0
mega_kernel_kdw:
  global_load_dword v21, v20, s[50:51] sc1
  s_add_u32 s60, s60, 1
  s_cmp_gt_u32 s60, 50000000
  s_cbranch_scc1 mega_kernel_fail
  s_waitcnt vmcnt(0)
  v_readfirstlane_b32 s52, v21
  s_nop 3
  s_cmp_ge_u32 s52, 224
  s_cbranch_scc0 mega_kernel_kdw
mega_kernel_kd:

  s_barrier
  buffer_load_dwordx4 v[108:111], v2, s[24:27], s44 offen sc1
  buffer_load_dwordx4 v[112:115], v2, s[24:27], s45 offen sc1
  s_add_u32 s19, s19, 1
  s_lshr_b32 s50, s19, 1
  s_and_b32 s70, s50, 1
  s_xor_b32 s36, s36, 0x40000
  s_xor_b32 s40, s40, 0x40000
  s_xor_b32 s37, s37, 0x40000
  s_xor_b32 s41, s41, 0x40000
  s_add_u32 s47, s47, 8192
  s_and_b32 s47, s47, 0x7fff
  s_add_u32 s48, s48, 8192
  s_and_b32 s48, s48, 0x7fff
  v_mov_b32 v52, 0
  v_mov_b32 v53, 0
  v_mov_b32 v54, 0
  v_mov_b32 v55, 0
  v_mov_b32 v56, 0
  v_mov_b32 v57, 0
  v_mov_b32 v58, 0
  v_mov_b32 v59, 0
  v_mov_b32 v60, 0
  v_mov_b32 v61, 0
  v_mov_b32 v62, 0
  v_mov_b32 v63, 0
  v_mov_b32 v64, 0
  v_mov_b32 v65, 0
  v_mov_b32 v66, 0
  v_mov_b32 v67, 0
  v_mov_b32 v68, 0
  v_mov_b32 v69, 0
  v_mov_b32 v70, 0
  v_mov_b32 v71, 0
  v_mov_b32 v72, 0
  v_mov_b32 v73, 0
  v_mov_b32 v74, 0
  v_mov_b32 v75, 0
  buffer_load_dwordx4 v[116:119], v2, s[24:27], s44 offen sc1
  buffer_load_dwordx4 v[120:123], v2, s[24:27], s45 offen sc1
  v_add_u32 v127, s69, v2
  v_xor_b32 v124, 1024, v9
  v_xor_b32 v125, 2048, v9
  v_xor_b32 v126, 3072, v9
  s_mov_b32 s60, 0
  s_waitcnt vmcnt(6)
  ds_read_b128 v[76:79], v3 offset:12288
  ds_read_b128 v[80:83], v3 offset:13312
  ds_read_b128 v[84:87], v3 offset:28672
  ds_read_b128 v[88:91], v3 offset:29696
  ds_read_b128 v[92:95], v3 offset:14336
  ds_read_b128 v[96:99], v3 offset:15360
  ds_read_b128 v[100:103], v3 offset:30720
  ds_read_b128 v[104:107], v3 offset:31744
mega_kernel_gpoll:
  s_waitcnt vmcnt(2)
  v_max3_u32 v36, v108, v109, v110
  v_max3_u32 v37, v111, v112, v113
  v_max3_u32 v36, v36, v114, v115
  v_max_u32 v36, v36, v37
  v_cmp_eq_u32 vcc, -1, v36
  s_cbranch_vccz mega_kernel_gotA

  buffer_load_dwordx4 v[108:111], v2, s[24:27], s44 offen sc1
  buffer_load_dwordx4 v[112:115], v2, s[24:27], s45 offen sc1
  s_waitcnt vmcnt(2)
  v_max3_u32 v36, v116, v117, v118
  v_max3_u32 v37, v119, v120, v121
  v_max3_u32 v36, v36, v122, v123
  v_max_u32 v36, v36, v37
  v_cmp_eq_u32 vcc, -1, v36
  s_cbranch_vccz mega_kernel_gotB

  buffer_load_dwordx4 v[116:119], v2, s[24:27], s44 offen sc1
  buffer_load_dwordx4 v[120:123], v2, s[24:27], s45 offen sc1
  s_add_u32 s60, s60, 1
  s_cmp_gt_u32 s60, 50000000
  s_cbranch_scc1 mega_kernel_fail
  s_branch mega_kernel_gpoll

mega_kernel_gotB:
  ds_write_b128 v9, v[116:119]
  ds_write_b128 v9, v[120:123] offset:4096
  v_smfmac_f32_16x16x64_bf16 v[52:55], v[116:119], a[0:7], v1
  v_smfmac_f32_16x16x64_bf16 v[52:55], v[120:123], a[32:39], v1
  v_smfmac_f32_16x16x64_bf16 v[56:59], v[116:119], a[64:71], v1
  v_smfmac_f32_16x16x64_bf16 v[56:59], v[120:123], a[96:103], v1
  s_waitcnt lgkmcnt(0)
  s_barrier
  ds_read_b128 v[24:27], v124 offset:0
  ds_read_b128 v[40:43], v124 offset:4096
  ds_read_b128 v[28:31], v125 offset:0
  ds_read_b128 v[44:47], v125 offset:4096
  ds_read_b128 v[32:35], v126 offset:0
  ds_read_b128 v[48:51], v126 offset:4096
  v_smfmac_f32_16x16x64_bf16 v[60:63], v[116:119], a[128:135], v1
  v_smfmac_f32_16x16x64_bf16 v[60:63], v[120:123], a[160:167], v1
  v_smfmac_f32_16x16x64_bf16 v[64:67], v[116:119], a[192:199], v1
  v_smfmac_f32_16x16x64_bf16 v[64:67], v[120:123], a[224:231], v1
  s_branch mega_kernel_gdone
mega_kernel_gotA:
  ds_write_b128 v9, v[108:111]
  ds_write_b128 v9, v[112:115] offset:4096
  v_smfmac_f32_16x16x64_bf16 v[52:55], v[108:111], a[0:7], v1
  v_smfmac_f32_16x16x64_bf16 v[52:55], v[112:115], a[32:39], v1
  v_smfmac_f32_16x16x64_bf16 v[56:59], v[108:111], a[64:71], v1
  v_smfmac_f32_16x16x64_bf16 v[56:59], v[112:115], a[96:103], v1
  s_waitcnt lgkmcnt(0)
  s_barrier
  ds_read_b128 v[24:27], v124 offset:0
  ds_read_b128 v[40:43], v124 offset:4096
  ds_read_b128 v[28:31], v125 offset:0
  ds_read_b128 v[44:47], v125 offset:4096
  ds_read_b128 v[32:35], v126 offset:0
  ds_read_b128 v[48:51], v126 offset:4096
  v_smfmac_f32_16x16x64_bf16 v[60:63], v[108:111], a[128:135], v1
  v_smfmac_f32_16x16x64_bf16 v[60:63], v[112:115], a[160:167], v1
  v_smfmac_f32_16x16x64_bf16 v[64:67], v[108:111], a[192:199], v1
  v_smfmac_f32_16x16x64_bf16 v[64:67], v[112:115], a[224:231], v1
mega_kernel_gdone:
  s_mov_b32 s61, s60
  s_add_u32 s44, s44, 8192
  s_and_b32 s44, s44, 0x7fff
  s_add_u32 s45, s45, 8192
  s_and_b32 s45, s45, 0x7fff
  s_waitcnt lgkmcnt(5)
  v_smfmac_f32_16x16x64_bf16 v[52:55], v[24:27], v[76:83], v1
  v_smfmac_f32_16x16x64_bf16 v[56:59], v[24:27], v[84:91], v1
  s_waitcnt lgkmcnt(4)
  v_smfmac_f32_16x16x64_bf16 v[52:55], v[40:43], v[92:99], v1
  ds_read_b128 v[76:79], v2 offset:8192
  v_smfmac_f32_16x16x64_bf16 v[56:59], v[40:43], v[100:107], v1
  ds_read_b128 v[80:83], v2 offset:9216
  s_waitcnt lgkmcnt(5)
  v_smfmac_f32_16x16x64_bf16 v[52:55], v[28:31], a[16:23], v1
  ds_read_b128 v[84:87], v2 offset:10240
  v_smfmac_f32_16x16x64_bf16 v[56:59], v[28:31], a[80:87], v1
  ds_read_b128 v[88:91], v2 offset:11264
  s_waitcnt lgkmcnt(6)
  v_smfmac_f32_16x16x64_bf16 v[52:55], v[44:47], a[48:55], v1
  ds_read_b128 v[92:95], v2 offset:12288
  v_smfmac_f32_16x16x64_bf16 v[56:59], v[44:47], a[112:119], v1
  ds_read_b128 v[96:99], v2 offset:13312
  s_waitcnt lgkmcnt(7)
  v_smfmac_f32_16x16x64_bf16 v[52:55], v[32:35], a[24:31], v1
  ds_read_b128 v[100:103], v2 offset:14336
  v_smfmac_f32_16x16x64_bf16 v[56:59], v[32:35], a[88:95], v1
  ds_read_b128 v[104:107], v2 offset:15360
  s_waitcnt lgkmcnt(8)
  v_smfmac_f32_16x16x64_bf16 v[52:55], v[48:51], a[56:63], v1
  ds_read_b128 v[20:23], v9
  v_smfmac_f32_16x16x64_bf16 v[56:59], v[48:51], a[120:127], v1
  ds_read_b128 v[36:39], v9 offset:4096
  v_smfmac_f32_16x16x64_bf16 v[60:63], v[24:27], a[136:143], v1
  v_smfmac_f32_16x16x64_bf16 v[64:67], v[24:27], a[200:207], v1
  v_smfmac_f32_16x16x64_bf16 v[60:63], v[40:43], a[168:175], v1
  s_waitcnt vmcnt(0)
  ds_read_b128 v[120:123], v127
  ds_read_b128 v[124:127], v127 offset:1024
  v_smfmac_f32_16x16x64_bf16 v[64:67], v[40:43], a[232:239], v1
  v_add_f32 v52, v52, v54
  v_add_f32 v53, v53, v55
  v_smfmac_f32_16x16x64_bf16 v[60:63], v[28:31], a[144:151], v1
  v_add_f32 v56, v56, v58
  v_add_f32 v57, v57, v59
  v_smfmac_f32_16x16x64_bf16 v[64:67], v[28:31], a[208:215], v1
  v_cvt_pk_bf16_f32 v114, v52, v53
  v_smfmac_f32_16x16x64_bf16 v[60:63], v[44:47], a[176:183], v1
  v_cvt_pk_bf16_f32 v115, v56, v57
  v_smfmac_f32_16x16x64_bf16 v[64:67], v[44:47], a[240:247], v1
  ds_write2_b32 v4, v114, v114 offset0:0 offset1:1
  v_smfmac_f32_16x16x64_bf16 v[60:63], v[32:35], a[152:159], v1
  ds_write2_b32 v4, v115, v115 offset0:128 offset1:129
  v_smfmac_f32_16x16x64_bf16 v[64:67], v[32:35], a[216:223], v1
  v_smfmac_f32_16x16x64_bf16 v[60:63], v[48:51], a[184:191], v1
  v_smfmac_f32_16x16x64_bf16 v[64:67], v[48:51], a[248:255], v1
  v_add_u32 v114, 4096, v4
  v_smfmac_f32_16x16x64_bf16 v[68:71], v[24:27], v[136:143], v1
  v_smfmac_f32_16x16x64_bf16 v[72:75], v[24:27], v[200:207], v1
  v_smfmac_f32_16x16x64_bf16 v[68:71], v[28:31], v[144:151], v1
  v_add_f32 v60, v60, v62
  v_add_f32 v61, v61, v63
  v_add_f32 v64, v64, v66
  v_add_f32 v65, v65, v67
  v_smfmac_f32_16x16x64_bf16 v[72:75], v[28:31], v[208:215], v1
  v_cvt_pk_bf16_f32 v108, v60, v61
  v_cvt_pk_bf16_f32 v109, v64, v65
  ds_write2_b32 v114, v108, v109 offset0:0 offset1:128
  v_smfmac_f32_16x16x64_bf16 v[68:71], v[32:35], v[152:159], v1
  v_smfmac_f32_16x16x64_bf16 v[72:75], v[32:35], v[216:223], v1
  s_waitcnt lgkmcnt(1)
  v_smfmac_f32_16x16x64_bf16 v[68:71], v[20:23], v[128:135], v1
  v_smfmac_f32_16x16x64_bf16 v[72:75], v[20:23], v[192:199], v1
  s_waitcnt lgkmcnt(0)
  s_barrier
  v_smfmac_f32_16x16x64_bf16 v[68:71], v[40:43], v[168:175], v1
  ds_read_b64_tr_b16 v[52:53], v5 offset:0
  ds_read_b64_tr_b16 v[54:55], v0 offset:0
  ds_read_b64_tr_b16 v[56:57], v5 offset:1024
  v_smfmac_f32_16x16x64_bf16 v[72:75], v[40:43], v[232:239], v1
  ds_read_b64_tr_b16 v[58:59], v0 offset:1024
  ds_read_b64_tr_b16 v[60:61], v5 offset:2048
  ds_read_b64_tr_b16 v[62:63], v0 offset:2048
  v_smfmac_f32_16x16x64_bf16 v[68:71], v[44:47], v[176:183], v1
  ds_read_b64_tr_b16 v[64:65], v5 offset:3072
  ds_read_b64_tr_b16 v[66:67], v0 offset:3072
  ds_read_b64_tr_b16 v[20:21], v5 offset:4096
  v_smfmac_f32_16x16x64_bf16 v[72:75], v[44:47], v[240:247], v1
  ds_read_b64_tr_b16 v[22:23], v0 offset:4096
  ds_read_b64_tr_b16 v[24:25], v5 offset:5120
  ds_read_b64_tr_b16 v[26:27], v0 offset:5120
  v_smfmac_f32_16x16x64_bf16 v[68:71], v[48:51], v[184:191], v1
  ds_read_b64_tr_b16 v[28:29], v5 offset:6144
  ds_read_b64_tr_b16 v[30:31], v0 offset:6144
  ds_read_b64_tr_b16 v[32:33], v5 offset:7168
  v_smfmac_f32_16x16x64_bf16 v[72:75], v[48:51], v[248:255], v1
  ds_read_b64_tr_b16 v[34:35], v0 offset:7168
  v_smfmac_f32_16x16x64_bf16 v[68:71], v[36:39], v[160:167], v1
  v_smfmac_f32_16x16x64_bf16 v[72:75], v[36:39], v[224:231], v1
  s_waitcnt lgkmcnt(14)
  v_mfma_f32_16x16x32_bf16 v[36:39], v[76:79], v[52:55], 0
  s_waitcnt lgkmcnt(12)
  v_mfma_f32_16x16x32_bf16 v[36:39], v[80:83], v[56:59], v[36:39]
  s_waitcnt lgkmcnt(10)
  v_mfma_f32_16x16x32_bf16 v[36:39], v[84:87], v[60:63], v[36:39]
  v_add_f32 v68, v68, v70
  v_add_f32 v69, v69, v71
  v_add_f32 v72, v72, v74
  v_add_f32 v73, v73, v75
  s_waitcnt lgkmcnt(8)
  v_mfma_f32_16x16x32_bf16 v[36:39], v[88:91], v[64:67], v[36:39]
  v_cvt_pk_bf16_f32 v110, v68, v69
  v_cvt_pk_bf16_f32 v111, v72, v73
  v_mfma_f32_16x16x32_bf16 v[40:43], v[92:95], v[52:55], 0
  v_cvt_pk_bf16_f32 v112, v72, v73
  v_mov_b32 v113, 0
  global_store_dwordx4 v2, v[108:111], s[32:33] sc1
  s_add_u32 s32, s32, 131072
  s_addc_u32 s33, s33, 0
  s_cmp_eq_u32 s19, 63
  s_cbranch_scc1 mega_kernel_fin
  v_mfma_f32_16x16x32_bf16 v[40:43], v[96:99], v[56:59], v[40:43]
  s_mov_b32 m0, s68
  s_nop 0
  global_load_lds_dwordx4 v2, s[28:29] sc1
  v_mfma_f32_16x16x32_bf16 v[40:43], v[100:103], v[60:63], v[40:43]
  global_load_lds_dwordx4 v2, s[28:29] offset:1024 sc1
  s_add_u32 s28, s28, 8192
  s_addc_u32 s29, s29, 0
  v_mfma_f32_16x16x32_bf16 v[40:43], v[104:107], v[64:67], v[40:43]
  s_mov_b32 m0, s69
  s_nop 0
  global_load_lds_dwordx4 v2, s[30:31] sc1
  s_waitcnt lgkmcnt(0)
  v_mfma_f32_16x16x32_bf16 v[44:47], v[20:23], v[52:55], 0
  global_load_lds_dwordx4 v2, s[30:31] offset:1024 sc1
  s_add_u32 s30, s30, 8192
  s_addc_u32 s31, s31, 0
  s_cmp_eq_u32 s18, 3
  s_cbranch_scc0 mega_kernel_nf
  v_mov_b32 v114, s19
  global_store_dword v11, v114, s[34:35] sc1
mega_kernel_nf:
  ds_read_b128 v[76:79], v3 offset:0
  ds_read_b128 v[80:83], v3 offset:1024
  v_mfma_f32_16x16x32_bf16 v[44:47], v[24:27], v[56:59], v[44:47]
  ds_read_b128 v[84:87], v3 offset:16384
  ds_read_b128 v[88:91], v3 offset:17408
  v_max3_f32 v48, v36, v37, v38
  v_mfma_f32_16x16x32_bf16 v[44:47], v[28:31], v[60:63], v[44:47]
  ds_read_b128 v[92:95], v3 offset:2048
  ds_read_b128 v[96:99], v3 offset:3072
  v_max3_f32 v49, v39, v40, v41
  v_mfma_f32_16x16x32_bf16 v[44:47], v[32:35], v[64:67], v[44:47]
  ds_read_b128 v[100:103], v3 offset:18432
  ds_read_b128 v[104:107], v3 offset:19456
  v_max3_f32 v48, v48, v42, v43
  v_max_f32 v48, v48, v49
  ds_read_b128 v[68:71], v3 offset:6144
  ds_read_b128 v[72:75], v3 offset:7168
  s_nop 1
  v_max3_f32 v48, v48, v44, v45
  v_mov_b32 v49, v48

  ds_read_b128 v[52:55], v3 offset:4096
  ds_read_b128 v[56:59], v3 offset:5120
  v_permlane32_swap_b32 v48, v49
  v_max_f32 v48, v48, v49
  v_mov_b32 v49, v48

  ds_read_b128 v[60:63], v3 offset:20480
  ds_read_b128 v[64:67], v3 offset:21504
  v_permlane16_swap_b32 v48, v49
  v_max_f32 v48, v48, v49
  v_mul_f32 v48, s49, v48
  v_fma_f32 v44, v44, s49, -v48
  v_fma_f32 v45, v45, s49, -v48
  v_exp_f32 v44, v44
  v_exp_f32 v45, v45

  v_fma_f32 v36, v36, s49, -v48
  v_fma_f32 v37, v37, s49, -v48
  v_fma_f32 v38, v38, s49, -v48
  v_fma_f32 v39, v39, s49, -v48
  v_cvt_pk_bf16_f32 v10, v44, v45
  v_fma_f32 v40, v40, s49, -v48
  v_fma_f32 v41, v41, s49, -v48
  v_fma_f32 v42, v42, s49, -v48
  v_fma_f32 v43, v43, s49, -v48
  v_mfma_f32_16x16x16_bf16 v[20:23], v[110:111], v[10:11], 0
  v_exp_f32 v36, v36
  v_exp_f32 v37, v37
  v_mfma_f32_16x16x16_bf16 v[24:27], v[112:113], v[10:11], 0
  v_exp_f32 v38, v38
  v_exp_f32 v39, v39
  v_mfma_f32_16x16x16_bf16 v[28:31], v[12:13], v[10:11], 0
  v_exp_f32 v40, v40
  v_cvt_pk_bf16_f32 v116, v36, v37
  v_exp_f32 v41, v41
  v_cvt_pk_bf16_f32 v117, v38, v39
  v_exp_f32 v42, v42
  v_exp_f32 v43, v43
  v_cvt_pk_bf16_f32 v118, v40, v41
  v_cvt_pk_bf16_f32 v119, v42, v43
  s_nop 0
  s_nop 0
  v_mfma_f32_16x16x32_bf16 v[28:31], v[12:15], v[116:119], v[28:31]
  v_mfma_f32_16x16x32_bf16 v[20:23], v[120:123], v[116:119], v[20:23]
  v_mfma_f32_16x16x32_bf16 v[24:27], v[124:127], v[116:119], v[24:27]

  v_mov_b32 v36, 0
  v_mov_b32 v37, 0
  v_mov_b32 v38, 0
  v_mov_b32 v39, 0
  v_mov_b32 v40, 0
  v_mov_b32 v41, 0
  v_rcp_f32 v48, v28
  v_mov_b32 v42, 0
  v_mov_b32 v43, 0

  v_cndmask_b32 v32, v24, v20, s[42:43]
  v_cndmask_b32 v33, v25, v21, s[42:43]
  v_cndmask_b32 v34, v26, v22, s[42:43]
  v_cndmask_b32 v35, v27, v23, s[42:43]
  v_mul_f32 v32, v32, v48
  v_mul_f32 v33, v33, v48
  v_mul_f32 v34, v34, v48
  v_mul_f32 v35, v35, v48
  v_cvt_pk_bf16_f32 v50, v32, v33
  v_cvt_pk_bf16_f32 v51, v34, v35
  ds_write_b64 v6, v[50:51]

  v_mov_b32 v20, 0
  v_mov_b32 v21, 0
  v_mov_b32 v22, 0
  v_mov_b32 v23, 0
  v_mov_b32 v24, 0
  v_mov_b32 v25, 0
  v_mov_b32 v26, 0
  v_mov_b32 v27, 0
  v_mov_b32 v28, 0
  v_mov_b32 v29, 0
  v_mov_b32 v30, 0
  v_mov_b32 v31, 0
  v_mov_b32 v44, 0
  v_mov_b32 v45, 0
  s_waitcnt lgkmcnt(0)
  s_barrier
  ds_read_b128 v[108:111], v2 offset:0
  ds_read_b128 v[112:115], v2 offset:1024

  v_mov_b32 v32, 0
  v_mov_b32 v33, 0
  v_mov_b32 v34, 0
  v_mov_b32 v35, 0
  v_mov_b32 v46, 0
  v_mov_b32 v47, 0
  v_mov_b32 v48, 0
  v_mov_b32 v49, 0
  v_mov_b32 v50, 0
  v_mov_b32 v51, 0
  s_waitcnt lgkmcnt(1)
  v_smfmac_f32_16x16x64_bf16 v[20:23], v[108:111], v[76:83], v1
  s_waitcnt lgkmcnt(0)
  v_smfmac_f32_16x16x64_bf16 v[20:23], v[112:115], v[84:91], v1
  ds_read_b128 v[120:123], v3 offset:22528
  ds_read_b128 v[124:127], v3 offset:23552
  v_smfmac_f32_16x16x64_bf16 v[24:27], v[108:111], v[92:99], v1
  ds_read_b128 v[76:79], v3 offset:8192
  ds_read_b128 v[80:83], v3 offset:9216
  v_smfmac_f32_16x16x64_bf16 v[24:27], v[112:115], v[100:107], v1
  ds_read_b128 v[84:87], v3 offset:24576
  ds_read_b128 v[88:91], v3 offset:25600
  v_smfmac_f32_16x16x64_bf16 v[28:31], v[108:111], v[52:59], v1
  ds_read_b128 v[92:95], v3 offset:10240
  ds_read_b128 v[96:99], v3 offset:11264
  v_add_f32 v20, v20, v22
  v_add_f32 v21, v21, v23
  v_cvt_pk_bf16_f32 v116, v20, v21
  v_smfmac_f32_16x16x64_bf16 v[28:31], v[112:115], v[60:67], v1
  ds_read_b128 v[100:103], v3 offset:26624
  ds_read_b128 v[104:107], v3 offset:27648
  v_smfmac_f32_16x16x64_bf16 v[32:35], v[108:111], v[68:75], v1
  v_add_f32 v24, v24, v26
  v_add_f32 v25, v25, v27
  v_cvt_pk_bf16_f32 v117, v24, v25
  s_waitcnt lgkmcnt(8)
  v_smfmac_f32_16x16x64_bf16 v[32:35], v[112:115], v[120:127], v1
  s_waitcnt lgkmcnt(4)
  v_smfmac_f32_16x16x64_bf16 v[36:39], v[108:111], v[76:83], v1
  v_add_f32 v28, v28, v30
  v_add_f32 v29, v29, v31
  v_cvt_pk_bf16_f32 v118, v28, v29
  v_smfmac_f32_16x16x64_bf16 v[36:39], v[112:115], v[84:91], v1
  s_waitcnt lgkmcnt(0)
  v_smfmac_f32_16x16x64_bf16 v[40:43], v[108:111], v[92:99], v1
  v_add_f32 v32, v32, v34
  v_add_f32 v33, v33, v35
  v_cvt_pk_bf16_f32 v119, v32, v33
  v_and_or_b32 v116, v116, -2, s70
  buffer_store_dwordx4 v[116:119], v7, s[20:23], s36 offen
  v_smfmac_f32_16x16x64_bf16 v[40:43], v[112:115], v[100:107], v1
  v_smfmac_f32_16x16x64_bf16 v[44:47], v[108:111], a[8:15], v1
  v_add_f32 v36, v36, v38
  v_add_f32 v37, v37, v39
  v_cvt_pk_bf16_f32 v116, v36, v37
  v_smfmac_f32_16x16x64_bf16 v[44:47], v[112:115], a[72:79], v1
  v_smfmac_f32_16x16x64_bf16 v[48:51], v[108:111], a[40:47], v1
  v_add_f32 v40, v40, v42
  v_add_f32 v41, v41, v43
  v_cvt_pk_bf16_f32 v117, v40, v41
  v_smfmac_f32_16x16x64_bf16 v[48:51], v[112:115], a[104:111], v1
  s_nop 1
  v_add_f32 v44, v44, v46
  v_add_f32 v45, v45, v47
  v_cvt_pk_bf16_f32 v118, v44, v45
  s_nop 4
  v_add_f32 v48, v48, v50
  v_add_f32 v49, v49, v51
  v_cvt_pk_bf16_f32 v119, v48, v49
  v_and_or_b32 v116, v116, -2, s70
  buffer_store_dwordx4 v[116:119], v7, s[20:23], s37 offen
  s_cmp_eq_u32 s18, 0
  s_cbranch_scc0 mega_kernel_rdone
  s_mov_b32 s60, 0

  v_mov_b32 v45, s70
  v_mov_b32 v46, -1
  v_mov_b32 v47, -1
  s_mov_b32 s60, 0
  s_sleep 4
  buffer_load_dwordx4 v[108:111], v2, s[20:23], s40 offen offset:0 sc1
  buffer_load_dwordx4 v[112:115], v2, s[20:23], s40 offen offset:1024 sc1
  buffer_load_dwordx4 v[116:119], v2, s[20:23], s40 offen offset:2048 sc1
  buffer_load_dwordx4 v[120:123], v2, s[20:23], s40 offen offset:3072 sc1
  buffer_load_dwordx4 v[92:95], v2, s[20:23], s41 offen offset:0 sc1
  buffer_load_dwordx4 v[96:99], v2, s[20:23], s41 offen offset:1024 sc1
  buffer_load_dwordx4 v[100:103], v2, s[20:23], s41 offen offset:2048 sc1
  buffer_load_dwordx4 v[104:107], v2, s[20:23], s41 offen offset:3072 sc1
  s_branch mega_kernel_l2a
  buffer_load_dwordx4 v[20:23], v2, s[20:23], s40 offen offset:0 sc1
  buffer_load_dwordx4 v[24:27], v2, s[20:23], s40 offen offset:1024 sc1
  buffer_load_dwordx4 v[28:31], v2, s[20:23], s40 offen offset:2048 sc1
  buffer_load_dwordx4 v[32:35], v2, s[20:23], s40 offen offset:3072 sc1
  v_mov_b32 v45, s70
  v_mov_b32 v46, -1
  v_mov_b32 v47, -1
  s_mov_b32 s60, 0
  s_waitcnt vmcnt(4)
  buffer_load_dwordx4 v[76:79], v2, s[20:23], s41 offen offset:0 sc1
  buffer_load_dwordx4 v[80:83], v2, s[20:23], s41 offen offset:1024 sc1
  buffer_load_dwordx4 v[84:87], v2, s[20:23], s41 offen offset:2048 sc1
  buffer_load_dwordx4 v[88:91], v2, s[20:23], s41 offen offset:3072 sc1
  s_waitcnt vmcnt(4)
  v_mfma_f32_16x16x32_bf16 v[36:39], v[20:23], v[16:19], 0
  v_bitop3_b32 v44, v20, v24, v45 bitop3:0x7e
  v_bitop3_b32 v44, v44, v28, v45 bitop3:0xf6
  v_mfma_f32_16x16x32_bf16 v[36:39], v[24:27], v[16:19], v[36:39]
  v_bitop3_b32 v44, v44, v32, v45 bitop3:0xf6
  v_and_b32 v44, 1, v44
  v_mfma_f32_16x16x32_bf16 v[36:39], v[28:31], v[16:19], v[36:39]
  v_cmp_ne_u32 vcc, 0, v44
  v_mfma_f32_16x16x32_bf16 v[36:39], v[32:35], v[16:19], v[36:39]
  s_cbranch_vccnz mega_kernel_r0f

mega_kernel_r1a:
  buffer_load_dwordx4 v[92:95], v2, s[20:23], s41 offen offset:0 sc1
  buffer_load_dwordx4 v[96:99], v2, s[20:23], s41 offen offset:1024 sc1
  buffer_load_dwordx4 v[100:103], v2, s[20:23], s41 offen offset:2048 sc1
  buffer_load_dwordx4 v[104:107], v2, s[20:23], s41 offen offset:3072 sc1
mega_kernel_r1:
  s_waitcnt vmcnt(4)
  v_mfma_f32_16x16x32_bf16 v[40:43], v[76:79], v[16:19], v[36:39]
  v_bitop3_b32 v44, v76, v80, v45 bitop3:0x7e
  v_bitop3_b32 v44, v44, v84, v45 bitop3:0xf6
  v_mfma_f32_16x16x32_bf16 v[40:43], v[80:83], v[16:19], v[40:43]
  v_bitop3_b32 v44, v44, v88, v45 bitop3:0xf6
  v_and_b32 v44, 1, v44
  v_mfma_f32_16x16x32_bf16 v[40:43], v[84:87], v[16:19], v[40:43]
  v_cmp_ne_u32 vcc, 0, v44
  v_mfma_f32_16x16x32_bf16 v[40:43], v[88:91], v[16:19], v[40:43]
  s_cbranch_vccnz mega_kernel_r1x

mega_kernel_rok:
  s_nop 6
  v_cvt_pk_bf16_f32 v48, v40, v41
  v_cvt_pk_bf16_f32 v49, v42, v43
  buffer_store_dwordx2 v[48:49], v8, s[24:27], s47 offen
  buffer_store_dwordx2 v[46:47], v8, s[24:27], s48 offen

mega_kernel_rdone:
  s_branch mega_kernel_loop
mega_kernel_r0f:
  buffer_load_dwordx4 v[108:111], v2, s[20:23], s40 offen offset:0 sc1
  buffer_load_dwordx4 v[112:115], v2, s[20:23], s40 offen offset:1024 sc1
  buffer_load_dwordx4 v[116:119], v2, s[20:23], s40 offen offset:2048 sc1
  buffer_load_dwordx4 v[120:123], v2, s[20:23], s40 offen offset:3072 sc1
  buffer_load_dwordx4 v[92:95], v2, s[20:23], s41 offen offset:0 sc1
  buffer_load_dwordx4 v[96:99], v2, s[20:23], s41 offen offset:1024 sc1
  buffer_load_dwordx4 v[100:103], v2, s[20:23], s41 offen offset:2048 sc1
  buffer_load_dwordx4 v[104:107], v2, s[20:23], s41 offen offset:3072 sc1
  s_nop 15
  s_nop 15
mega_kernel_l2a:
  s_add_u32 s60, s60, 1
  s_cmp_gt_u32 s60, 50000000
  s_cbranch_scc1 mega_kernel_fail
  buffer_load_dwordx4 v[20:23], v2, s[20:23], s40 offen offset:0 sc1
  buffer_load_dwordx4 v[24:27], v2, s[20:23], s40 offen offset:1024 sc1
  buffer_load_dwordx4 v[28:31], v2, s[20:23], s40 offen offset:2048 sc1
  buffer_load_dwordx4 v[32:35], v2, s[20:23], s40 offen offset:3072 sc1
  buffer_load_dwordx4 v[76:79], v2, s[20:23], s41 offen offset:0 sc1
  buffer_load_dwordx4 v[80:83], v2, s[20:23], s41 offen offset:1024 sc1
  buffer_load_dwordx4 v[84:87], v2, s[20:23], s41 offen offset:2048 sc1
  buffer_load_dwordx4 v[88:91], v2, s[20:23], s41 offen offset:3072 sc1
  s_waitcnt vmcnt(12)
  v_mfma_f32_16x16x32_bf16 v[36:39], v[108:111], v[16:19], 0
  v_bitop3_b32 v44, v108, v112, v45 bitop3:0x7e
  v_bitop3_b32 v44, v44, v116, v45 bitop3:0xf6
  v_mfma_f32_16x16x32_bf16 v[36:39], v[112:115], v[16:19], v[36:39]
  v_bitop3_b32 v44, v44, v120, v45 bitop3:0xf6
  v_and_b32 v44, 1, v44
  v_mfma_f32_16x16x32_bf16 v[36:39], v[116:119], v[16:19], v[36:39]
  v_cmp_ne_u32 vcc, 0, v44
  v_mfma_f32_16x16x32_bf16 v[36:39], v[120:123], v[16:19], v[36:39]
  s_cbranch_vccnz mega_kernel_l2b

  s_waitcnt vmcnt(8)
  v_mfma_f32_16x16x32_bf16 v[40:43], v[92:95], v[16:19], v[36:39]
  v_bitop3_b32 v44, v92, v96, v45 bitop3:0x7e
  v_bitop3_b32 v44, v44, v100, v45 bitop3:0xf6
  v_mfma_f32_16x16x32_bf16 v[40:43], v[96:99], v[16:19], v[40:43]
  v_bitop3_b32 v44, v44, v104, v45 bitop3:0xf6
  v_and_b32 v44, 1, v44
  v_mfma_f32_16x16x32_bf16 v[40:43], v[100:103], v[16:19], v[40:43]
  v_cmp_ne_u32 vcc, 0, v44
  v_mfma_f32_16x16x32_bf16 v[40:43], v[104:107], v[16:19], v[40:43]
  s_cbranch_vccnz mega_kernel_r1a

  s_branch mega_kernel_rok
mega_kernel_l2b:
  buffer_load_dwordx4 v[108:111], v2, s[20:23], s40 offen offset:0 sc1
  buffer_load_dwordx4 v[112:115], v2, s[20:23], s40 offen offset:1024 sc1
  buffer_load_dwordx4 v[116:119], v2, s[20:23], s40 offen offset:2048 sc1
  buffer_load_dwordx4 v[120:123], v2, s[20:23], s40 offen offset:3072 sc1
  buffer_load_dwordx4 v[92:95], v2, s[20:23], s41 offen offset:0 sc1
  buffer_load_dwordx4 v[96:99], v2, s[20:23], s41 offen offset:1024 sc1
  buffer_load_dwordx4 v[100:103], v2, s[20:23], s41 offen offset:2048 sc1
  buffer_load_dwordx4 v[104:107], v2, s[20:23], s41 offen offset:3072 sc1
  s_waitcnt vmcnt(12)
  v_mfma_f32_16x16x32_bf16 v[36:39], v[20:23], v[16:19], 0
  v_bitop3_b32 v44, v20, v24, v45 bitop3:0x7e
  v_bitop3_b32 v44, v44, v28, v45 bitop3:0xf6
  v_mfma_f32_16x16x32_bf16 v[36:39], v[24:27], v[16:19], v[36:39]
  v_bitop3_b32 v44, v44, v32, v45 bitop3:0xf6
  v_and_b32 v44, 1, v44
  v_mfma_f32_16x16x32_bf16 v[36:39], v[28:31], v[16:19], v[36:39]
  v_cmp_ne_u32 vcc, 0, v44
  v_mfma_f32_16x16x32_bf16 v[36:39], v[32:35], v[16:19], v[36:39]
  s_cbranch_vccnz mega_kernel_l2a

  s_waitcnt vmcnt(8)
  v_mfma_f32_16x16x32_bf16 v[40:43], v[76:79], v[16:19], v[36:39]
  v_bitop3_b32 v44, v76, v80, v45 bitop3:0x7e
  v_bitop3_b32 v44, v44, v84, v45 bitop3:0xf6
  v_mfma_f32_16x16x32_bf16 v[40:43], v[80:83], v[16:19], v[40:43]
  v_bitop3_b32 v44, v44, v88, v45 bitop3:0xf6
  v_and_b32 v44, 1, v44
  v_mfma_f32_16x16x32_bf16 v[40:43], v[84:87], v[16:19], v[40:43]
  v_cmp_ne_u32 vcc, 0, v44
  v_mfma_f32_16x16x32_bf16 v[40:43], v[88:91], v[16:19], v[40:43]
  s_cbranch_vccnz mega_kernel_r1x

  s_branch mega_kernel_rok
mega_kernel_r1x:
  s_add_u32 s60, s60, 1
  s_cmp_gt_u32 s60, 50000000
  s_cbranch_scc1 mega_kernel_fail
  buffer_load_dwordx4 v[76:79], v2, s[20:23], s41 offen offset:0 sc1
  buffer_load_dwordx4 v[80:83], v2, s[20:23], s41 offen offset:1024 sc1
  buffer_load_dwordx4 v[84:87], v2, s[20:23], s41 offen offset:2048 sc1
  buffer_load_dwordx4 v[88:91], v2, s[20:23], s41 offen offset:3072 sc1
  s_waitcnt vmcnt(4)
  v_mfma_f32_16x16x32_bf16 v[40:43], v[92:95], v[16:19], v[36:39]
  v_bitop3_b32 v44, v92, v96, v45 bitop3:0x7e
  v_bitop3_b32 v44, v44, v100, v45 bitop3:0xf6
  v_mfma_f32_16x16x32_bf16 v[40:43], v[96:99], v[16:19], v[40:43]
  v_bitop3_b32 v44, v44, v104, v45 bitop3:0xf6
  v_and_b32 v44, 1, v44
  v_mfma_f32_16x16x32_bf16 v[40:43], v[100:103], v[16:19], v[40:43]
  v_cmp_ne_u32 vcc, 0, v44
  v_mfma_f32_16x16x32_bf16 v[40:43], v[104:107], v[16:19], v[40:43]
  s_cbranch_vccnz mega_kernel_r1y

  s_branch mega_kernel_rok
mega_kernel_r1y:
  buffer_load_dwordx4 v[92:95], v2, s[20:23], s41 offen offset:0 sc1
  buffer_load_dwordx4 v[96:99], v2, s[20:23], s41 offen offset:1024 sc1
  buffer_load_dwordx4 v[100:103], v2, s[20:23], s41 offen offset:2048 sc1
  buffer_load_dwordx4 v[104:107], v2, s[20:23], s41 offen offset:3072 sc1
  s_branch mega_kernel_r1
mega_kernel_fin:
  s_waitcnt vmcnt(0)
  s_barrier
  v_mov_b32 v36, 64
  global_store_dword v11, v36, s[34:35] sc1

  s_branch mega_kernel_end
mega_kernel_fail:
  s_load_dwordx2 s[50:51], s[0:1], 104
  v_mov_b32 v20, 160
  v_mov_b32 v21, 0xdead
  v_add_u32 v21, s19, v21
  s_waitcnt lgkmcnt(0)
  global_store_dword v20, v21, s[50:51]

mega_kernel_end:
  s_endpgm
mega_kernel_worker:
  s_sub_u32 s17, s17, 256
  s_cmp_ge_u32 s17, 224
  s_cbranch_scc1 mega_kernel_end
  s_add_u32 s14, s12, 66125824
  s_addc_u32 s15, s13, 0
  v_lshlrev_b32 v1, 4, v0
  s_mov_b32 s16, 0
  s_mul_hi_u32 s26, s17, 613566757
  s_mul_i32 s28, s26, 7
  s_sub_u32 s28, s17, s28
  s_and_b32 s27, s26, 15
  s_lshr_b32 s29, s26, 4
  s_lshl_b32 s35, s27, 6
  s_add_u32 s35, s35, 6400
  s_cmp_eq_u32 s29, 1
  s_cselect_b32 s4, s8, s6
  s_cselect_b32 s5, s9, s7
  s_mov_b32 s30, 2097152
  s_cselect_b32 s30, 18874368, s30
  s_mov_b32 s20, 9
  s_cmp_eq_u32 s28, 0
  s_cselect_b32 s20, 10, s20
  s_mov_b32 s21, 229376
  s_mov_b32 s25, 57344
mega_kernel_Aset:
  s_lshl_b32 s60, s27, 9
  s_lshl_b32 s26, s18, 7
  s_add_u32 s60, s60, s26
  s_add_u32 s4, s4, s60
  s_addc_u32 s5, s5, 0
  s_lshl_b32 s60, s27, 1
  s_lshr_b32 s26, s18, 1
  s_add_u32 s60, s60, s26
  s_lshl_b32 s60, s60, 19
  s_add_u32 s30, s30, s60
  s_lshl_b32 s60, s28, 13
  s_add_u32 s30, s30, s60
  s_and_b32 s60, s18, 1
  s_lshl_b32 s60, s60, 11
  s_lshl_b32 s60, s60, s29
  s_add_u32 s30, s30, s60
  s_add_u32 s22, s12, s30
  s_addc_u32 s23, s13, 0
  s_mul_i32 s36, s28, 0
  s_and_b32 s37, s18, 1
  s_lshl_b32 s37, s37, 3
  s_add_u32 s37, s37, s36
  s_lshl_b32 s60, s28, 15
  s_lshr_b32 s26, s18, 1
  s_lshl_b32 s26, s26, 14
  s_add_u32 s60, s60, s26
  s_add_u32 s60, s60, 0
  s_add_u32 s6, s12, s60
  s_addc_u32 s7, s13, 0
  s_cmp_eq_u32 s29, 1
  s_cbranch_scc1 mega_kernel_V

  s_mov_b32 s60, s29
  s_lshl_b32 s28, s16, 8
  s_add_u32 s28, s28, s17
  s_cmp_lt_u32 s28, 128
  s_cselect_b32 s39, 1, 0
  s_cbranch_scc0 mega_kernel_qk_pre_a
  s_load_dwordx2 s[26:27], s[0:1], 0
  v_and_b32 v5, 15, v0
  v_lshlrev_b32 v5, 10, v5
  v_lshrrev_b32 v6, 4, v0
  v_lshl_add_u32 v5, v6, 4, v5
  s_lshl_b32 s28, s17, 14
  s_lshl_b32 s29, s18, 8
  s_add_u32 s28, s28, s29
  s_waitcnt lgkmcnt(0)
  s_add_u32 s26, s26, s28
  s_addc_u32 s27, s27, 0

  global_load_dwordx4 v[40:43], v5, s[26:27] offset:0
  global_load_dwordx4 v[44:47], v5, s[26:27] offset:64
  global_load_dwordx4 v[48:51], v5, s[26:27] offset:128
  global_load_dwordx4 v[52:55], v5, s[26:27] offset:192
  s_cmp_lt_u32 s17, 30
  s_cbranch_scc0 mega_kernel_qk_pre_a
  v_mov_b32 v100, 0
  v_mov_b32 v101, 0
  v_mov_b32 v102, 0
  v_mov_b32 v103, 0
  v_lshlrev_b32 v6, 4, v0
  s_lshl_b32 s26, s17, 12
  s_add_u32 s28, s26, 83886080
  s_add_u32 s29, s26, 85983232
  s_cmp_ge_u32 s17, 4
  s_cselect_b32 s28, s29, s28
  s_add_u32 s29, s26, 66093056
  s_cmp_ge_u32 s17, 8
  s_cselect_b32 s28, s29, s28
  s_lshl_b32 s26, s18, 10
  s_add_u32 s28, s28, s26
  s_add_u32 s28, s12, s28
  s_addc_u32 s29, s13, 0
  global_store_dwordx4 v6, v[100:103], s[28:29] sc1
mega_kernel_qk_pre_a:

  v_lshrrev_b32 v5, 3, v0
  v_mov_b32 v6, 8192
  v_mul_lo_u32 v5, v5, v6
  v_and_b32 v6, 7, v0
  v_lshl_add_u32 v2, v6, 4, v5
  v_and_b32 v5, 15, v0
  v_lshrrev_b32 v6, 4, v0
  v_lshrrev_b32 v7, 2, v5
  v_lshl_add_u32 v7, v6, 3, v7
  v_mul_u32_u24 v7, 128, v7
  v_and_b32 v5, 3, v5
  v_lshl_add_u32 v7, v5, 4, v7
  s_mul_i32 s24, s18, 36864
  s_add_u32 s24, s24, 4096
  v_add_u32 v3, s24, v7

  s_add_u32 s8, s4, 0
  s_addc_u32 s9, s5, 0
  s_add_u32 m0, s24, 0
  s_nop 0
  global_load_lds_dwordx4 v2, s[8:9]

  s_add_u32 s8, s4, 65536
  s_addc_u32 s9, s5, 0
  s_add_u32 m0, s24, 1024
  s_nop 0
  global_load_lds_dwordx4 v2, s[8:9]

  s_add_u32 s8, s4, 131072
  s_addc_u32 s9, s5, 0
  s_add_u32 m0, s24, 2048
  s_nop 0
  global_load_lds_dwordx4 v2, s[8:9]

  s_add_u32 s8, s4, 196608
  s_addc_u32 s9, s5, 0
  s_add_u32 m0, s24, 3072
  s_nop 0
  global_load_lds_dwordx4 v2, s[8:9]

  s_add_u32 s8, s4, 262144
  s_addc_u32 s9, s5, 0
  s_add_u32 m0, s24, 4096
  s_nop 0
  global_load_lds_dwordx4 v2, s[8:9]

  s_add_u32 s8, s4, 327680
  s_addc_u32 s9, s5, 0
  s_add_u32 m0, s24, 5120
  s_nop 0
  global_load_lds_dwordx4 v2, s[8:9]

  s_add_u32 s8, s4, 393216
  s_addc_u32 s9, s5, 0
  s_add_u32 m0, s24, 6144
  s_nop 0
  global_load_lds_dwordx4 v2, s[8:9]

  s_add_u32 s8, s4, 458752
  s_addc_u32 s9, s5, 0
  s_add_u32 m0, s24, 7168
  s_nop 0
  global_load_lds_dwordx4 v2, s[8:9]

  s_add_u32 s8, s4, 524288
  s_addc_u32 s9, s5, 0
  s_add_u32 m0, s24, 8192
  s_nop 0
  global_load_lds_dwordx4 v2, s[8:9]

  s_add_u32 s8, s4, 589824
  s_addc_u32 s9, s5, 0
  s_add_u32 m0, s24, 9216
  s_nop 0
  global_load_lds_dwordx4 v2, s[8:9]

  s_add_u32 s8, s4, 655360
  s_addc_u32 s9, s5, 0
  s_add_u32 m0, s24, 10240
  s_nop 0
  global_load_lds_dwordx4 v2, s[8:9]

  s_add_u32 s8, s4, 720896
  s_addc_u32 s9, s5, 0
  s_add_u32 m0, s24, 11264
  s_nop 0
  global_load_lds_dwordx4 v2, s[8:9]

  s_add_u32 s8, s4, 786432
  s_addc_u32 s9, s5, 0
  s_add_u32 m0, s24, 12288
  s_nop 0
  global_load_lds_dwordx4 v2, s[8:9]

  s_add_u32 s8, s4, 851968
  s_addc_u32 s9, s5, 0
  s_add_u32 m0, s24, 13312
  s_nop 0
  global_load_lds_dwordx4 v2, s[8:9]

  s_add_u32 s8, s4, 917504
  s_addc_u32 s9, s5, 0
  s_add_u32 m0, s24, 14336
  s_nop 0
  global_load_lds_dwordx4 v2, s[8:9]

  s_add_u32 s8, s4, 983040
  s_addc_u32 s9, s5, 0
  s_add_u32 m0, s24, 15360
  s_nop 0
  global_load_lds_dwordx4 v2, s[8:9]

  s_add_u32 s8, s4, 1048576
  s_addc_u32 s9, s5, 0
  s_add_u32 m0, s24, 16384
  s_nop 0
  global_load_lds_dwordx4 v2, s[8:9]

  s_add_u32 s8, s4, 1114112
  s_addc_u32 s9, s5, 0
  s_add_u32 m0, s24, 17408
  s_nop 0
  global_load_lds_dwordx4 v2, s[8:9]

  s_add_u32 s8, s4, 1179648
  s_addc_u32 s9, s5, 0
  s_add_u32 m0, s24, 18432
  s_nop 0
  global_load_lds_dwordx4 v2, s[8:9]

  s_add_u32 s8, s4, 1245184
  s_addc_u32 s9, s5, 0
  s_add_u32 m0, s24, 19456
  s_nop 0
  global_load_lds_dwordx4 v2, s[8:9]

  s_add_u32 s8, s4, 1310720
  s_addc_u32 s9, s5, 0
  s_add_u32 m0, s24, 20480
  s_nop 0
  global_load_lds_dwordx4 v2, s[8:9]

  s_add_u32 s8, s4, 1376256
  s_addc_u32 s9, s5, 0
  s_add_u32 m0, s24, 21504
  s_nop 0
  global_load_lds_dwordx4 v2, s[8:9]

  s_add_u32 s8, s4, 1441792
  s_addc_u32 s9, s5, 0
  s_add_u32 m0, s24, 22528
  s_nop 0
  global_load_lds_dwordx4 v2, s[8:9]

  s_add_u32 s8, s4, 1507328
  s_addc_u32 s9, s5, 0
  s_add_u32 m0, s24, 23552
  s_nop 0
  global_load_lds_dwordx4 v2, s[8:9]

  s_add_u32 s8, s4, 1572864
  s_addc_u32 s9, s5, 0
  s_add_u32 m0, s24, 24576
  s_nop 0
  global_load_lds_dwordx4 v2, s[8:9]

  s_add_u32 s8, s4, 1638400
  s_addc_u32 s9, s5, 0
  s_add_u32 m0, s24, 25600
  s_nop 0
  global_load_lds_dwordx4 v2, s[8:9]

  s_add_u32 s8, s4, 1703936
  s_addc_u32 s9, s5, 0
  s_add_u32 m0, s24, 26624
  s_nop 0
  global_load_lds_dwordx4 v2, s[8:9]

  s_add_u32 s8, s4, 1769472
  s_addc_u32 s9, s5, 0
  s_add_u32 m0, s24, 27648
  s_nop 0
  global_load_lds_dwordx4 v2, s[8:9]

  s_add_u32 s8, s4, 1835008
  s_addc_u32 s9, s5, 0
  s_add_u32 m0, s24, 28672
  s_nop 0
  global_load_lds_dwordx4 v2, s[8:9]

  s_add_u32 s8, s4, 1900544
  s_addc_u32 s9, s5, 0
  s_add_u32 m0, s24, 29696
  s_nop 0
  global_load_lds_dwordx4 v2, s[8:9]

  s_add_u32 s8, s4, 1966080
  s_addc_u32 s9, s5, 0
  s_add_u32 m0, s24, 30720
  s_nop 0
  global_load_lds_dwordx4 v2, s[8:9]

  s_add_u32 s8, s4, 2031616
  s_addc_u32 s9, s5, 0
  s_add_u32 m0, s24, 31744
  s_nop 0
  global_load_lds_dwordx4 v2, s[8:9]

  s_add_u32 s8, s4, 2097152
  s_addc_u32 s9, s5, 0
  s_add_u32 m0, s24, 32768
  s_nop 0
  global_load_lds_dwordx4 v2, s[8:9]

  s_add_u32 s8, s4, 2162688
  s_addc_u32 s9, s5, 0
  s_add_u32 m0, s24, 33792
  s_nop 0
  global_load_lds_dwordx4 v2, s[8:9]

  s_add_u32 s8, s4, 2228224
  s_addc_u32 s9, s5, 0
  s_add_u32 m0, s24, 34816
  s_nop 0
  global_load_lds_dwordx4 v2, s[8:9]

  s_add_u32 s8, s4, 2293760
  s_addc_u32 s9, s5, 0
  s_add_u32 m0, s24, 35840
  s_nop 0
  global_load_lds_dwordx4 v2, s[8:9]

  s_cmp_eq_u32 s39, 1
  s_cbranch_scc0 mega_kernel_qk_pre_b
  s_waitcnt vmcnt(36)
  v_lshlrev_b32 v64, 16, v40
  v_and_b32 v65, 0xffff0000, v40
  v_lshlrev_b32 v66, 16, v41
  v_and_b32 v67, 0xffff0000, v41
  v_lshlrev_b32 v68, 16, v42
  v_and_b32 v69, 0xffff0000, v42
  v_lshlrev_b32 v70, 16, v43
  v_and_b32 v71, 0xffff0000, v43
  v_lshlrev_b32 v72, 16, v44
  v_and_b32 v73, 0xffff0000, v44
  v_lshlrev_b32 v74, 16, v45
  v_and_b32 v75, 0xffff0000, v45
  v_lshlrev_b32 v76, 16, v46
  v_and_b32 v77, 0xffff0000, v46
  v_lshlrev_b32 v78, 16, v47
  v_and_b32 v79, 0xffff0000, v47
  v_lshlrev_b32 v80, 16, v48
  v_and_b32 v81, 0xffff0000, v48
  v_lshlrev_b32 v82, 16, v49
  v_and_b32 v83, 0xffff0000, v49
  v_lshlrev_b32 v84, 16, v50
  v_and_b32 v85, 0xffff0000, v50
  v_lshlrev_b32 v86, 16, v51
  v_and_b32 v87, 0xffff0000, v51
  v_lshlrev_b32 v88, 16, v52
  v_and_b32 v89, 0xffff0000, v52
  v_lshlrev_b32 v90, 16, v53
  v_and_b32 v91, 0xffff0000, v53
  v_lshlrev_b32 v92, 16, v54
  v_and_b32 v93, 0xffff0000, v54
  v_lshlrev_b32 v94, 16, v55
  v_and_b32 v95, 0xffff0000, v55
  v_pk_add_f32 v[24:25], v[64:65], v[66:67]
  v_pk_add_f32 v[26:27], v[68:69], v[70:71]
  v_pk_add_f32 v[24:25], v[24:25], v[72:73]
  v_pk_add_f32 v[26:27], v[26:27], v[74:75]
  v_pk_add_f32 v[24:25], v[24:25], v[76:77]
  v_pk_add_f32 v[26:27], v[26:27], v[78:79]
  v_pk_add_f32 v[24:25], v[24:25], v[80:81]
  v_pk_add_f32 v[26:27], v[26:27], v[82:83]
  v_pk_add_f32 v[24:25], v[24:25], v[84:85]
  v_pk_add_f32 v[26:27], v[26:27], v[86:87]
  v_pk_add_f32 v[24:25], v[24:25], v[88:89]
  v_pk_add_f32 v[26:27], v[26:27], v[90:91]
  v_pk_add_f32 v[24:25], v[24:25], v[92:93]
  v_pk_add_f32 v[26:27], v[26:27], v[94:95]
  v_pk_add_f32 v[24:25], v[24:25], v[26:27]
  v_add_f32 v24, v24, v25
  v_mov_b32 v25, v24
  s_nop 1
  v_permlane32_swap_b32 v24, v25
  v_add_f32 v24, v24, v25
  v_mov_b32 v25, v24
  s_nop 1
  v_permlane16_swap_b32 v24, v25
  v_add_f32 v24, v24, v25

  v_mul_f32 v24, 0x3c000000, v24
  v_pk_add_f32 v[64:65], v[64:65], v[24:25] op_sel_hi:[1,0] neg_lo:[0,1] neg_hi:[0,1]
  v_pk_add_f32 v[66:67], v[66:67], v[24:25] op_sel_hi:[1,0] neg_lo:[0,1] neg_hi:[0,1]
  v_pk_add_f32 v[68:69], v[68:69], v[24:25] op_sel_hi:[1,0] neg_lo:[0,1] neg_hi:[0,1]
  v_pk_add_f32 v[70:71], v[70:71], v[24:25] op_sel_hi:[1,0] neg_lo:[0,1] neg_hi:[0,1]
  v_pk_add_f32 v[72:73], v[72:73], v[24:25] op_sel_hi:[1,0] neg_lo:[0,1] neg_hi:[0,1]
  v_pk_add_f32 v[74:75], v[74:75], v[24:25] op_sel_hi:[1,0] neg_lo:[0,1] neg_hi:[0,1]
  v_pk_add_f32 v[76:77], v[76:77], v[24:25] op_sel_hi:[1,0] neg_lo:[0,1] neg_hi:[0,1]
  v_pk_add_f32 v[78:79], v[78:79], v[24:25] op_sel_hi:[1,0] neg_lo:[0,1] neg_hi:[0,1]
  v_pk_add_f32 v[80:81], v[80:81], v[24:25] op_sel_hi:[1,0] neg_lo:[0,1] neg_hi:[0,1]
  v_pk_add_f32 v[82:83], v[82:83], v[24:25] op_sel_hi:[1,0] neg_lo:[0,1] neg_hi:[0,1]
  v_pk_add_f32 v[84:85], v[84:85], v[24:25] op_sel_hi:[1,0] neg_lo:[0,1] neg_hi:[0,1]
  v_pk_add_f32 v[86:87], v[86:87], v[24:25] op_sel_hi:[1,0] neg_lo:[0,1] neg_hi:[0,1]
  v_pk_add_f32 v[88:89], v[88:89], v[24:25] op_sel_hi:[1,0] neg_lo:[0,1] neg_hi:[0,1]
  v_pk_add_f32 v[90:91], v[90:91], v[24:25] op_sel_hi:[1,0] neg_lo:[0,1] neg_hi:[0,1]
  v_pk_add_f32 v[92:93], v[92:93], v[24:25] op_sel_hi:[1,0] neg_lo:[0,1] neg_hi:[0,1]
  v_pk_add_f32 v[94:95], v[94:95], v[24:25] op_sel_hi:[1,0] neg_lo:[0,1] neg_hi:[0,1]
  v_pk_mul_f32 v[26:27], v[64:65], v[64:65]
  v_pk_mul_f32 v[28:29], v[66:67], v[66:67]
  v_pk_fma_f32 v[26:27], v[68:69], v[68:69], v[26:27]
  v_pk_fma_f32 v[28:29], v[70:71], v[70:71], v[28:29]
  v_pk_fma_f32 v[26:27], v[72:73], v[72:73], v[26:27]
  v_pk_fma_f32 v[28:29], v[74:75], v[74:75], v[28:29]
  v_pk_fma_f32 v[26:27], v[76:77], v[76:77], v[26:27]
  v_pk_fma_f32 v[28:29], v[78:79], v[78:79], v[28:29]
  v_pk_fma_f32 v[26:27], v[80:81], v[80:81], v[26:27]
  v_pk_fma_f32 v[28:29], v[82:83], v[82:83], v[28:29]
  v_pk_fma_f32 v[26:27], v[84:85], v[84:85], v[26:27]
  v_pk_fma_f32 v[28:29], v[86:87], v[86:87], v[28:29]
  v_pk_fma_f32 v[26:27], v[88:89], v[88:89], v[26:27]
  v_pk_fma_f32 v[28:29], v[90:91], v[90:91], v[28:29]
  v_pk_fma_f32 v[26:27], v[92:93], v[92:93], v[26:27]
  v_pk_fma_f32 v[28:29], v[94:95], v[94:95], v[28:29]
  v_pk_add_f32 v[26:27], v[26:27], v[28:29]
  v_add_f32 v25, v26, v27
  v_mov_b32 v26, v25
  s_nop 1
  v_permlane32_swap_b32 v25, v26
  v_add_f32 v25, v25, v26
  v_mov_b32 v26, v25
  s_nop 1
  v_permlane16_swap_b32 v25, v26
  v_add_f32 v25, v25, v26

  v_and_b32 v26, 15, v0
  v_lshlrev_b32 v26, 5, v26
  s_lshl_b32 s26, s18, 3
  v_add_u32 v27, s26, v26
  ds_write_b64 v27, v[24:25] offset:0
  s_waitcnt lgkmcnt(0)
  s_barrier
  ds_read_b128 v[28:31], v26 offset:0
  ds_read_b128 v[32:35], v26 offset:16
  s_waitcnt lgkmcnt(0)
  v_add_f32 v25, v28, v30
  v_add_f32 v26, v32, v34
  v_add_f32 v25, v25, v26
  v_mul_f32 v25, 0.25, v25
  v_add_f32 v29, v29, v31
  v_add_f32 v33, v33, v35
  v_add_f32 v29, v29, v33
  v_sub_f32 v28, v28, v25
  v_sub_f32 v30, v30, v25
  v_sub_f32 v32, v32, v25
  v_sub_f32 v34, v34, v25
  v_mul_f32 v28, v28, v28
  v_fmac_f32 v28, v30, v30
  v_fmac_f32 v28, v32, v32
  v_fmac_f32 v28, v34, v34
  v_fmac_f32 v29, 0x43000000, v28
  v_mul_f32 v29, 0x3b000000, v29
  v_add_f32 v30, 0x3727c5ac, v29
  v_rsq_f32 v30, v30
  v_sub_f32 v24, v24, v25
  v_mul_f32 v24, v24, v30

  v_pk_fma_f32 v[64:65], v[64:65], v[30:31], v[24:25] op_sel_hi:[1,0,0]
  v_pk_fma_f32 v[66:67], v[66:67], v[30:31], v[24:25] op_sel_hi:[1,0,0]
  v_pk_fma_f32 v[68:69], v[68:69], v[30:31], v[24:25] op_sel_hi:[1,0,0]
  v_pk_fma_f32 v[70:71], v[70:71], v[30:31], v[24:25] op_sel_hi:[1,0,0]
  v_pk_fma_f32 v[72:73], v[72:73], v[30:31], v[24:25] op_sel_hi:[1,0,0]
  v_pk_fma_f32 v[74:75], v[74:75], v[30:31], v[24:25] op_sel_hi:[1,0,0]
  v_pk_fma_f32 v[76:77], v[76:77], v[30:31], v[24:25] op_sel_hi:[1,0,0]
  v_pk_fma_f32 v[78:79], v[78:79], v[30:31], v[24:25] op_sel_hi:[1,0,0]
  v_pk_fma_f32 v[80:81], v[80:81], v[30:31], v[24:25] op_sel_hi:[1,0,0]
  v_pk_fma_f32 v[82:83], v[82:83], v[30:31], v[24:25] op_sel_hi:[1,0,0]
  v_pk_fma_f32 v[84:85], v[84:85], v[30:31], v[24:25] op_sel_hi:[1,0,0]
  v_pk_fma_f32 v[86:87], v[86:87], v[30:31], v[24:25] op_sel_hi:[1,0,0]
  v_pk_fma_f32 v[88:89], v[88:89], v[30:31], v[24:25] op_sel_hi:[1,0,0]
  v_pk_fma_f32 v[90:91], v[90:91], v[30:31], v[24:25] op_sel_hi:[1,0,0]
  v_pk_fma_f32 v[92:93], v[92:93], v[30:31], v[24:25] op_sel_hi:[1,0,0]
  v_pk_fma_f32 v[94:95], v[94:95], v[30:31], v[24:25] op_sel_hi:[1,0,0]
  v_cvt_pk_bf16_f32 v40, v64, v65
  v_cvt_pk_bf16_f32 v41, v66, v67
  v_cvt_pk_bf16_f32 v42, v68, v69
  v_cvt_pk_bf16_f32 v43, v70, v71
  v_cvt_pk_bf16_f32 v44, v72, v73
  v_cvt_pk_bf16_f32 v45, v74, v75
  v_cvt_pk_bf16_f32 v46, v76, v77
  v_cvt_pk_bf16_f32 v47, v78, v79
  v_cvt_pk_bf16_f32 v48, v80, v81
  v_cvt_pk_bf16_f32 v49, v82, v83
  v_cvt_pk_bf16_f32 v50, v84, v85
  v_cvt_pk_bf16_f32 v51, v86, v87
  v_cvt_pk_bf16_f32 v52, v88, v89
  v_cvt_pk_bf16_f32 v53, v90, v91
  v_cvt_pk_bf16_f32 v54, v92, v93
  v_cvt_pk_bf16_f32 v55, v94, v95
  v_lshlrev_b32 v6, 4, v0
  s_lshl_b32 s26, s17, 14
  s_lshl_b32 s27, s18, 12
  s_add_u32 s26, s26, s27
  s_add_u32 s26, s26, 0
  s_add_u32 s28, s12, s26
  s_addc_u32 s29, s13, 0

  global_store_dwordx4 v6, v[40:43], s[28:29] offset:0 sc1
  global_store_dwordx4 v6, v[44:47], s[28:29] offset:1024 sc1
  global_store_dwordx4 v6, v[48:51], s[28:29] offset:2048 sc1
  global_store_dwordx4 v6, v[52:55], s[28:29] offset:3072 sc1
mega_kernel_qk_pre_b:
  s_waitcnt vmcnt(0)
  s_cmp_eq_u32 s39, 1
  s_cbranch_scc0 mega_kernel_qk_pre_c
  s_barrier
  s_cmp_eq_u32 s18, 0
  s_cbranch_scc0 mega_kernel_qk_pre_c
  v_mov_b32 v100, 32
  v_mov_b32 v101, 1
  v_cmp_eq_u32 vcc, 0, v0
  s_and_saveexec_b64 s[62:63], vcc
  global_atomic_add v100, v101, s[58:59]
  s_mov_b64 exec, s[62:63]

mega_kernel_qk_pre_c:
  s_waitcnt vmcnt(32)
  ds_read_b64_tr_b16 a[0:1], v3 offset:0
  ds_read_b64_tr_b16 a[2:3], v3 offset:512
  ds_read_b64_tr_b16 a[4:5], v3 offset:8
  ds_read_b64_tr_b16 a[6:7], v3 offset:520
  ds_read_b64_tr_b16 a[8:9], v3 offset:64
  ds_read_b64_tr_b16 a[10:11], v3 offset:576
  ds_read_b64_tr_b16 a[12:13], v3 offset:72
  ds_read_b64_tr_b16 a[14:15], v3 offset:584
  s_waitcnt lgkmcnt(0)

  s_add_u32 s8, s4, 2359296
  s_addc_u32 s9, s5, 0
  s_add_u32 m0, s24, 0
  s_nop 0
  global_load_lds_dwordx4 v2, s[8:9]

  s_add_u32 s8, s4, 2424832
  s_addc_u32 s9, s5, 0
  s_add_u32 m0, s24, 1024
  s_nop 0
  global_load_lds_dwordx4 v2, s[8:9]

  s_add_u32 s8, s4, 2490368
  s_addc_u32 s9, s5, 0
  s_add_u32 m0, s24, 2048
  s_nop 0
  global_load_lds_dwordx4 v2, s[8:9]

  s_add_u32 s8, s4, 2555904
  s_addc_u32 s9, s5, 0
  s_add_u32 m0, s24, 3072
  s_nop 0
  global_load_lds_dwordx4 v2, s[8:9]

  s_waitcnt vmcnt(32)
  ds_read_b64_tr_b16 a[16:17], v3 offset:4096
  ds_read_b64_tr_b16 a[18:19], v3 offset:4608
  ds_read_b64_tr_b16 a[20:21], v3 offset:4104
  ds_read_b64_tr_b16 a[22:23], v3 offset:4616
  ds_read_b64_tr_b16 a[24:25], v3 offset:4160
  ds_read_b64_tr_b16 a[26:27], v3 offset:4672
  ds_read_b64_tr_b16 a[28:29], v3 offset:4168
  ds_read_b64_tr_b16 a[30:31], v3 offset:4680
  s_waitcnt lgkmcnt(0)

  s_add_u32 s8, s4, 2621440
  s_addc_u32 s9, s5, 0
  s_add_u32 m0, s24, 4096
  s_nop 0
  global_load_lds_dwordx4 v2, s[8:9]

  s_add_u32 s8, s4, 2686976
  s_addc_u32 s9, s5, 0
  s_add_u32 m0, s24, 5120
  s_nop 0
  global_load_lds_dwordx4 v2, s[8:9]

  s_add_u32 s8, s4, 2752512
  s_addc_u32 s9, s5, 0
  s_add_u32 m0, s24, 6144
  s_nop 0
  global_load_lds_dwordx4 v2, s[8:9]

  s_add_u32 s8, s4, 2818048
  s_addc_u32 s9, s5, 0
  s_add_u32 m0, s24, 7168
  s_nop 0
  global_load_lds_dwordx4 v2, s[8:9]

  s_waitcnt vmcnt(32)
  ds_read_b64_tr_b16 a[32:33], v3 offset:8192
  ds_read_b64_tr_b16 a[34:35], v3 offset:8704
  ds_read_b64_tr_b16 a[36:37], v3 offset:8200
  ds_read_b64_tr_b16 a[38:39], v3 offset:8712
  ds_read_b64_tr_b16 a[40:41], v3 offset:8256
  ds_read_b64_tr_b16 a[42:43], v3 offset:8768
  ds_read_b64_tr_b16 a[44:45], v3 offset:8264
  ds_read_b64_tr_b16 a[46:47], v3 offset:8776
  s_waitcnt lgkmcnt(0)

  s_add_u32 s8, s4, 2883584
  s_addc_u32 s9, s5, 0
  s_add_u32 m0, s24, 8192
  s_nop 0
  global_load_lds_dwordx4 v2, s[8:9]

  s_add_u32 s8, s4, 2949120
  s_addc_u32 s9, s5, 0
  s_add_u32 m0, s24, 9216
  s_nop 0
  global_load_lds_dwordx4 v2, s[8:9]

  s_add_u32 s8, s4, 3014656
  s_addc_u32 s9, s5, 0
  s_add_u32 m0, s24, 10240
  s_nop 0
  global_load_lds_dwordx4 v2, s[8:9]

  s_add_u32 s8, s4, 3080192
  s_addc_u32 s9, s5, 0
  s_add_u32 m0, s24, 11264
  s_nop 0
  global_load_lds_dwordx4 v2, s[8:9]

  s_waitcnt vmcnt(32)
  ds_read_b64_tr_b16 a[48:49], v3 offset:12288
  ds_read_b64_tr_b16 a[50:51], v3 offset:12800
  ds_read_b64_tr_b16 a[52:53], v3 offset:12296
  ds_read_b64_tr_b16 a[54:55], v3 offset:12808
  ds_read_b64_tr_b16 a[56:57], v3 offset:12352
  ds_read_b64_tr_b16 a[58:59], v3 offset:12864
  ds_read_b64_tr_b16 a[60:61], v3 offset:12360
  ds_read_b64_tr_b16 a[62:63], v3 offset:12872
  s_waitcnt lgkmcnt(0)

  s_add_u32 s8, s4, 3145728
  s_addc_u32 s9, s5, 0
  s_add_u32 m0, s24, 12288
  s_nop 0
  global_load_lds_dwordx4 v2, s[8:9]

  s_add_u32 s8, s4, 3211264
  s_addc_u32 s9, s5, 0
  s_add_u32 m0, s24, 13312
  s_nop 0
  global_load_lds_dwordx4 v2, s[8:9]

  s_add_u32 s8, s4, 3276800
  s_addc_u32 s9, s5, 0
  s_add_u32 m0, s24, 14336
  s_nop 0
  global_load_lds_dwordx4 v2, s[8:9]

  s_add_u32 s8, s4, 3342336
  s_addc_u32 s9, s5, 0
  s_add_u32 m0, s24, 15360
  s_nop 0
  global_load_lds_dwordx4 v2, s[8:9]

  s_waitcnt vmcnt(32)
  ds_read_b64_tr_b16 a[64:65], v3 offset:16384
  ds_read_b64_tr_b16 a[66:67], v3 offset:16896
  ds_read_b64_tr_b16 a[68:69], v3 offset:16392
  ds_read_b64_tr_b16 a[70:71], v3 offset:16904
  ds_read_b64_tr_b16 a[72:73], v3 offset:16448
  ds_read_b64_tr_b16 a[74:75], v3 offset:16960
  ds_read_b64_tr_b16 a[76:77], v3 offset:16456
  ds_read_b64_tr_b16 a[78:79], v3 offset:16968
  s_waitcnt lgkmcnt(0)

  s_add_u32 s8, s4, 3407872
  s_addc_u32 s9, s5, 0
  s_add_u32 m0, s24, 16384
  s_nop 0
  global_load_lds_dwordx4 v2, s[8:9]

  s_add_u32 s8, s4, 3473408
  s_addc_u32 s9, s5, 0
  s_add_u32 m0, s24, 17408
  s_nop 0
  global_load_lds_dwordx4 v2, s[8:9]

  s_add_u32 s8, s4, 3538944
  s_addc_u32 s9, s5, 0
  s_add_u32 m0, s24, 18432
  s_nop 0
  global_load_lds_dwordx4 v2, s[8:9]

  s_add_u32 s8, s4, 3604480
  s_addc_u32 s9, s5, 0
  s_add_u32 m0, s24, 19456
  s_nop 0
  global_load_lds_dwordx4 v2, s[8:9]

  s_waitcnt vmcnt(32)
  ds_read_b64_tr_b16 a[80:81], v3 offset:20480
  ds_read_b64_tr_b16 a[82:83], v3 offset:20992
  ds_read_b64_tr_b16 a[84:85], v3 offset:20488
  ds_read_b64_tr_b16 a[86:87], v3 offset:21000
  ds_read_b64_tr_b16 a[88:89], v3 offset:20544
  ds_read_b64_tr_b16 a[90:91], v3 offset:21056
  ds_read_b64_tr_b16 a[92:93], v3 offset:20552
  ds_read_b64_tr_b16 a[94:95], v3 offset:21064
  s_waitcnt lgkmcnt(0)

  s_add_u32 s8, s4, 3670016
  s_addc_u32 s9, s5, 0
  s_add_u32 m0, s24, 20480
  s_nop 0
  global_load_lds_dwordx4 v2, s[8:9]

  s_add_u32 s8, s4, 3735552
  s_addc_u32 s9, s5, 0
  s_add_u32 m0, s24, 21504
  s_nop 0
  global_load_lds_dwordx4 v2, s[8:9]

  s_add_u32 s8, s4, 3801088
  s_addc_u32 s9, s5, 0
  s_add_u32 m0, s24, 22528
  s_nop 0
  global_load_lds_dwordx4 v2, s[8:9]

  s_add_u32 s8, s4, 3866624
  s_addc_u32 s9, s5, 0
  s_add_u32 m0, s24, 23552
  s_nop 0
  global_load_lds_dwordx4 v2, s[8:9]

  s_waitcnt vmcnt(32)
  ds_read_b64_tr_b16 a[96:97], v3 offset:24576
  ds_read_b64_tr_b16 a[98:99], v3 offset:25088
  ds_read_b64_tr_b16 a[100:101], v3 offset:24584
  ds_read_b64_tr_b16 a[102:103], v3 offset:25096
  ds_read_b64_tr_b16 a[104:105], v3 offset:24640
  ds_read_b64_tr_b16 a[106:107], v3 offset:25152
  ds_read_b64_tr_b16 a[108:109], v3 offset:24648
  ds_read_b64_tr_b16 a[110:111], v3 offset:25160
  s_waitcnt lgkmcnt(0)

  s_add_u32 s8, s4, 3932160
  s_addc_u32 s9, s5, 0
  s_add_u32 m0, s24, 24576
  s_nop 0
  global_load_lds_dwordx4 v2, s[8:9]

  s_add_u32 s8, s4, 3997696
  s_addc_u32 s9, s5, 0
  s_add_u32 m0, s24, 25600
  s_nop 0
  global_load_lds_dwordx4 v2, s[8:9]

  s_add_u32 s8, s4, 4063232
  s_addc_u32 s9, s5, 0
  s_add_u32 m0, s24, 26624
  s_nop 0
  global_load_lds_dwordx4 v2, s[8:9]

  s_add_u32 s8, s4, 4128768
  s_addc_u32 s9, s5, 0
  s_add_u32 m0, s24, 27648
  s_nop 0
  global_load_lds_dwordx4 v2, s[8:9]

  s_waitcnt vmcnt(32)
  ds_read_b64_tr_b16 a[112:113], v3 offset:28672
  ds_read_b64_tr_b16 a[114:115], v3 offset:29184
  ds_read_b64_tr_b16 a[116:117], v3 offset:28680
  ds_read_b64_tr_b16 a[118:119], v3 offset:29192
  ds_read_b64_tr_b16 a[120:121], v3 offset:28736
  ds_read_b64_tr_b16 a[122:123], v3 offset:29248
  ds_read_b64_tr_b16 a[124:125], v3 offset:28744
  ds_read_b64_tr_b16 a[126:127], v3 offset:29256
  s_waitcnt vmcnt(28)
  ds_read_b64_tr_b16 a[128:129], v3 offset:32768
  ds_read_b64_tr_b16 a[130:131], v3 offset:33280
  ds_read_b64_tr_b16 a[132:133], v3 offset:32776
  ds_read_b64_tr_b16 a[134:135], v3 offset:33288
  ds_read_b64_tr_b16 a[136:137], v3 offset:32832
  ds_read_b64_tr_b16 a[138:139], v3 offset:33344
  ds_read_b64_tr_b16 a[140:141], v3 offset:32840
  ds_read_b64_tr_b16 a[142:143], v3 offset:33352
  s_waitcnt vmcnt(24)
  ds_read_b64_tr_b16 a[144:145], v3 offset:0
  ds_read_b64_tr_b16 a[146:147], v3 offset:512
  ds_read_b64_tr_b16 a[148:149], v3 offset:8
  ds_read_b64_tr_b16 a[150:151], v3 offset:520
  ds_read_b64_tr_b16 a[152:153], v3 offset:64
  ds_read_b64_tr_b16 a[154:155], v3 offset:576
  ds_read_b64_tr_b16 a[156:157], v3 offset:72
  ds_read_b64_tr_b16 a[158:159], v3 offset:584
  s_waitcnt vmcnt(20)
  ds_read_b64_tr_b16 a[160:161], v3 offset:4096
  ds_read_b64_tr_b16 a[162:163], v3 offset:4608
  ds_read_b64_tr_b16 a[164:165], v3 offset:4104
  ds_read_b64_tr_b16 a[166:167], v3 offset:4616
  ds_read_b64_tr_b16 a[168:169], v3 offset:4160
  ds_read_b64_tr_b16 a[170:171], v3 offset:4672
  ds_read_b64_tr_b16 a[172:173], v3 offset:4168
  ds_read_b64_tr_b16 a[174:175], v3 offset:4680
  s_waitcnt vmcnt(16)
  ds_read_b64_tr_b16 a[176:177], v3 offset:8192
  ds_read_b64_tr_b16 a[178:179], v3 offset:8704
  ds_read_b64_tr_b16 a[180:181], v3 offset:8200
  ds_read_b64_tr_b16 a[182:183], v3 offset:8712
  ds_read_b64_tr_b16 a[184:185], v3 offset:8256
  ds_read_b64_tr_b16 a[186:187], v3 offset:8768
  ds_read_b64_tr_b16 a[188:189], v3 offset:8264
  ds_read_b64_tr_b16 a[190:191], v3 offset:8776
  s_waitcnt vmcnt(12)
  ds_read_b64_tr_b16 a[192:193], v3 offset:12288
  ds_read_b64_tr_b16 a[194:195], v3 offset:12800
  ds_read_b64_tr_b16 a[196:197], v3 offset:12296
  ds_read_b64_tr_b16 a[198:199], v3 offset:12808
  ds_read_b64_tr_b16 a[200:201], v3 offset:12352
  ds_read_b64_tr_b16 a[202:203], v3 offset:12864
  ds_read_b64_tr_b16 a[204:205], v3 offset:12360
  ds_read_b64_tr_b16 a[206:207], v3 offset:12872
  s_waitcnt vmcnt(8)
  ds_read_b64_tr_b16 a[208:209], v3 offset:16384
  ds_read_b64_tr_b16 a[210:211], v3 offset:16896
  ds_read_b64_tr_b16 a[212:213], v3 offset:16392
  ds_read_b64_tr_b16 a[214:215], v3 offset:16904
  ds_read_b64_tr_b16 a[216:217], v3 offset:16448
  ds_read_b64_tr_b16 a[218:219], v3 offset:16960
  ds_read_b64_tr_b16 a[220:221], v3 offset:16456
  ds_read_b64_tr_b16 a[222:223], v3 offset:16968
  s_waitcnt vmcnt(4)
  ds_read_b64_tr_b16 a[224:225], v3 offset:20480
  ds_read_b64_tr_b16 a[226:227], v3 offset:20992
  ds_read_b64_tr_b16 a[228:229], v3 offset:20488
  ds_read_b64_tr_b16 a[230:231], v3 offset:21000
  ds_read_b64_tr_b16 a[232:233], v3 offset:20544
  ds_read_b64_tr_b16 a[234:235], v3 offset:21056
  ds_read_b64_tr_b16 a[236:237], v3 offset:20552
  ds_read_b64_tr_b16 a[238:239], v3 offset:21064
  s_waitcnt vmcnt(0)
  ds_read_b64_tr_b16 a[240:241], v3 offset:24576
  ds_read_b64_tr_b16 a[242:243], v3 offset:25088
  ds_read_b64_tr_b16 a[244:245], v3 offset:24584
  ds_read_b64_tr_b16 a[246:247], v3 offset:25096
  ds_read_b64_tr_b16 a[248:249], v3 offset:24640
  ds_read_b64_tr_b16 a[250:251], v3 offset:25152
  ds_read_b64_tr_b16 a[252:253], v3 offset:24648
  ds_read_b64_tr_b16 a[254:255], v3 offset:25160
  s_waitcnt lgkmcnt(0)
  s_barrier
  s_mov_b64 s[10:11], s[14:15]
  s_mov_b64 s[14:15], s[58:59]
  s_mov_b32 s28, 32
  s_cmp_eq_u32 s18, 0
  s_cbranch_scc0 mega_kernel_p1_1
  v_mov_b32 v2, s28
  s_mov_b32 s27, 0
mega_kernel_pl_2:
  global_load_dword v3, v2, s[14:15] sc1
  s_add_u32 s27, s27, 1
  s_cmp_gt_u32 s27, 50000000
  s_cbranch_scc1 mega_kernel_fail
  s_waitcnt vmcnt(0)
  v_readfirstlane_b32 s26, v3
  s_nop 3
  s_cmp_ge_u32 s26, 128
  s_cbranch_scc1 mega_kernel_pl_2_ok
  s_sleep 8
  s_branch mega_kernel_pl_2
mega_kernel_pl_2_ok:

mega_kernel_p1_1:
  s_barrier
  s_mov_b64 s[14:15], s[10:11]
  s_lshl_b32 s26, s18, 13
  s_mov_b32 s28, 0
  s_add_u32 s10, s28, s26
  s_add_u32 m0, s10, 0
  s_lshl_b32 s11, s37, 10
  s_add_u32 s11, s11, 0
  s_add_u32 s8, s6, s11
  s_addc_u32 s9, s7, 0
  global_load_lds_dwordx4 v1, s[8:9] sc1
  global_load_lds_dwordx4 v1, s[8:9] offset:1024 sc1
  global_load_lds_dwordx4 v1, s[8:9] offset:2048 sc1
  global_load_lds_dwordx4 v1, s[8:9] offset:3072 sc1
  s_add_u32 s10, s28, s26
  s_add_u32 m0, s10, 4096
  s_lshl_b32 s11, s37, 10
  s_add_u32 s11, s11, 4096
  s_add_u32 s8, s6, s11
  s_addc_u32 s9, s7, 0
  global_load_lds_dwordx4 v1, s[8:9] sc1
  global_load_lds_dwordx4 v1, s[8:9] offset:1024 sc1
  global_load_lds_dwordx4 v1, s[8:9] offset:2048 sc1
  global_load_lds_dwordx4 v1, s[8:9] offset:3072 sc1
  s_add_u32 s6, s6, s21
  s_addc_u32 s7, s7, 0
  s_mov_b32 s28, 32768
  s_add_u32 s10, s28, s26
  s_add_u32 m0, s10, 0
  s_lshl_b32 s11, s37, 10
  s_add_u32 s11, s11, 0
  s_add_u32 s8, s6, s11
  s_addc_u32 s9, s7, 0
  global_load_lds_dwordx4 v1, s[8:9] sc1
  global_load_lds_dwordx4 v1, s[8:9] offset:1024 sc1
  global_load_lds_dwordx4 v1, s[8:9] offset:2048 sc1
  global_load_lds_dwordx4 v1, s[8:9] offset:3072 sc1
  s_add_u32 s10, s28, s26
  s_add_u32 m0, s10, 4096
  s_lshl_b32 s11, s37, 10
  s_add_u32 s11, s11, 4096
  s_add_u32 s8, s6, s11
  s_addc_u32 s9, s7, 0
  global_load_lds_dwordx4 v1, s[8:9] sc1
  global_load_lds_dwordx4 v1, s[8:9] offset:1024 sc1
  global_load_lds_dwordx4 v1, s[8:9] offset:2048 sc1
  global_load_lds_dwordx4 v1, s[8:9] offset:3072 sc1
  s_add_u32 s6, s6, s21
  s_addc_u32 s7, s7, 0
  s_mov_b32 s19, 0
  s_mov_b32 s29, 0
  s_mov_b32 s28, 65536
  v_add_u32 v4, 4096, v1
  s_add_u32 s27, s19, 1
  s_cmp_lt_u32 s27, s20
  s_cbranch_scc1 mega_kernel_qk_b0_w1
  s_waitcnt vmcnt(0)
mega_kernel_qk_b0_w1:
  s_cmp_lt_u32 s19, 3
  s_cbranch_scc0 mega_kernel_qk_b0_w2
  s_waitcnt vmcnt(8)
mega_kernel_qk_b0_w2:
  s_waitcnt vmcnt(12)
  s_barrier
  s_add_u32 s27, s18, s16
  s_lshl_b32 s27, s27, 8
  s_add_u32 s27, s27, s19
  s_mov_b32 s10, 1664
  s_cmp_eq_u32 s27, 5
  s_cbranch_scc1 mega_kernel_qk_b0_ye
  s_mov_b32 s10, s35
  s_cmp_eq_u32 s27, 1
  s_cbranch_scc0 mega_kernel_qk_b0_ne
mega_kernel_qk_b0_ye:
  v_mov_b32 v5, s10
  v_mov_b32 v6, 1
  v_cmp_eq_u32 vcc, 0, v0
  s_and_saveexec_b64 s[62:63], vcc
  global_atomic_add v5, v6, s[14:15]
  s_mov_b64 exec, s[62:63]
mega_kernel_qk_b0_ne:
  v_add_u32 v5, s29, v1

  ds_read_b128 v[8:11], v5 offset:0
  ds_read_b128 v[12:15], v5 offset:16384
  ds_read_b128 v[16:19], v5 offset:1024
  ds_read_b128 v[20:23], v5 offset:17408
  ds_read_b128 v[24:27], v5 offset:2048
  ds_read_b128 v[28:31], v5 offset:18432
  s_waitcnt lgkmcnt(4)
  v_mfma_f32_16x16x32_bf16 v[40:43], a[0:3], v[8:11], 0
  ds_read_b128 v[32:35], v5 offset:3072
  ds_read_b128 v[36:39], v5 offset:19456
  v_mfma_f32_16x16x32_bf16 v[44:47], a[4:7], v[8:11], 0
  v_mfma_f32_16x16x32_bf16 v[48:51], a[8:11], v[8:11], 0
  v_mfma_f32_16x16x32_bf16 v[52:55], a[12:15], v[8:11], 0
  v_mfma_f32_16x16x32_bf16 v[56:59], a[0:3], v[12:15], 0
  v_mfma_f32_16x16x32_bf16 v[60:63], a[4:7], v[12:15], 0
  v_mfma_f32_16x16x32_bf16 v[64:67], a[8:11], v[12:15], 0
  v_mfma_f32_16x16x32_bf16 v[68:71], a[12:15], v[12:15], 0
  s_waitcnt lgkmcnt(4)
  v_mfma_f32_16x16x32_bf16 v[40:43], a[16:19], v[16:19], v[40:43]
  ds_read_b128 v[8:11], v5 offset:4096
  ds_read_b128 v[12:15], v5 offset:20480
  v_mfma_f32_16x16x32_bf16 v[44:47], a[20:23], v[16:19], v[44:47]
  v_mfma_f32_16x16x32_bf16 v[48:51], a[24:27], v[16:19], v[48:51]
  v_mfma_f32_16x16x32_bf16 v[52:55], a[28:31], v[16:19], v[52:55]
  v_mfma_f32_16x16x32_bf16 v[56:59], a[16:19], v[20:23], v[56:59]
  v_mfma_f32_16x16x32_bf16 v[60:63], a[20:23], v[20:23], v[60:63]
  v_mfma_f32_16x16x32_bf16 v[64:67], a[24:27], v[20:23], v[64:67]
  v_mfma_f32_16x16x32_bf16 v[68:71], a[28:31], v[20:23], v[68:71]
  s_waitcnt lgkmcnt(4)
  v_mfma_f32_16x16x32_bf16 v[40:43], a[32:35], v[24:27], v[40:43]
  ds_read_b128 v[16:19], v5 offset:5120
  ds_read_b128 v[20:23], v5 offset:21504
  v_mfma_f32_16x16x32_bf16 v[44:47], a[36:39], v[24:27], v[44:47]
  v_mfma_f32_16x16x32_bf16 v[48:51], a[40:43], v[24:27], v[48:51]
  v_mfma_f32_16x16x32_bf16 v[52:55], a[44:47], v[24:27], v[52:55]
  v_mfma_f32_16x16x32_bf16 v[56:59], a[32:35], v[28:31], v[56:59]
  v_mfma_f32_16x16x32_bf16 v[60:63], a[36:39], v[28:31], v[60:63]
  v_mfma_f32_16x16x32_bf16 v[64:67], a[40:43], v[28:31], v[64:67]
  v_mfma_f32_16x16x32_bf16 v[68:71], a[44:47], v[28:31], v[68:71]
  s_waitcnt lgkmcnt(4)
  v_mfma_f32_16x16x32_bf16 v[40:43], a[48:51], v[32:35], v[40:43]
  ds_read_b128 v[24:27], v5 offset:6144
  ds_read_b128 v[28:31], v5 offset:22528
  v_mfma_f32_16x16x32_bf16 v[44:47], a[52:55], v[32:35], v[44:47]
  v_mfma_f32_16x16x32_bf16 v[48:51], a[56:59], v[32:35], v[48:51]
  v_mfma_f32_16x16x32_bf16 v[52:55], a[60:63], v[32:35], v[52:55]
  v_mfma_f32_16x16x32_bf16 v[56:59], a[48:51], v[36:39], v[56:59]
  v_mfma_f32_16x16x32_bf16 v[60:63], a[52:55], v[36:39], v[60:63]
  v_mfma_f32_16x16x32_bf16 v[64:67], a[56:59], v[36:39], v[64:67]
  v_mfma_f32_16x16x32_bf16 v[68:71], a[60:63], v[36:39], v[68:71]
  s_waitcnt lgkmcnt(4)
  v_mfma_f32_16x16x32_bf16 v[40:43], a[64:67], v[8:11], v[40:43]
  ds_read_b128 v[32:35], v5 offset:7168
  ds_read_b128 v[36:39], v5 offset:23552
  v_mfma_f32_16x16x32_bf16 v[44:47], a[68:71], v[8:11], v[44:47]
  v_mfma_f32_16x16x32_bf16 v[48:51], a[72:75], v[8:11], v[48:51]
  v_mfma_f32_16x16x32_bf16 v[52:55], a[76:79], v[8:11], v[52:55]
  v_mfma_f32_16x16x32_bf16 v[56:59], a[64:67], v[12:15], v[56:59]
  v_mfma_f32_16x16x32_bf16 v[60:63], a[68:71], v[12:15], v[60:63]
  v_mfma_f32_16x16x32_bf16 v[64:67], a[72:75], v[12:15], v[64:67]
  v_mfma_f32_16x16x32_bf16 v[68:71], a[76:79], v[12:15], v[68:71]
  s_waitcnt lgkmcnt(4)
  v_mfma_f32_16x16x32_bf16 v[40:43], a[80:83], v[16:19], v[40:43]
  ds_read_b128 v[8:11], v5 offset:8192
  ds_read_b128 v[12:15], v5 offset:24576
  v_mfma_f32_16x16x32_bf16 v[44:47], a[84:87], v[16:19], v[44:47]
  v_mfma_f32_16x16x32_bf16 v[48:51], a[88:91], v[16:19], v[48:51]
  v_mfma_f32_16x16x32_bf16 v[52:55], a[92:95], v[16:19], v[52:55]
  v_mfma_f32_16x16x32_bf16 v[56:59], a[80:83], v[20:23], v[56:59]
  v_mfma_f32_16x16x32_bf16 v[60:63], a[84:87], v[20:23], v[60:63]
  v_mfma_f32_16x16x32_bf16 v[64:67], a[88:91], v[20:23], v[64:67]
  v_mfma_f32_16x16x32_bf16 v[68:71], a[92:95], v[20:23], v[68:71]
  s_add_u32 s27, s19, 2
  s_cmp_lt_u32 s27, s20
  s_cbranch_scc0 mega_kernel_qk_b0_nd
  s_add_u32 s10, s28, s26
  s_add_u32 m0, s10, 0
  s_lshl_b32 s11, s37, 10
  s_add_u32 s11, s11, 0
  s_add_u32 s8, s6, s11
  s_addc_u32 s9, s7, 0
  global_load_lds_dwordx4 v1, s[8:9] sc1
  global_load_lds_dwordx4 v1, s[8:9] offset:1024 sc1
  global_load_lds_dwordx4 v1, s[8:9] offset:2048 sc1
  global_load_lds_dwordx4 v1, s[8:9] offset:3072 sc1
  s_add_u32 s10, s28, s26
  s_add_u32 m0, s10, 4096
  s_lshl_b32 s11, s37, 10
  s_add_u32 s11, s11, 4096
  s_add_u32 s8, s6, s11
  s_addc_u32 s9, s7, 0
  global_load_lds_dwordx4 v1, s[8:9] sc1
  global_load_lds_dwordx4 v1, s[8:9] offset:1024 sc1
  global_load_lds_dwordx4 v1, s[8:9] offset:2048 sc1
  global_load_lds_dwordx4 v1, s[8:9] offset:3072 sc1
  s_add_u32 s6, s6, s21
  s_addc_u32 s7, s7, 0
mega_kernel_qk_b0_nd:
  s_waitcnt lgkmcnt(4)
  v_mfma_f32_16x16x32_bf16 v[40:43], a[96:99], v[24:27], v[40:43]
  ds_read_b128 v[16:19], v5 offset:9216
  ds_read_b128 v[20:23], v5 offset:25600
  v_mfma_f32_16x16x32_bf16 v[44:47], a[100:103], v[24:27], v[44:47]
  v_mfma_f32_16x16x32_bf16 v[48:51], a[104:107], v[24:27], v[48:51]
  v_mfma_f32_16x16x32_bf16 v[52:55], a[108:111], v[24:27], v[52:55]
  v_mfma_f32_16x16x32_bf16 v[56:59], a[96:99], v[28:31], v[56:59]
  v_mfma_f32_16x16x32_bf16 v[60:63], a[100:103], v[28:31], v[60:63]
  v_mfma_f32_16x16x32_bf16 v[64:67], a[104:107], v[28:31], v[64:67]
  v_mfma_f32_16x16x32_bf16 v[68:71], a[108:111], v[28:31], v[68:71]
  s_waitcnt lgkmcnt(4)
  v_mfma_f32_16x16x32_bf16 v[40:43], a[112:115], v[32:35], v[40:43]
  ds_read_b128 v[24:27], v5 offset:10240
  ds_read_b128 v[28:31], v5 offset:26624
  v_mfma_f32_16x16x32_bf16 v[44:47], a[116:119], v[32:35], v[44:47]
  v_mfma_f32_16x16x32_bf16 v[48:51], a[120:123], v[32:35], v[48:51]
  v_mfma_f32_16x16x32_bf16 v[52:55], a[124:127], v[32:35], v[52:55]
  v_mfma_f32_16x16x32_bf16 v[56:59], a[112:115], v[36:39], v[56:59]
  v_mfma_f32_16x16x32_bf16 v[60:63], a[116:119], v[36:39], v[60:63]
  v_mfma_f32_16x16x32_bf16 v[64:67], a[120:123], v[36:39], v[64:67]
  v_mfma_f32_16x16x32_bf16 v[68:71], a[124:127], v[36:39], v[68:71]
  s_waitcnt lgkmcnt(4)
  v_mfma_f32_16x16x32_bf16 v[40:43], a[128:131], v[8:11], v[40:43]
  ds_read_b128 v[32:35], v5 offset:11264
  ds_read_b128 v[36:39], v5 offset:27648
  v_mfma_f32_16x16x32_bf16 v[44:47], a[132:135], v[8:11], v[44:47]
  v_mfma_f32_16x16x32_bf16 v[48:51], a[136:139], v[8:11], v[48:51]
  v_mfma_f32_16x16x32_bf16 v[52:55], a[140:143], v[8:11], v[52:55]
  v_mfma_f32_16x16x32_bf16 v[56:59], a[128:131], v[12:15], v[56:59]
  v_mfma_f32_16x16x32_bf16 v[60:63], a[132:135], v[12:15], v[60:63]
  v_mfma_f32_16x16x32_bf16 v[64:67], a[136:139], v[12:15], v[64:67]
  v_mfma_f32_16x16x32_bf16 v[68:71], a[140:143], v[12:15], v[68:71]
  s_waitcnt lgkmcnt(4)
  v_mfma_f32_16x16x32_bf16 v[40:43], a[144:147], v[16:19], v[40:43]
  ds_read_b128 v[8:11], v5 offset:12288
  ds_read_b128 v[12:15], v5 offset:28672
  v_mfma_f32_16x16x32_bf16 v[44:47], a[148:151], v[16:19], v[44:47]
  v_mfma_f32_16x16x32_bf16 v[48:51], a[152:155], v[16:19], v[48:51]
  v_mfma_f32_16x16x32_bf16 v[52:55], a[156:159], v[16:19], v[52:55]
  v_mfma_f32_16x16x32_bf16 v[56:59], a[144:147], v[20:23], v[56:59]
  v_mfma_f32_16x16x32_bf16 v[60:63], a[148:151], v[20:23], v[60:63]
  v_mfma_f32_16x16x32_bf16 v[64:67], a[152:155], v[20:23], v[64:67]
  v_mfma_f32_16x16x32_bf16 v[68:71], a[156:159], v[20:23], v[68:71]
  s_waitcnt lgkmcnt(4)
  v_mfma_f32_16x16x32_bf16 v[40:43], a[160:163], v[24:27], v[40:43]
  ds_read_b128 v[16:19], v5 offset:13312
  ds_read_b128 v[20:23], v5 offset:29696
  v_mfma_f32_16x16x32_bf16 v[44:47], a[164:167], v[24:27], v[44:47]
  v_mfma_f32_16x16x32_bf16 v[48:51], a[168:171], v[24:27], v[48:51]
  v_mfma_f32_16x16x32_bf16 v[52:55], a[172:175], v[24:27], v[52:55]
  v_mfma_f32_16x16x32_bf16 v[56:59], a[160:163], v[28:31], v[56:59]
  v_mfma_f32_16x16x32_bf16 v[60:63], a[164:167], v[28:31], v[60:63]
  v_mfma_f32_16x16x32_bf16 v[64:67], a[168:171], v[28:31], v[64:67]
  v_mfma_f32_16x16x32_bf16 v[68:71], a[172:175], v[28:31], v[68:71]
  s_waitcnt lgkmcnt(4)
  v_mfma_f32_16x16x32_bf16 v[40:43], a[176:179], v[32:35], v[40:43]
  ds_read_b128 v[24:27], v5 offset:14336
  ds_read_b128 v[28:31], v5 offset:30720
  v_mfma_f32_16x16x32_bf16 v[44:47], a[180:183], v[32:35], v[44:47]
  v_mfma_f32_16x16x32_bf16 v[48:51], a[184:187], v[32:35], v[48:51]
  v_mfma_f32_16x16x32_bf16 v[52:55], a[188:191], v[32:35], v[52:55]
  v_mfma_f32_16x16x32_bf16 v[56:59], a[176:179], v[36:39], v[56:59]
  v_mfma_f32_16x16x32_bf16 v[60:63], a[180:183], v[36:39], v[60:63]
  v_mfma_f32_16x16x32_bf16 v[64:67], a[184:187], v[36:39], v[64:67]
  v_mfma_f32_16x16x32_bf16 v[68:71], a[188:191], v[36:39], v[68:71]
  s_waitcnt lgkmcnt(4)
  v_mfma_f32_16x16x32_bf16 v[40:43], a[192:195], v[8:11], v[40:43]
  ds_read_b128 v[32:35], v5 offset:15360
  ds_read_b128 v[36:39], v5 offset:31744
  v_mfma_f32_16x16x32_bf16 v[44:47], a[196:199], v[8:11], v[44:47]
  v_mfma_f32_16x16x32_bf16 v[48:51], a[200:203], v[8:11], v[48:51]
  v_mfma_f32_16x16x32_bf16 v[52:55], a[204:207], v[8:11], v[52:55]
  v_mfma_f32_16x16x32_bf16 v[56:59], a[192:195], v[12:15], v[56:59]
  v_mfma_f32_16x16x32_bf16 v[60:63], a[196:199], v[12:15], v[60:63]
  v_mfma_f32_16x16x32_bf16 v[64:67], a[200:203], v[12:15], v[64:67]
  v_mfma_f32_16x16x32_bf16 v[68:71], a[204:207], v[12:15], v[68:71]
  s_waitcnt lgkmcnt(4)
  v_mfma_f32_16x16x32_bf16 v[40:43], a[208:211], v[16:19], v[40:43]
  v_mfma_f32_16x16x32_bf16 v[44:47], a[212:215], v[16:19], v[44:47]
  v_mfma_f32_16x16x32_bf16 v[48:51], a[216:219], v[16:19], v[48:51]
  v_mfma_f32_16x16x32_bf16 v[52:55], a[220:223], v[16:19], v[52:55]
  v_mfma_f32_16x16x32_bf16 v[56:59], a[208:211], v[20:23], v[56:59]
  v_mfma_f32_16x16x32_bf16 v[60:63], a[212:215], v[20:23], v[60:63]
  v_mfma_f32_16x16x32_bf16 v[64:67], a[216:219], v[20:23], v[64:67]
  v_mfma_f32_16x16x32_bf16 v[68:71], a[220:223], v[20:23], v[68:71]
  s_waitcnt lgkmcnt(2)
  v_mfma_f32_16x16x32_bf16 v[40:43], a[224:227], v[24:27], v[40:43]
  v_mfma_f32_16x16x32_bf16 v[44:47], a[228:231], v[24:27], v[44:47]
  v_mfma_f32_16x16x32_bf16 v[48:51], a[232:235], v[24:27], v[48:51]
  v_mfma_f32_16x16x32_bf16 v[52:55], a[236:239], v[24:27], v[52:55]
  v_mfma_f32_16x16x32_bf16 v[56:59], a[224:227], v[28:31], v[56:59]
  v_mfma_f32_16x16x32_bf16 v[60:63], a[228:231], v[28:31], v[60:63]
  v_mfma_f32_16x16x32_bf16 v[64:67], a[232:235], v[28:31], v[64:67]
  v_mfma_f32_16x16x32_bf16 v[68:71], a[236:239], v[28:31], v[68:71]
  s_waitcnt lgkmcnt(0)
  v_mfma_f32_16x16x32_bf16 v[40:43], a[240:243], v[32:35], v[40:43]
  v_mfma_f32_16x16x32_bf16 v[44:47], a[244:247], v[32:35], v[44:47]
  v_mfma_f32_16x16x32_bf16 v[48:51], a[248:251], v[32:35], v[48:51]
  v_mfma_f32_16x16x32_bf16 v[52:55], a[252:255], v[32:35], v[52:55]
  v_mfma_f32_16x16x32_bf16 v[56:59], a[240:243], v[36:39], v[56:59]
  v_mfma_f32_16x16x32_bf16 v[60:63], a[244:247], v[36:39], v[60:63]
  v_mfma_f32_16x16x32_bf16 v[64:67], a[248:251], v[36:39], v[64:67]
  v_mfma_f32_16x16x32_bf16 v[68:71], a[252:255], v[36:39], v[68:71]
  s_add_u32 s29, s29, 32768
  s_cmp_eq_u32 s29, 98304
  s_cselect_b32 s29, 0, s29
  s_add_u32 s28, s28, 32768
  s_cmp_eq_u32 s28, 98304
  s_cselect_b32 s28, 0, s28
  s_add_u32 s19, s19, 1
  s_cmp_ge_u32 s19, s20

  s_nop 7
  v_cvt_pk_bf16_f32 v104, v40, v41
  v_cvt_pk_bf16_f32 v105, v42, v43
  v_cvt_pk_bf16_f32 v106, v44, v45
  v_cvt_pk_bf16_f32 v107, v46, v47
  global_store_dwordx4 v1, v[104:107], s[22:23] offset:0 sc1
  v_cvt_pk_bf16_f32 v108, v48, v49
  v_cvt_pk_bf16_f32 v109, v50, v51
  v_cvt_pk_bf16_f32 v110, v52, v53
  v_cvt_pk_bf16_f32 v111, v54, v55
  global_store_dwordx4 v1, v[108:111], s[22:23] offset:1024 sc1
  v_cvt_pk_bf16_f32 v104, v56, v57
  v_cvt_pk_bf16_f32 v105, v58, v59
  v_cvt_pk_bf16_f32 v106, v60, v61
  v_cvt_pk_bf16_f32 v107, v62, v63
  global_store_dwordx4 v4, v[104:107], s[22:23] offset:0 sc1
  v_cvt_pk_bf16_f32 v108, v64, v65
  v_cvt_pk_bf16_f32 v109, v66, v67
  v_cvt_pk_bf16_f32 v110, v68, v69
  v_cvt_pk_bf16_f32 v111, v70, v71
  global_store_dwordx4 v4, v[108:111], s[22:23] offset:1024 sc1
  s_add_u32 s22, s22, s25
  s_addc_u32 s23, s23, 0
  s_waitcnt vmcnt(0)
  s_add_u32 s27, s19, 1
  s_cmp_lt_u32 s27, s20
  s_cbranch_scc1 mega_kernel_qk_bx_w1
  s_waitcnt vmcnt(0)
mega_kernel_qk_bx_w1:
  s_cmp_lt_u32 s19, 3
  s_cbranch_scc0 mega_kernel_qk_bx_w2
  s_waitcnt vmcnt(8)
mega_kernel_qk_bx_w2:
  s_waitcnt vmcnt(12)
  s_barrier
  s_add_u32 s27, s18, s16
  s_lshl_b32 s27, s27, 8
  s_add_u32 s27, s27, s19
  s_mov_b32 s10, 1664
  s_cmp_eq_u32 s27, 5
  s_cbranch_scc1 mega_kernel_qk_bx_ye
  s_mov_b32 s10, s35
  s_cmp_eq_u32 s27, 1
  s_cbranch_scc0 mega_kernel_qk_bx_ne
mega_kernel_qk_bx_ye:
  v_mov_b32 v5, s10
  v_mov_b32 v6, 1
  v_cmp_eq_u32 vcc, 0, v0
  s_and_saveexec_b64 s[62:63], vcc
  global_atomic_add v5, v6, s[14:15]
  s_mov_b64 exec, s[62:63]
mega_kernel_qk_bx_ne:
  v_add_u32 v5, s29, v1

  ds_read_b128 v[8:11], v5 offset:0
  ds_read_b128 v[12:15], v5 offset:16384
  ds_read_b128 v[16:19], v5 offset:1024
  ds_read_b128 v[20:23], v5 offset:17408
  ds_read_b128 v[24:27], v5 offset:2048
  ds_read_b128 v[28:31], v5 offset:18432
  s_waitcnt lgkmcnt(4)
  v_mfma_f32_16x16x32_bf16 v[72:75], a[0:3], v[8:11], 0
  ds_read_b128 v[32:35], v5 offset:3072
  ds_read_b128 v[36:39], v5 offset:19456
  v_mfma_f32_16x16x32_bf16 v[76:79], a[4:7], v[8:11], 0
  v_mfma_f32_16x16x32_bf16 v[80:83], a[8:11], v[8:11], 0
  v_mfma_f32_16x16x32_bf16 v[84:87], a[12:15], v[8:11], 0
  v_mfma_f32_16x16x32_bf16 v[88:91], a[0:3], v[12:15], 0
  v_mfma_f32_16x16x32_bf16 v[92:95], a[4:7], v[12:15], 0
  v_mfma_f32_16x16x32_bf16 v[96:99], a[8:11], v[12:15], 0
  v_mfma_f32_16x16x32_bf16 v[100:103], a[12:15], v[12:15], 0
  s_waitcnt lgkmcnt(4)
  v_mfma_f32_16x16x32_bf16 v[72:75], a[16:19], v[16:19], v[72:75]
  ds_read_b128 v[8:11], v5 offset:4096
  ds_read_b128 v[12:15], v5 offset:20480
  v_mfma_f32_16x16x32_bf16 v[76:79], a[20:23], v[16:19], v[76:79]
  v_mfma_f32_16x16x32_bf16 v[80:83], a[24:27], v[16:19], v[80:83]
  v_mfma_f32_16x16x32_bf16 v[84:87], a[28:31], v[16:19], v[84:87]
  v_mfma_f32_16x16x32_bf16 v[88:91], a[16:19], v[20:23], v[88:91]
  v_mfma_f32_16x16x32_bf16 v[92:95], a[20:23], v[20:23], v[92:95]
  v_mfma_f32_16x16x32_bf16 v[96:99], a[24:27], v[20:23], v[96:99]
  v_mfma_f32_16x16x32_bf16 v[100:103], a[28:31], v[20:23], v[100:103]
  s_waitcnt lgkmcnt(4)
  v_mfma_f32_16x16x32_bf16 v[72:75], a[32:35], v[24:27], v[72:75]
  ds_read_b128 v[16:19], v5 offset:5120
  ds_read_b128 v[20:23], v5 offset:21504
  v_mfma_f32_16x16x32_bf16 v[76:79], a[36:39], v[24:27], v[76:79]
  v_mfma_f32_16x16x32_bf16 v[80:83], a[40:43], v[24:27], v[80:83]
  v_mfma_f32_16x16x32_bf16 v[84:87], a[44:47], v[24:27], v[84:87]
  v_mfma_f32_16x16x32_bf16 v[88:91], a[32:35], v[28:31], v[88:91]
  v_mfma_f32_16x16x32_bf16 v[92:95], a[36:39], v[28:31], v[92:95]
  v_mfma_f32_16x16x32_bf16 v[96:99], a[40:43], v[28:31], v[96:99]
  v_mfma_f32_16x16x32_bf16 v[100:103], a[44:47], v[28:31], v[100:103]
  s_waitcnt lgkmcnt(4)
  v_mfma_f32_16x16x32_bf16 v[72:75], a[48:51], v[32:35], v[72:75]
  ds_read_b128 v[24:27], v5 offset:6144
  ds_read_b128 v[28:31], v5 offset:22528
  v_mfma_f32_16x16x32_bf16 v[76:79], a[52:55], v[32:35], v[76:79]
  v_mfma_f32_16x16x32_bf16 v[80:83], a[56:59], v[32:35], v[80:83]
  v_mfma_f32_16x16x32_bf16 v[84:87], a[60:63], v[32:35], v[84:87]
  v_mfma_f32_16x16x32_bf16 v[88:91], a[48:51], v[36:39], v[88:91]
  v_mfma_f32_16x16x32_bf16 v[92:95], a[52:55], v[36:39], v[92:95]
  v_mfma_f32_16x16x32_bf16 v[96:99], a[56:59], v[36:39], v[96:99]
  v_mfma_f32_16x16x32_bf16 v[100:103], a[60:63], v[36:39], v[100:103]
  s_waitcnt lgkmcnt(4)
  v_mfma_f32_16x16x32_bf16 v[72:75], a[64:67], v[8:11], v[72:75]
  ds_read_b128 v[32:35], v5 offset:7168
  ds_read_b128 v[36:39], v5 offset:23552
  v_mfma_f32_16x16x32_bf16 v[76:79], a[68:71], v[8:11], v[76:79]
  v_mfma_f32_16x16x32_bf16 v[80:83], a[72:75], v[8:11], v[80:83]
  v_mfma_f32_16x16x32_bf16 v[84:87], a[76:79], v[8:11], v[84:87]
  v_mfma_f32_16x16x32_bf16 v[88:91], a[64:67], v[12:15], v[88:91]
  v_mfma_f32_16x16x32_bf16 v[92:95], a[68:71], v[12:15], v[92:95]
  v_mfma_f32_16x16x32_bf16 v[96:99], a[72:75], v[12:15], v[96:99]
  v_mfma_f32_16x16x32_bf16 v[100:103], a[76:79], v[12:15], v[100:103]
  s_waitcnt lgkmcnt(4)
  v_mfma_f32_16x16x32_bf16 v[72:75], a[80:83], v[16:19], v[72:75]
  ds_read_b128 v[8:11], v5 offset:8192
  ds_read_b128 v[12:15], v5 offset:24576
  v_mfma_f32_16x16x32_bf16 v[76:79], a[84:87], v[16:19], v[76:79]
  v_mfma_f32_16x16x32_bf16 v[80:83], a[88:91], v[16:19], v[80:83]
  v_mfma_f32_16x16x32_bf16 v[84:87], a[92:95], v[16:19], v[84:87]
  v_mfma_f32_16x16x32_bf16 v[88:91], a[80:83], v[20:23], v[88:91]
  v_mfma_f32_16x16x32_bf16 v[92:95], a[84:87], v[20:23], v[92:95]
  v_mfma_f32_16x16x32_bf16 v[96:99], a[88:91], v[20:23], v[96:99]
  v_mfma_f32_16x16x32_bf16 v[100:103], a[92:95], v[20:23], v[100:103]
  s_add_u32 s27, s19, 2
  s_cmp_lt_u32 s27, s20
  s_cbranch_scc0 mega_kernel_qk_bx_nd
  s_add_u32 s10, s28, s26
  s_add_u32 m0, s10, 0
  s_lshl_b32 s11, s37, 10
  s_add_u32 s11, s11, 0
  s_add_u32 s8, s6, s11
  s_addc_u32 s9, s7, 0
  global_load_lds_dwordx4 v1, s[8:9] sc1
  global_load_lds_dwordx4 v1, s[8:9] offset:1024 sc1
  global_load_lds_dwordx4 v1, s[8:9] offset:2048 sc1
  global_load_lds_dwordx4 v1, s[8:9] offset:3072 sc1
  s_add_u32 s10, s28, s26
  s_add_u32 m0, s10, 4096
  s_lshl_b32 s11, s37, 10
  s_add_u32 s11, s11, 4096
  s_add_u32 s8, s6, s11
  s_addc_u32 s9, s7, 0
  global_load_lds_dwordx4 v1, s[8:9] sc1
  global_load_lds_dwordx4 v1, s[8:9] offset:1024 sc1
  global_load_lds_dwordx4 v1, s[8:9] offset:2048 sc1
  global_load_lds_dwordx4 v1, s[8:9] offset:3072 sc1
  s_add_u32 s6, s6, s21
  s_addc_u32 s7, s7, 0
mega_kernel_qk_bx_nd:
  s_waitcnt lgkmcnt(4)
  v_mfma_f32_16x16x32_bf16 v[72:75], a[96:99], v[24:27], v[72:75]
  ds_read_b128 v[16:19], v5 offset:9216
  ds_read_b128 v[20:23], v5 offset:25600
  v_mfma_f32_16x16x32_bf16 v[76:79], a[100:103], v[24:27], v[76:79]
  v_mfma_f32_16x16x32_bf16 v[80:83], a[104:107], v[24:27], v[80:83]
  v_mfma_f32_16x16x32_bf16 v[84:87], a[108:111], v[24:27], v[84:87]
  v_mfma_f32_16x16x32_bf16 v[88:91], a[96:99], v[28:31], v[88:91]
  v_mfma_f32_16x16x32_bf16 v[92:95], a[100:103], v[28:31], v[92:95]
  v_mfma_f32_16x16x32_bf16 v[96:99], a[104:107], v[28:31], v[96:99]
  v_mfma_f32_16x16x32_bf16 v[100:103], a[108:111], v[28:31], v[100:103]
  s_waitcnt lgkmcnt(4)
  v_mfma_f32_16x16x32_bf16 v[72:75], a[112:115], v[32:35], v[72:75]
  ds_read_b128 v[24:27], v5 offset:10240
  ds_read_b128 v[28:31], v5 offset:26624
  v_mfma_f32_16x16x32_bf16 v[76:79], a[116:119], v[32:35], v[76:79]
  v_mfma_f32_16x16x32_bf16 v[80:83], a[120:123], v[32:35], v[80:83]
  v_mfma_f32_16x16x32_bf16 v[84:87], a[124:127], v[32:35], v[84:87]
  v_mfma_f32_16x16x32_bf16 v[88:91], a[112:115], v[36:39], v[88:91]
  v_mfma_f32_16x16x32_bf16 v[92:95], a[116:119], v[36:39], v[92:95]
  v_mfma_f32_16x16x32_bf16 v[96:99], a[120:123], v[36:39], v[96:99]
  v_mfma_f32_16x16x32_bf16 v[100:103], a[124:127], v[36:39], v[100:103]
  s_waitcnt lgkmcnt(4)
  v_mfma_f32_16x16x32_bf16 v[72:75], a[128:131], v[8:11], v[72:75]
  ds_read_b128 v[32:35], v5 offset:11264
  ds_read_b128 v[36:39], v5 offset:27648
  v_mfma_f32_16x16x32_bf16 v[76:79], a[132:135], v[8:11], v[76:79]
  v_mfma_f32_16x16x32_bf16 v[80:83], a[136:139], v[8:11], v[80:83]
  v_mfma_f32_16x16x32_bf16 v[84:87], a[140:143], v[8:11], v[84:87]
  v_mfma_f32_16x16x32_bf16 v[88:91], a[128:131], v[12:15], v[88:91]
  v_mfma_f32_16x16x32_bf16 v[92:95], a[132:135], v[12:15], v[92:95]
  v_mfma_f32_16x16x32_bf16 v[96:99], a[136:139], v[12:15], v[96:99]
  v_mfma_f32_16x16x32_bf16 v[100:103], a[140:143], v[12:15], v[100:103]
  s_waitcnt lgkmcnt(4)
  v_mfma_f32_16x16x32_bf16 v[72:75], a[144:147], v[16:19], v[72:75]
  ds_read_b128 v[8:11], v5 offset:12288
  ds_read_b128 v[12:15], v5 offset:28672
  v_mfma_f32_16x16x32_bf16 v[76:79], a[148:151], v[16:19], v[76:79]
  v_mfma_f32_16x16x32_bf16 v[80:83], a[152:155], v[16:19], v[80:83]
  v_mfma_f32_16x16x32_bf16 v[84:87], a[156:159], v[16:19], v[84:87]
  v_mfma_f32_16x16x32_bf16 v[88:91], a[144:147], v[20:23], v[88:91]
  v_mfma_f32_16x16x32_bf16 v[92:95], a[148:151], v[20:23], v[92:95]
  v_mfma_f32_16x16x32_bf16 v[96:99], a[152:155], v[20:23], v[96:99]
  v_mfma_f32_16x16x32_bf16 v[100:103], a[156:159], v[20:23], v[100:103]
  s_waitcnt lgkmcnt(4)
  v_mfma_f32_16x16x32_bf16 v[72:75], a[160:163], v[24:27], v[72:75]
  ds_read_b128 v[16:19], v5 offset:13312
  ds_read_b128 v[20:23], v5 offset:29696
  v_mfma_f32_16x16x32_bf16 v[76:79], a[164:167], v[24:27], v[76:79]
  v_mfma_f32_16x16x32_bf16 v[80:83], a[168:171], v[24:27], v[80:83]
  v_mfma_f32_16x16x32_bf16 v[84:87], a[172:175], v[24:27], v[84:87]
  v_mfma_f32_16x16x32_bf16 v[88:91], a[160:163], v[28:31], v[88:91]
  v_mfma_f32_16x16x32_bf16 v[92:95], a[164:167], v[28:31], v[92:95]
  v_mfma_f32_16x16x32_bf16 v[96:99], a[168:171], v[28:31], v[96:99]
  v_mfma_f32_16x16x32_bf16 v[100:103], a[172:175], v[28:31], v[100:103]
  s_waitcnt lgkmcnt(4)
  v_mfma_f32_16x16x32_bf16 v[72:75], a[176:179], v[32:35], v[72:75]
  ds_read_b128 v[24:27], v5 offset:14336
  ds_read_b128 v[28:31], v5 offset:30720
  v_mfma_f32_16x16x32_bf16 v[76:79], a[180:183], v[32:35], v[76:79]
  v_mfma_f32_16x16x32_bf16 v[80:83], a[184:187], v[32:35], v[80:83]
  v_mfma_f32_16x16x32_bf16 v[84:87], a[188:191], v[32:35], v[84:87]
  v_mfma_f32_16x16x32_bf16 v[88:91], a[176:179], v[36:39], v[88:91]
  v_mfma_f32_16x16x32_bf16 v[92:95], a[180:183], v[36:39], v[92:95]
  v_mfma_f32_16x16x32_bf16 v[96:99], a[184:187], v[36:39], v[96:99]
  v_mfma_f32_16x16x32_bf16 v[100:103], a[188:191], v[36:39], v[100:103]
  s_waitcnt lgkmcnt(4)
  v_mfma_f32_16x16x32_bf16 v[72:75], a[192:195], v[8:11], v[72:75]
  ds_read_b128 v[32:35], v5 offset:15360
  ds_read_b128 v[36:39], v5 offset:31744
  v_mfma_f32_16x16x32_bf16 v[76:79], a[196:199], v[8:11], v[76:79]
  v_mfma_f32_16x16x32_bf16 v[80:83], a[200:203], v[8:11], v[80:83]
  v_mfma_f32_16x16x32_bf16 v[84:87], a[204:207], v[8:11], v[84:87]
  v_mfma_f32_16x16x32_bf16 v[88:91], a[192:195], v[12:15], v[88:91]
  v_mfma_f32_16x16x32_bf16 v[92:95], a[196:199], v[12:15], v[92:95]
  v_mfma_f32_16x16x32_bf16 v[96:99], a[200:203], v[12:15], v[96:99]
  v_mfma_f32_16x16x32_bf16 v[100:103], a[204:207], v[12:15], v[100:103]
  s_waitcnt lgkmcnt(4)
  v_mfma_f32_16x16x32_bf16 v[72:75], a[208:211], v[16:19], v[72:75]
  v_mfma_f32_16x16x32_bf16 v[76:79], a[212:215], v[16:19], v[76:79]
  v_mfma_f32_16x16x32_bf16 v[80:83], a[216:219], v[16:19], v[80:83]
  v_mfma_f32_16x16x32_bf16 v[84:87], a[220:223], v[16:19], v[84:87]
  v_mfma_f32_16x16x32_bf16 v[88:91], a[208:211], v[20:23], v[88:91]
  v_mfma_f32_16x16x32_bf16 v[92:95], a[212:215], v[20:23], v[92:95]
  v_mfma_f32_16x16x32_bf16 v[96:99], a[216:219], v[20:23], v[96:99]
  v_mfma_f32_16x16x32_bf16 v[100:103], a[220:223], v[20:23], v[100:103]
  s_waitcnt lgkmcnt(2)
  v_mfma_f32_16x16x32_bf16 v[72:75], a[224:227], v[24:27], v[72:75]
  v_mfma_f32_16x16x32_bf16 v[76:79], a[228:231], v[24:27], v[76:79]
  v_mfma_f32_16x16x32_bf16 v[80:83], a[232:235], v[24:27], v[80:83]
  v_mfma_f32_16x16x32_bf16 v[84:87], a[236:239], v[24:27], v[84:87]
  v_mfma_f32_16x16x32_bf16 v[88:91], a[224:227], v[28:31], v[88:91]
  v_mfma_f32_16x16x32_bf16 v[92:95], a[228:231], v[28:31], v[92:95]
  v_mfma_f32_16x16x32_bf16 v[96:99], a[232:235], v[28:31], v[96:99]
  v_mfma_f32_16x16x32_bf16 v[100:103], a[236:239], v[28:31], v[100:103]
  s_waitcnt lgkmcnt(0)
  v_mfma_f32_16x16x32_bf16 v[72:75], a[240:243], v[32:35], v[72:75]
  v_mfma_f32_16x16x32_bf16 v[76:79], a[244:247], v[32:35], v[76:79]
  v_mfma_f32_16x16x32_bf16 v[80:83], a[248:251], v[32:35], v[80:83]
  v_mfma_f32_16x16x32_bf16 v[84:87], a[252:255], v[32:35], v[84:87]
  v_mfma_f32_16x16x32_bf16 v[88:91], a[240:243], v[36:39], v[88:91]
  v_mfma_f32_16x16x32_bf16 v[92:95], a[244:247], v[36:39], v[92:95]
  v_mfma_f32_16x16x32_bf16 v[96:99], a[248:251], v[36:39], v[96:99]
  v_mfma_f32_16x16x32_bf16 v[100:103], a[252:255], v[36:39], v[100:103]
  s_add_u32 s29, s29, 32768
  s_cmp_eq_u32 s29, 98304
  s_cselect_b32 s29, 0, s29
  s_add_u32 s28, s28, 32768
  s_cmp_eq_u32 s28, 98304
  s_cselect_b32 s28, 0, s28
  s_add_u32 s19, s19, 1
  s_cmp_ge_u32 s19, s20

mega_kernel_qk_loop:
  s_add_u32 s27, s19, 1
  s_cmp_lt_u32 s27, s20
  s_cbranch_scc1 mega_kernel_qk_b2_w1
  s_waitcnt vmcnt(0)
mega_kernel_qk_b2_w1:
  s_cmp_lt_u32 s19, 3
  s_cbranch_scc0 mega_kernel_qk_b2_w2
  s_waitcnt vmcnt(8)
mega_kernel_qk_b2_w2:
  s_waitcnt vmcnt(12)
  s_barrier
  s_add_u32 s27, s18, s16
  s_lshl_b32 s27, s27, 8
  s_add_u32 s27, s27, s19
  s_mov_b32 s10, 1664
  s_cmp_eq_u32 s27, 5
  s_cbranch_scc1 mega_kernel_qk_b2_ye
  s_mov_b32 s10, s35
  s_cmp_eq_u32 s27, 1
  s_cbranch_scc0 mega_kernel_qk_b2_ne
mega_kernel_qk_b2_ye:
  v_mov_b32 v5, s10
  v_mov_b32 v6, 1
  v_cmp_eq_u32 vcc, 0, v0
  s_and_saveexec_b64 s[62:63], vcc
  global_atomic_add v5, v6, s[14:15]
  s_mov_b64 exec, s[62:63]
mega_kernel_qk_b2_ne:
  v_add_u32 v5, s29, v1

  ds_read_b128 v[8:11], v5 offset:0
  ds_read_b128 v[12:15], v5 offset:16384
  ds_read_b128 v[16:19], v5 offset:1024
  ds_read_b128 v[20:23], v5 offset:17408
  ds_read_b128 v[24:27], v5 offset:2048
  ds_read_b128 v[28:31], v5 offset:18432
  s_waitcnt lgkmcnt(4)
  v_mfma_f32_16x16x32_bf16 v[40:43], a[0:3], v[8:11], 0
  ds_read_b128 v[32:35], v5 offset:3072
  ds_read_b128 v[36:39], v5 offset:19456
  v_mfma_f32_16x16x32_bf16 v[44:47], a[4:7], v[8:11], 0
  v_mfma_f32_16x16x32_bf16 v[48:51], a[8:11], v[8:11], 0
  v_mfma_f32_16x16x32_bf16 v[52:55], a[12:15], v[8:11], 0
  v_mfma_f32_16x16x32_bf16 v[56:59], a[0:3], v[12:15], 0
  v_cvt_pk_bf16_f32 v104, v72, v73
  v_mfma_f32_16x16x32_bf16 v[60:63], a[4:7], v[12:15], 0
  v_cvt_pk_bf16_f32 v105, v74, v75
  v_mfma_f32_16x16x32_bf16 v[64:67], a[8:11], v[12:15], 0
  v_cvt_pk_bf16_f32 v106, v76, v77
  v_mfma_f32_16x16x32_bf16 v[68:71], a[12:15], v[12:15], 0
  v_cvt_pk_bf16_f32 v107, v78, v79
  s_waitcnt lgkmcnt(4)
  v_mfma_f32_16x16x32_bf16 v[40:43], a[16:19], v[16:19], v[40:43]
  ds_read_b128 v[8:11], v5 offset:4096
  ds_read_b128 v[12:15], v5 offset:20480
  v_mfma_f32_16x16x32_bf16 v[44:47], a[20:23], v[16:19], v[44:47]
  global_store_dwordx4 v1, v[104:107], s[22:23] offset:0 sc1
  v_mfma_f32_16x16x32_bf16 v[48:51], a[24:27], v[16:19], v[48:51]
  v_cvt_pk_bf16_f32 v108, v80, v81
  v_mfma_f32_16x16x32_bf16 v[52:55], a[28:31], v[16:19], v[52:55]
  v_cvt_pk_bf16_f32 v109, v82, v83
  v_mfma_f32_16x16x32_bf16 v[56:59], a[16:19], v[20:23], v[56:59]
  v_cvt_pk_bf16_f32 v110, v84, v85
  v_mfma_f32_16x16x32_bf16 v[60:63], a[20:23], v[20:23], v[60:63]
  v_cvt_pk_bf16_f32 v111, v86, v87
  v_mfma_f32_16x16x32_bf16 v[64:67], a[24:27], v[20:23], v[64:67]
  global_store_dwordx4 v1, v[108:111], s[22:23] offset:1024 sc1
  v_mfma_f32_16x16x32_bf16 v[68:71], a[28:31], v[20:23], v[68:71]
  v_cvt_pk_bf16_f32 v104, v88, v89
  s_waitcnt lgkmcnt(4)
  v_mfma_f32_16x16x32_bf16 v[40:43], a[32:35], v[24:27], v[40:43]
  ds_read_b128 v[16:19], v5 offset:5120
  ds_read_b128 v[20:23], v5 offset:21504
  v_mfma_f32_16x16x32_bf16 v[44:47], a[36:39], v[24:27], v[44:47]
  v_cvt_pk_bf16_f32 v105, v90, v91
  v_mfma_f32_16x16x32_bf16 v[48:51], a[40:43], v[24:27], v[48:51]
  v_cvt_pk_bf16_f32 v106, v92, v93
  v_mfma_f32_16x16x32_bf16 v[52:55], a[44:47], v[24:27], v[52:55]
  v_cvt_pk_bf16_f32 v107, v94, v95
  v_mfma_f32_16x16x32_bf16 v[56:59], a[32:35], v[28:31], v[56:59]
  global_store_dwordx4 v4, v[104:107], s[22:23] offset:0 sc1
  v_mfma_f32_16x16x32_bf16 v[60:63], a[36:39], v[28:31], v[60:63]
  v_cvt_pk_bf16_f32 v108, v96, v97
  v_mfma_f32_16x16x32_bf16 v[64:67], a[40:43], v[28:31], v[64:67]
  v_cvt_pk_bf16_f32 v109, v98, v99
  v_mfma_f32_16x16x32_bf16 v[68:71], a[44:47], v[28:31], v[68:71]
  v_cvt_pk_bf16_f32 v110, v100, v101
  s_waitcnt lgkmcnt(4)
  v_mfma_f32_16x16x32_bf16 v[40:43], a[48:51], v[32:35], v[40:43]
  ds_read_b128 v[24:27], v5 offset:6144
  ds_read_b128 v[28:31], v5 offset:22528
  v_mfma_f32_16x16x32_bf16 v[44:47], a[52:55], v[32:35], v[44:47]
  v_cvt_pk_bf16_f32 v111, v102, v103
  v_mfma_f32_16x16x32_bf16 v[48:51], a[56:59], v[32:35], v[48:51]
  global_store_dwordx4 v4, v[108:111], s[22:23] offset:1024 sc1
  s_add_u32 s22, s22, s25
  s_addc_u32 s23, s23, 0
  v_mfma_f32_16x16x32_bf16 v[52:55], a[60:63], v[32:35], v[52:55]
  v_mfma_f32_16x16x32_bf16 v[56:59], a[48:51], v[36:39], v[56:59]
  v_mfma_f32_16x16x32_bf16 v[60:63], a[52:55], v[36:39], v[60:63]
  v_mfma_f32_16x16x32_bf16 v[64:67], a[56:59], v[36:39], v[64:67]
  v_mfma_f32_16x16x32_bf16 v[68:71], a[60:63], v[36:39], v[68:71]
  s_waitcnt lgkmcnt(4)
  v_mfma_f32_16x16x32_bf16 v[40:43], a[64:67], v[8:11], v[40:43]
  ds_read_b128 v[32:35], v5 offset:7168
  ds_read_b128 v[36:39], v5 offset:23552
  v_mfma_f32_16x16x32_bf16 v[44:47], a[68:71], v[8:11], v[44:47]
  v_mfma_f32_16x16x32_bf16 v[48:51], a[72:75], v[8:11], v[48:51]
  v_mfma_f32_16x16x32_bf16 v[52:55], a[76:79], v[8:11], v[52:55]
  v_mfma_f32_16x16x32_bf16 v[56:59], a[64:67], v[12:15], v[56:59]
  v_mfma_f32_16x16x32_bf16 v[60:63], a[68:71], v[12:15], v[60:63]
  v_mfma_f32_16x16x32_bf16 v[64:67], a[72:75], v[12:15], v[64:67]
  v_mfma_f32_16x16x32_bf16 v[68:71], a[76:79], v[12:15], v[68:71]
  s_waitcnt lgkmcnt(4)
  v_mfma_f32_16x16x32_bf16 v[40:43], a[80:83], v[16:19], v[40:43]
  ds_read_b128 v[8:11], v5 offset:8192
  ds_read_b128 v[12:15], v5 offset:24576
  v_mfma_f32_16x16x32_bf16 v[44:47], a[84:87], v[16:19], v[44:47]
  v_mfma_f32_16x16x32_bf16 v[48:51], a[88:91], v[16:19], v[48:51]
  v_mfma_f32_16x16x32_bf16 v[52:55], a[92:95], v[16:19], v[52:55]
  v_mfma_f32_16x16x32_bf16 v[56:59], a[80:83], v[20:23], v[56:59]
  v_mfma_f32_16x16x32_bf16 v[60:63], a[84:87], v[20:23], v[60:63]
  v_mfma_f32_16x16x32_bf16 v[64:67], a[88:91], v[20:23], v[64:67]
  v_mfma_f32_16x16x32_bf16 v[68:71], a[92:95], v[20:23], v[68:71]
  s_add_u32 s27, s19, 2
  s_cmp_lt_u32 s27, s20
  s_cbranch_scc0 mega_kernel_qk_b2_nd
  s_add_u32 s10, s28, s26
  s_add_u32 m0, s10, 0
  s_lshl_b32 s11, s37, 10
  s_add_u32 s11, s11, 0
  s_add_u32 s8, s6, s11
  s_addc_u32 s9, s7, 0
  global_load_lds_dwordx4 v1, s[8:9] sc1
  global_load_lds_dwordx4 v1, s[8:9] offset:1024 sc1
  global_load_lds_dwordx4 v1, s[8:9] offset:2048 sc1
  global_load_lds_dwordx4 v1, s[8:9] offset:3072 sc1
  s_add_u32 s10, s28, s26
  s_add_u32 m0, s10, 4096
  s_lshl_b32 s11, s37, 10
  s_add_u32 s11, s11, 4096
  s_add_u32 s8, s6, s11
  s_addc_u32 s9, s7, 0
  global_load_lds_dwordx4 v1, s[8:9] sc1
  global_load_lds_dwordx4 v1, s[8:9] offset:1024 sc1
  global_load_lds_dwordx4 v1, s[8:9] offset:2048 sc1
  global_load_lds_dwordx4 v1, s[8:9] offset:3072 sc1
  s_add_u32 s6, s6, s21
  s_addc_u32 s7, s7, 0
mega_kernel_qk_b2_nd:
  s_waitcnt lgkmcnt(4)
  v_mfma_f32_16x16x32_bf16 v[40:43], a[96:99], v[24:27], v[40:43]
  ds_read_b128 v[16:19], v5 offset:9216
  ds_read_b128 v[20:23], v5 offset:25600
  v_mfma_f32_16x16x32_bf16 v[44:47], a[100:103], v[24:27], v[44:47]
  v_mfma_f32_16x16x32_bf16 v[48:51], a[104:107], v[24:27], v[48:51]
  v_mfma_f32_16x16x32_bf16 v[52:55], a[108:111], v[24:27], v[52:55]
  v_mfma_f32_16x16x32_bf16 v[56:59], a[96:99], v[28:31], v[56:59]
  v_mfma_f32_16x16x32_bf16 v[60:63], a[100:103], v[28:31], v[60:63]
  v_mfma_f32_16x16x32_bf16 v[64:67], a[104:107], v[28:31], v[64:67]
  v_mfma_f32_16x16x32_bf16 v[68:71], a[108:111], v[28:31], v[68:71]
  s_waitcnt lgkmcnt(4)
  v_mfma_f32_16x16x32_bf16 v[40:43], a[112:115], v[32:35], v[40:43]
  ds_read_b128 v[24:27], v5 offset:10240
  ds_read_b128 v[28:31], v5 offset:26624
  v_mfma_f32_16x16x32_bf16 v[44:47], a[116:119], v[32:35], v[44:47]
  v_mfma_f32_16x16x32_bf16 v[48:51], a[120:123], v[32:35], v[48:51]
  v_mfma_f32_16x16x32_bf16 v[52:55], a[124:127], v[32:35], v[52:55]
  v_mfma_f32_16x16x32_bf16 v[56:59], a[112:115], v[36:39], v[56:59]
  v_mfma_f32_16x16x32_bf16 v[60:63], a[116:119], v[36:39], v[60:63]
  v_mfma_f32_16x16x32_bf16 v[64:67], a[120:123], v[36:39], v[64:67]
  v_mfma_f32_16x16x32_bf16 v[68:71], a[124:127], v[36:39], v[68:71]
  s_waitcnt lgkmcnt(4)
  v_mfma_f32_16x16x32_bf16 v[40:43], a[128:131], v[8:11], v[40:43]
  ds_read_b128 v[32:35], v5 offset:11264
  ds_read_b128 v[36:39], v5 offset:27648
  v_mfma_f32_16x16x32_bf16 v[44:47], a[132:135], v[8:11], v[44:47]
  v_mfma_f32_16x16x32_bf16 v[48:51], a[136:139], v[8:11], v[48:51]
  v_mfma_f32_16x16x32_bf16 v[52:55], a[140:143], v[8:11], v[52:55]
  v_mfma_f32_16x16x32_bf16 v[56:59], a[128:131], v[12:15], v[56:59]
  v_mfma_f32_16x16x32_bf16 v[60:63], a[132:135], v[12:15], v[60:63]
  v_mfma_f32_16x16x32_bf16 v[64:67], a[136:139], v[12:15], v[64:67]
  v_mfma_f32_16x16x32_bf16 v[68:71], a[140:143], v[12:15], v[68:71]
  s_waitcnt lgkmcnt(4)
  v_mfma_f32_16x16x32_bf16 v[40:43], a[144:147], v[16:19], v[40:43]
  ds_read_b128 v[8:11], v5 offset:12288
  ds_read_b128 v[12:15], v5 offset:28672
  v_mfma_f32_16x16x32_bf16 v[44:47], a[148:151], v[16:19], v[44:47]
  v_mfma_f32_16x16x32_bf16 v[48:51], a[152:155], v[16:19], v[48:51]
  v_mfma_f32_16x16x32_bf16 v[52:55], a[156:159], v[16:19], v[52:55]
  v_mfma_f32_16x16x32_bf16 v[56:59], a[144:147], v[20:23], v[56:59]
  v_mfma_f32_16x16x32_bf16 v[60:63], a[148:151], v[20:23], v[60:63]
  v_mfma_f32_16x16x32_bf16 v[64:67], a[152:155], v[20:23], v[64:67]
  v_mfma_f32_16x16x32_bf16 v[68:71], a[156:159], v[20:23], v[68:71]
  s_waitcnt lgkmcnt(4)
  v_mfma_f32_16x16x32_bf16 v[40:43], a[160:163], v[24:27], v[40:43]
  ds_read_b128 v[16:19], v5 offset:13312
  ds_read_b128 v[20:23], v5 offset:29696
  v_mfma_f32_16x16x32_bf16 v[44:47], a[164:167], v[24:27], v[44:47]
  v_mfma_f32_16x16x32_bf16 v[48:51], a[168:171], v[24:27], v[48:51]
  v_mfma_f32_16x16x32_bf16 v[52:55], a[172:175], v[24:27], v[52:55]
  v_mfma_f32_16x16x32_bf16 v[56:59], a[160:163], v[28:31], v[56:59]
  v_mfma_f32_16x16x32_bf16 v[60:63], a[164:167], v[28:31], v[60:63]
  v_mfma_f32_16x16x32_bf16 v[64:67], a[168:171], v[28:31], v[64:67]
  v_mfma_f32_16x16x32_bf16 v[68:71], a[172:175], v[28:31], v[68:71]
  s_waitcnt lgkmcnt(4)
  v_mfma_f32_16x16x32_bf16 v[40:43], a[176:179], v[32:35], v[40:43]
  ds_read_b128 v[24:27], v5 offset:14336
  ds_read_b128 v[28:31], v5 offset:30720
  v_mfma_f32_16x16x32_bf16 v[44:47], a[180:183], v[32:35], v[44:47]
  v_mfma_f32_16x16x32_bf16 v[48:51], a[184:187], v[32:35], v[48:51]
  v_mfma_f32_16x16x32_bf16 v[52:55], a[188:191], v[32:35], v[52:55]
  v_mfma_f32_16x16x32_bf16 v[56:59], a[176:179], v[36:39], v[56:59]
  v_mfma_f32_16x16x32_bf16 v[60:63], a[180:183], v[36:39], v[60:63]
  v_mfma_f32_16x16x32_bf16 v[64:67], a[184:187], v[36:39], v[64:67]
  v_mfma_f32_16x16x32_bf16 v[68:71], a[188:191], v[36:39], v[68:71]
  s_waitcnt lgkmcnt(4)
  v_mfma_f32_16x16x32_bf16 v[40:43], a[192:195], v[8:11], v[40:43]
  ds_read_b128 v[32:35], v5 offset:15360
  ds_read_b128 v[36:39], v5 offset:31744
  v_mfma_f32_16x16x32_bf16 v[44:47], a[196:199], v[8:11], v[44:47]
  v_mfma_f32_16x16x32_bf16 v[48:51], a[200:203], v[8:11], v[48:51]
  v_mfma_f32_16x16x32_bf16 v[52:55], a[204:207], v[8:11], v[52:55]
  v_mfma_f32_16x16x32_bf16 v[56:59], a[192:195], v[12:15], v[56:59]
  v_mfma_f32_16x16x32_bf16 v[60:63], a[196:199], v[12:15], v[60:63]
  v_mfma_f32_16x16x32_bf16 v[64:67], a[200:203], v[12:15], v[64:67]
  v_mfma_f32_16x16x32_bf16 v[68:71], a[204:207], v[12:15], v[68:71]
  s_waitcnt lgkmcnt(4)
  v_mfma_f32_16x16x32_bf16 v[40:43], a[208:211], v[16:19], v[40:43]
  v_mfma_f32_16x16x32_bf16 v[44:47], a[212:215], v[16:19], v[44:47]
  v_mfma_f32_16x16x32_bf16 v[48:51], a[216:219], v[16:19], v[48:51]
  v_mfma_f32_16x16x32_bf16 v[52:55], a[220:223], v[16:19], v[52:55]
  v_mfma_f32_16x16x32_bf16 v[56:59], a[208:211], v[20:23], v[56:59]
  v_mfma_f32_16x16x32_bf16 v[60:63], a[212:215], v[20:23], v[60:63]
  v_mfma_f32_16x16x32_bf16 v[64:67], a[216:219], v[20:23], v[64:67]
  v_mfma_f32_16x16x32_bf16 v[68:71], a[220:223], v[20:23], v[68:71]
  s_waitcnt lgkmcnt(2)
  v_mfma_f32_16x16x32_bf16 v[40:43], a[224:227], v[24:27], v[40:43]
  v_mfma_f32_16x16x32_bf16 v[44:47], a[228:231], v[24:27], v[44:47]
  v_mfma_f32_16x16x32_bf16 v[48:51], a[232:235], v[24:27], v[48:51]
  v_mfma_f32_16x16x32_bf16 v[52:55], a[236:239], v[24:27], v[52:55]
  v_mfma_f32_16x16x32_bf16 v[56:59], a[224:227], v[28:31], v[56:59]
  v_mfma_f32_16x16x32_bf16 v[60:63], a[228:231], v[28:31], v[60:63]
  v_mfma_f32_16x16x32_bf16 v[64:67], a[232:235], v[28:31], v[64:67]
  v_mfma_f32_16x16x32_bf16 v[68:71], a[236:239], v[28:31], v[68:71]
  s_waitcnt lgkmcnt(0)
  v_mfma_f32_16x16x32_bf16 v[40:43], a[240:243], v[32:35], v[40:43]
  v_mfma_f32_16x16x32_bf16 v[44:47], a[244:247], v[32:35], v[44:47]
  v_mfma_f32_16x16x32_bf16 v[48:51], a[248:251], v[32:35], v[48:51]
  v_mfma_f32_16x16x32_bf16 v[52:55], a[252:255], v[32:35], v[52:55]
  v_mfma_f32_16x16x32_bf16 v[56:59], a[240:243], v[36:39], v[56:59]
  v_mfma_f32_16x16x32_bf16 v[60:63], a[244:247], v[36:39], v[60:63]
  v_mfma_f32_16x16x32_bf16 v[64:67], a[248:251], v[36:39], v[64:67]
  v_mfma_f32_16x16x32_bf16 v[68:71], a[252:255], v[36:39], v[68:71]
  s_add_u32 s29, s29, 32768
  s_cmp_eq_u32 s29, 98304
  s_cselect_b32 s29, 0, s29
  s_add_u32 s28, s28, 32768
  s_cmp_eq_u32 s28, 98304
  s_cselect_b32 s28, 0, s28
  s_add_u32 s19, s19, 1
  s_cmp_ge_u32 s19, s20

  s_cbranch_scc1 mega_kernel_qk_t0
  s_add_u32 s27, s19, 1
  s_cmp_lt_u32 s27, s20
  s_cbranch_scc1 mega_kernel_qk_b1_w1
  s_waitcnt vmcnt(0)
mega_kernel_qk_b1_w1:
  s_cmp_lt_u32 s19, 3
  s_cbranch_scc0 mega_kernel_qk_b1_w2
  s_waitcnt vmcnt(8)
mega_kernel_qk_b1_w2:
  s_waitcnt vmcnt(12)
  s_barrier
  s_add_u32 s27, s18, s16
  s_lshl_b32 s27, s27, 8
  s_add_u32 s27, s27, s19
  s_mov_b32 s10, 1664
  s_cmp_eq_u32 s27, 5
  s_cbranch_scc1 mega_kernel_qk_b1_ye
  s_mov_b32 s10, s35
  s_cmp_eq_u32 s27, 1
  s_cbranch_scc0 mega_kernel_qk_b1_ne
mega_kernel_qk_b1_ye:
  v_mov_b32 v5, s10
  v_mov_b32 v6, 1
  v_cmp_eq_u32 vcc, 0, v0
  s_and_saveexec_b64 s[62:63], vcc
  global_atomic_add v5, v6, s[14:15]
  s_mov_b64 exec, s[62:63]
mega_kernel_qk_b1_ne:
  v_add_u32 v5, s29, v1

  ds_read_b128 v[8:11], v5 offset:0
  ds_read_b128 v[12:15], v5 offset:16384
  ds_read_b128 v[16:19], v5 offset:1024
  ds_read_b128 v[20:23], v5 offset:17408
  ds_read_b128 v[24:27], v5 offset:2048
  ds_read_b128 v[28:31], v5 offset:18432
  s_waitcnt lgkmcnt(4)
  v_mfma_f32_16x16x32_bf16 v[72:75], a[0:3], v[8:11], 0
  ds_read_b128 v[32:35], v5 offset:3072
  ds_read_b128 v[36:39], v5 offset:19456
  v_mfma_f32_16x16x32_bf16 v[76:79], a[4:7], v[8:11], 0
  v_mfma_f32_16x16x32_bf16 v[80:83], a[8:11], v[8:11], 0
  v_mfma_f32_16x16x32_bf16 v[84:87], a[12:15], v[8:11], 0
  v_mfma_f32_16x16x32_bf16 v[88:91], a[0:3], v[12:15], 0
  v_cvt_pk_bf16_f32 v104, v40, v41
  v_mfma_f32_16x16x32_bf16 v[92:95], a[4:7], v[12:15], 0
  v_cvt_pk_bf16_f32 v105, v42, v43
  v_mfma_f32_16x16x32_bf16 v[96:99], a[8:11], v[12:15], 0
  v_cvt_pk_bf16_f32 v106, v44, v45
  v_mfma_f32_16x16x32_bf16 v[100:103], a[12:15], v[12:15], 0
  v_cvt_pk_bf16_f32 v107, v46, v47
  s_waitcnt lgkmcnt(4)
  v_mfma_f32_16x16x32_bf16 v[72:75], a[16:19], v[16:19], v[72:75]
  ds_read_b128 v[8:11], v5 offset:4096
  ds_read_b128 v[12:15], v5 offset:20480
  v_mfma_f32_16x16x32_bf16 v[76:79], a[20:23], v[16:19], v[76:79]
  global_store_dwordx4 v1, v[104:107], s[22:23] offset:0 sc1
  v_mfma_f32_16x16x32_bf16 v[80:83], a[24:27], v[16:19], v[80:83]
  v_cvt_pk_bf16_f32 v108, v48, v49
  v_mfma_f32_16x16x32_bf16 v[84:87], a[28:31], v[16:19], v[84:87]
  v_cvt_pk_bf16_f32 v109, v50, v51
  v_mfma_f32_16x16x32_bf16 v[88:91], a[16:19], v[20:23], v[88:91]
  v_cvt_pk_bf16_f32 v110, v52, v53
  v_mfma_f32_16x16x32_bf16 v[92:95], a[20:23], v[20:23], v[92:95]
  v_cvt_pk_bf16_f32 v111, v54, v55
  v_mfma_f32_16x16x32_bf16 v[96:99], a[24:27], v[20:23], v[96:99]
  global_store_dwordx4 v1, v[108:111], s[22:23] offset:1024 sc1
  v_mfma_f32_16x16x32_bf16 v[100:103], a[28:31], v[20:23], v[100:103]
  v_cvt_pk_bf16_f32 v104, v56, v57
  s_waitcnt lgkmcnt(4)
  v_mfma_f32_16x16x32_bf16 v[72:75], a[32:35], v[24:27], v[72:75]
  ds_read_b128 v[16:19], v5 offset:5120
  ds_read_b128 v[20:23], v5 offset:21504
  v_mfma_f32_16x16x32_bf16 v[76:79], a[36:39], v[24:27], v[76:79]
  v_cvt_pk_bf16_f32 v105, v58, v59
  v_mfma_f32_16x16x32_bf16 v[80:83], a[40:43], v[24:27], v[80:83]
  v_cvt_pk_bf16_f32 v106, v60, v61
  v_mfma_f32_16x16x32_bf16 v[84:87], a[44:47], v[24:27], v[84:87]
  v_cvt_pk_bf16_f32 v107, v62, v63
  v_mfma_f32_16x16x32_bf16 v[88:91], a[32:35], v[28:31], v[88:91]
  global_store_dwordx4 v4, v[104:107], s[22:23] offset:0 sc1
  v_mfma_f32_16x16x32_bf16 v[92:95], a[36:39], v[28:31], v[92:95]
  v_cvt_pk_bf16_f32 v108, v64, v65
  v_mfma_f32_16x16x32_bf16 v[96:99], a[40:43], v[28:31], v[96:99]
  v_cvt_pk_bf16_f32 v109, v66, v67
  v_mfma_f32_16x16x32_bf16 v[100:103], a[44:47], v[28:31], v[100:103]
  v_cvt_pk_bf16_f32 v110, v68, v69
  s_waitcnt lgkmcnt(4)
  v_mfma_f32_16x16x32_bf16 v[72:75], a[48:51], v[32:35], v[72:75]
  ds_read_b128 v[24:27], v5 offset:6144
  ds_read_b128 v[28:31], v5 offset:22528
  v_mfma_f32_16x16x32_bf16 v[76:79], a[52:55], v[32:35], v[76:79]
  v_cvt_pk_bf16_f32 v111, v70, v71
  v_mfma_f32_16x16x32_bf16 v[80:83], a[56:59], v[32:35], v[80:83]
  global_store_dwordx4 v4, v[108:111], s[22:23] offset:1024 sc1
  s_add_u32 s22, s22, s25
  s_addc_u32 s23, s23, 0
  v_mfma_f32_16x16x32_bf16 v[84:87], a[60:63], v[32:35], v[84:87]
  v_mfma_f32_16x16x32_bf16 v[88:91], a[48:51], v[36:39], v[88:91]
  v_mfma_f32_16x16x32_bf16 v[92:95], a[52:55], v[36:39], v[92:95]
  v_mfma_f32_16x16x32_bf16 v[96:99], a[56:59], v[36:39], v[96:99]
  v_mfma_f32_16x16x32_bf16 v[100:103], a[60:63], v[36:39], v[100:103]
  s_waitcnt lgkmcnt(4)
  v_mfma_f32_16x16x32_bf16 v[72:75], a[64:67], v[8:11], v[72:75]
  ds_read_b128 v[32:35], v5 offset:7168
  ds_read_b128 v[36:39], v5 offset:23552
  v_mfma_f32_16x16x32_bf16 v[76:79], a[68:71], v[8:11], v[76:79]
  v_mfma_f32_16x16x32_bf16 v[80:83], a[72:75], v[8:11], v[80:83]
  v_mfma_f32_16x16x32_bf16 v[84:87], a[76:79], v[8:11], v[84:87]
  v_mfma_f32_16x16x32_bf16 v[88:91], a[64:67], v[12:15], v[88:91]
  v_mfma_f32_16x16x32_bf16 v[92:95], a[68:71], v[12:15], v[92:95]
  v_mfma_f32_16x16x32_bf16 v[96:99], a[72:75], v[12:15], v[96:99]
  v_mfma_f32_16x16x32_bf16 v[100:103], a[76:79], v[12:15], v[100:103]
  s_waitcnt lgkmcnt(4)
  v_mfma_f32_16x16x32_bf16 v[72:75], a[80:83], v[16:19], v[72:75]
  ds_read_b128 v[8:11], v5 offset:8192
  ds_read_b128 v[12:15], v5 offset:24576
  v_mfma_f32_16x16x32_bf16 v[76:79], a[84:87], v[16:19], v[76:79]
  v_mfma_f32_16x16x32_bf16 v[80:83], a[88:91], v[16:19], v[80:83]
  v_mfma_f32_16x16x32_bf16 v[84:87], a[92:95], v[16:19], v[84:87]
  v_mfma_f32_16x16x32_bf16 v[88:91], a[80:83], v[20:23], v[88:91]
  v_mfma_f32_16x16x32_bf16 v[92:95], a[84:87], v[20:23], v[92:95]
  v_mfma_f32_16x16x32_bf16 v[96:99], a[88:91], v[20:23], v[96:99]
  v_mfma_f32_16x16x32_bf16 v[100:103], a[92:95], v[20:23], v[100:103]
  s_add_u32 s27, s19, 2
  s_cmp_lt_u32 s27, s20
  s_cbranch_scc0 mega_kernel_qk_b1_nd
  s_add_u32 s10, s28, s26
  s_add_u32 m0, s10, 0
  s_lshl_b32 s11, s37, 10
  s_add_u32 s11, s11, 0
  s_add_u32 s8, s6, s11
  s_addc_u32 s9, s7, 0
  global_load_lds_dwordx4 v1, s[8:9] sc1
  global_load_lds_dwordx4 v1, s[8:9] offset:1024 sc1
  global_load_lds_dwordx4 v1, s[8:9] offset:2048 sc1
  global_load_lds_dwordx4 v1, s[8:9] offset:3072 sc1
  s_add_u32 s10, s28, s26
  s_add_u32 m0, s10, 4096
  s_lshl_b32 s11, s37, 10
  s_add_u32 s11, s11, 4096
  s_add_u32 s8, s6, s11
  s_addc_u32 s9, s7, 0
  global_load_lds_dwordx4 v1, s[8:9] sc1
  global_load_lds_dwordx4 v1, s[8:9] offset:1024 sc1
  global_load_lds_dwordx4 v1, s[8:9] offset:2048 sc1
  global_load_lds_dwordx4 v1, s[8:9] offset:3072 sc1
  s_add_u32 s6, s6, s21
  s_addc_u32 s7, s7, 0
mega_kernel_qk_b1_nd:
  s_waitcnt lgkmcnt(4)
  v_mfma_f32_16x16x32_bf16 v[72:75], a[96:99], v[24:27], v[72:75]
  ds_read_b128 v[16:19], v5 offset:9216
  ds_read_b128 v[20:23], v5 offset:25600
  v_mfma_f32_16x16x32_bf16 v[76:79], a[100:103], v[24:27], v[76:79]
  v_mfma_f32_16x16x32_bf16 v[80:83], a[104:107], v[24:27], v[80:83]
  v_mfma_f32_16x16x32_bf16 v[84:87], a[108:111], v[24:27], v[84:87]
  v_mfma_f32_16x16x32_bf16 v[88:91], a[96:99], v[28:31], v[88:91]
  v_mfma_f32_16x16x32_bf16 v[92:95], a[100:103], v[28:31], v[92:95]
  v_mfma_f32_16x16x32_bf16 v[96:99], a[104:107], v[28:31], v[96:99]
  v_mfma_f32_16x16x32_bf16 v[100:103], a[108:111], v[28:31], v[100:103]
  s_waitcnt lgkmcnt(4)
  v_mfma_f32_16x16x32_bf16 v[72:75], a[112:115], v[32:35], v[72:75]
  ds_read_b128 v[24:27], v5 offset:10240
  ds_read_b128 v[28:31], v5 offset:26624
  v_mfma_f32_16x16x32_bf16 v[76:79], a[116:119], v[32:35], v[76:79]
  v_mfma_f32_16x16x32_bf16 v[80:83], a[120:123], v[32:35], v[80:83]
  v_mfma_f32_16x16x32_bf16 v[84:87], a[124:127], v[32:35], v[84:87]
  v_mfma_f32_16x16x32_bf16 v[88:91], a[112:115], v[36:39], v[88:91]
  v_mfma_f32_16x16x32_bf16 v[92:95], a[116:119], v[36:39], v[92:95]
  v_mfma_f32_16x16x32_bf16 v[96:99], a[120:123], v[36:39], v[96:99]
  v_mfma_f32_16x16x32_bf16 v[100:103], a[124:127], v[36:39], v[100:103]
  s_waitcnt lgkmcnt(4)
  v_mfma_f32_16x16x32_bf16 v[72:75], a[128:131], v[8:11], v[72:75]
  ds_read_b128 v[32:35], v5 offset:11264
  ds_read_b128 v[36:39], v5 offset:27648
  v_mfma_f32_16x16x32_bf16 v[76:79], a[132:135], v[8:11], v[76:79]
  v_mfma_f32_16x16x32_bf16 v[80:83], a[136:139], v[8:11], v[80:83]
  v_mfma_f32_16x16x32_bf16 v[84:87], a[140:143], v[8:11], v[84:87]
  v_mfma_f32_16x16x32_bf16 v[88:91], a[128:131], v[12:15], v[88:91]
  v_mfma_f32_16x16x32_bf16 v[92:95], a[132:135], v[12:15], v[92:95]
  v_mfma_f32_16x16x32_bf16 v[96:99], a[136:139], v[12:15], v[96:99]
  v_mfma_f32_16x16x32_bf16 v[100:103], a[140:143], v[12:15], v[100:103]
  s_waitcnt lgkmcnt(4)
  v_mfma_f32_16x16x32_bf16 v[72:75], a[144:147], v[16:19], v[72:75]
  ds_read_b128 v[8:11], v5 offset:12288
  ds_read_b128 v[12:15], v5 offset:28672
  v_mfma_f32_16x16x32_bf16 v[76:79], a[148:151], v[16:19], v[76:79]
  v_mfma_f32_16x16x32_bf16 v[80:83], a[152:155], v[16:19], v[80:83]
  v_mfma_f32_16x16x32_bf16 v[84:87], a[156:159], v[16:19], v[84:87]
  v_mfma_f32_16x16x32_bf16 v[88:91], a[144:147], v[20:23], v[88:91]
  v_mfma_f32_16x16x32_bf16 v[92:95], a[148:151], v[20:23], v[92:95]
  v_mfma_f32_16x16x32_bf16 v[96:99], a[152:155], v[20:23], v[96:99]
  v_mfma_f32_16x16x32_bf16 v[100:103], a[156:159], v[20:23], v[100:103]
  s_waitcnt lgkmcnt(4)
  v_mfma_f32_16x16x32_bf16 v[72:75], a[160:163], v[24:27], v[72:75]
  ds_read_b128 v[16:19], v5 offset:13312
  ds_read_b128 v[20:23], v5 offset:29696
  v_mfma_f32_16x16x32_bf16 v[76:79], a[164:167], v[24:27], v[76:79]
  v_mfma_f32_16x16x32_bf16 v[80:83], a[168:171], v[24:27], v[80:83]
  v_mfma_f32_16x16x32_bf16 v[84:87], a[172:175], v[24:27], v[84:87]
  v_mfma_f32_16x16x32_bf16 v[88:91], a[160:163], v[28:31], v[88:91]
  v_mfma_f32_16x16x32_bf16 v[92:95], a[164:167], v[28:31], v[92:95]
  v_mfma_f32_16x16x32_bf16 v[96:99], a[168:171], v[28:31], v[96:99]
  v_mfma_f32_16x16x32_bf16 v[100:103], a[172:175], v[28:31], v[100:103]
  s_waitcnt lgkmcnt(4)
  v_mfma_f32_16x16x32_bf16 v[72:75], a[176:179], v[32:35], v[72:75]
  ds_read_b128 v[24:27], v5 offset:14336
  ds_read_b128 v[28:31], v5 offset:30720
  v_mfma_f32_16x16x32_bf16 v[76:79], a[180:183], v[32:35], v[76:79]
  v_mfma_f32_16x16x32_bf16 v[80:83], a[184:187], v[32:35], v[80:83]
  v_mfma_f32_16x16x32_bf16 v[84:87], a[188:191], v[32:35], v[84:87]
  v_mfma_f32_16x16x32_bf16 v[88:91], a[176:179], v[36:39], v[88:91]
  v_mfma_f32_16x16x32_bf16 v[92:95], a[180:183], v[36:39], v[92:95]
  v_mfma_f32_16x16x32_bf16 v[96:99], a[184:187], v[36:39], v[96:99]
  v_mfma_f32_16x16x32_bf16 v[100:103], a[188:191], v[36:39], v[100:103]
  s_waitcnt lgkmcnt(4)
  v_mfma_f32_16x16x32_bf16 v[72:75], a[192:195], v[8:11], v[72:75]
  ds_read_b128 v[32:35], v5 offset:15360
  ds_read_b128 v[36:39], v5 offset:31744
  v_mfma_f32_16x16x32_bf16 v[76:79], a[196:199], v[8:11], v[76:79]
  v_mfma_f32_16x16x32_bf16 v[80:83], a[200:203], v[8:11], v[80:83]
  v_mfma_f32_16x16x32_bf16 v[84:87], a[204:207], v[8:11], v[84:87]
  v_mfma_f32_16x16x32_bf16 v[88:91], a[192:195], v[12:15], v[88:91]
  v_mfma_f32_16x16x32_bf16 v[92:95], a[196:199], v[12:15], v[92:95]
  v_mfma_f32_16x16x32_bf16 v[96:99], a[200:203], v[12:15], v[96:99]
  v_mfma_f32_16x16x32_bf16 v[100:103], a[204:207], v[12:15], v[100:103]
  s_waitcnt lgkmcnt(4)
  v_mfma_f32_16x16x32_bf16 v[72:75], a[208:211], v[16:19], v[72:75]
  v_mfma_f32_16x16x32_bf16 v[76:79], a[212:215], v[16:19], v[76:79]
  v_mfma_f32_16x16x32_bf16 v[80:83], a[216:219], v[16:19], v[80:83]
  v_mfma_f32_16x16x32_bf16 v[84:87], a[220:223], v[16:19], v[84:87]
  v_mfma_f32_16x16x32_bf16 v[88:91], a[208:211], v[20:23], v[88:91]
  v_mfma_f32_16x16x32_bf16 v[92:95], a[212:215], v[20:23], v[92:95]
  v_mfma_f32_16x16x32_bf16 v[96:99], a[216:219], v[20:23], v[96:99]
  v_mfma_f32_16x16x32_bf16 v[100:103], a[220:223], v[20:23], v[100:103]
  s_waitcnt lgkmcnt(2)
  v_mfma_f32_16x16x32_bf16 v[72:75], a[224:227], v[24:27], v[72:75]
  v_mfma_f32_16x16x32_bf16 v[76:79], a[228:231], v[24:27], v[76:79]
  v_mfma_f32_16x16x32_bf16 v[80:83], a[232:235], v[24:27], v[80:83]
  v_mfma_f32_16x16x32_bf16 v[84:87], a[236:239], v[24:27], v[84:87]
  v_mfma_f32_16x16x32_bf16 v[88:91], a[224:227], v[28:31], v[88:91]
  v_mfma_f32_16x16x32_bf16 v[92:95], a[228:231], v[28:31], v[92:95]
  v_mfma_f32_16x16x32_bf16 v[96:99], a[232:235], v[28:31], v[96:99]
  v_mfma_f32_16x16x32_bf16 v[100:103], a[236:239], v[28:31], v[100:103]
  s_waitcnt lgkmcnt(0)
  v_mfma_f32_16x16x32_bf16 v[72:75], a[240:243], v[32:35], v[72:75]
  v_mfma_f32_16x16x32_bf16 v[76:79], a[244:247], v[32:35], v[76:79]
  v_mfma_f32_16x16x32_bf16 v[80:83], a[248:251], v[32:35], v[80:83]
  v_mfma_f32_16x16x32_bf16 v[84:87], a[252:255], v[32:35], v[84:87]
  v_mfma_f32_16x16x32_bf16 v[88:91], a[240:243], v[36:39], v[88:91]
  v_mfma_f32_16x16x32_bf16 v[92:95], a[244:247], v[36:39], v[92:95]
  v_mfma_f32_16x16x32_bf16 v[96:99], a[248:251], v[36:39], v[96:99]
  v_mfma_f32_16x16x32_bf16 v[100:103], a[252:255], v[36:39], v[100:103]
  s_add_u32 s29, s29, 32768
  s_cmp_eq_u32 s29, 98304
  s_cselect_b32 s29, 0, s29
  s_add_u32 s28, s28, 32768
  s_cmp_eq_u32 s28, 98304
  s_cselect_b32 s28, 0, s28
  s_add_u32 s19, s19, 1
  s_cmp_ge_u32 s19, s20

  s_cbranch_scc0 mega_kernel_qk_loop
  s_nop 7
  v_cvt_pk_bf16_f32 v104, v72, v73
  v_cvt_pk_bf16_f32 v105, v74, v75
  v_cvt_pk_bf16_f32 v106, v76, v77
  v_cvt_pk_bf16_f32 v107, v78, v79
  global_store_dwordx4 v1, v[104:107], s[22:23] offset:0 sc1
  v_cvt_pk_bf16_f32 v108, v80, v81
  v_cvt_pk_bf16_f32 v109, v82, v83
  v_cvt_pk_bf16_f32 v110, v84, v85
  v_cvt_pk_bf16_f32 v111, v86, v87
  global_store_dwordx4 v1, v[108:111], s[22:23] offset:1024 sc1
  v_cvt_pk_bf16_f32 v104, v88, v89
  v_cvt_pk_bf16_f32 v105, v90, v91
  v_cvt_pk_bf16_f32 v106, v92, v93
  v_cvt_pk_bf16_f32 v107, v94, v95
  global_store_dwordx4 v4, v[104:107], s[22:23] offset:0 sc1
  v_cvt_pk_bf16_f32 v108, v96, v97
  v_cvt_pk_bf16_f32 v109, v98, v99
  v_cvt_pk_bf16_f32 v110, v100, v101
  v_cvt_pk_bf16_f32 v111, v102, v103
  global_store_dwordx4 v4, v[108:111], s[22:23] offset:1024 sc1
  s_add_u32 s22, s22, s25
  s_addc_u32 s23, s23, 0
  s_branch mega_kernel_qk_done
mega_kernel_qk_t0:
  s_nop 7
  v_cvt_pk_bf16_f32 v104, v40, v41
  v_cvt_pk_bf16_f32 v105, v42, v43
  v_cvt_pk_bf16_f32 v106, v44, v45
  v_cvt_pk_bf16_f32 v107, v46, v47
  global_store_dwordx4 v1, v[104:107], s[22:23] offset:0 sc1
  v_cvt_pk_bf16_f32 v108, v48, v49
  v_cvt_pk_bf16_f32 v109, v50, v51
  v_cvt_pk_bf16_f32 v110, v52, v53
  v_cvt_pk_bf16_f32 v111, v54, v55
  global_store_dwordx4 v1, v[108:111], s[22:23] offset:1024 sc1
  v_cvt_pk_bf16_f32 v104, v56, v57
  v_cvt_pk_bf16_f32 v105, v58, v59
  v_cvt_pk_bf16_f32 v106, v60, v61
  v_cvt_pk_bf16_f32 v107, v62, v63
  global_store_dwordx4 v4, v[104:107], s[22:23] offset:0 sc1
  v_cvt_pk_bf16_f32 v108, v64, v65
  v_cvt_pk_bf16_f32 v109, v66, v67
  v_cvt_pk_bf16_f32 v110, v68, v69
  v_cvt_pk_bf16_f32 v111, v70, v71
  global_store_dwordx4 v4, v[108:111], s[22:23] offset:1024 sc1
  s_add_u32 s22, s22, s25
  s_addc_u32 s23, s23, 0
mega_kernel_qk_done:
  s_branch mega_kernel_Adone
mega_kernel_V:
  s_mov_b32 s60, s29
  s_lshl_b32 s28, s16, 8
  s_add_u32 s28, s28, s17
  s_cmp_lt_u32 s28, 128
  s_cselect_b32 s39, 1, 0
  s_cbranch_scc0 mega_kernel_v_pre_a
  s_load_dwordx2 s[26:27], s[0:1], 0
  v_and_b32 v5, 15, v0
  v_lshlrev_b32 v5, 10, v5
  v_lshrrev_b32 v6, 4, v0
  v_lshl_add_u32 v5, v6, 4, v5
  s_lshl_b32 s28, s17, 14
  s_lshl_b32 s29, s18, 8
  s_add_u32 s28, s28, s29
  s_waitcnt lgkmcnt(0)
  s_add_u32 s26, s26, s28
  s_addc_u32 s27, s27, 0

  global_load_dwordx4 v[40:43], v5, s[26:27] offset:0
  global_load_dwordx4 v[44:47], v5, s[26:27] offset:64
  global_load_dwordx4 v[48:51], v5, s[26:27] offset:128
  global_load_dwordx4 v[52:55], v5, s[26:27] offset:192
  s_cmp_lt_u32 s17, 30
  s_cbranch_scc0 mega_kernel_v_pre_a
  v_mov_b32 v100, 0
  v_mov_b32 v101, 0
  v_mov_b32 v102, 0
  v_mov_b32 v103, 0
  v_lshlrev_b32 v6, 4, v0
  s_lshl_b32 s26, s17, 12
  s_add_u32 s28, s26, 83886080
  s_add_u32 s29, s26, 85983232
  s_cmp_ge_u32 s17, 4
  s_cselect_b32 s28, s29, s28
  s_add_u32 s29, s26, 66093056
  s_cmp_ge_u32 s17, 8
  s_cselect_b32 s28, s29, s28
  s_lshl_b32 s26, s18, 10
  s_add_u32 s28, s28, s26
  s_add_u32 s28, s12, s28
  s_addc_u32 s29, s13, 0
  global_store_dwordx4 v6, v[100:103], s[28:29] sc1
mega_kernel_v_pre_a:

  v_lshrrev_b32 v5, 3, v0
  v_mov_b32 v6, 8192
  v_mul_lo_u32 v5, v5, v6
  v_and_b32 v6, 7, v0
  v_lshl_add_u32 v2, v6, 4, v5
  v_and_b32 v5, 15, v0
  v_lshrrev_b32 v6, 4, v0
  v_lshrrev_b32 v7, 2, v5
  v_lshl_add_u32 v7, v6, 3, v7
  v_mul_u32_u24 v7, 128, v7
  v_and_b32 v5, 3, v5
  v_lshl_add_u32 v7, v5, 4, v7
  s_mul_i32 s24, s18, 36864
  s_add_u32 s24, s24, 4096
  v_add_u32 v3, s24, v7

  s_add_u32 s8, s4, 0
  s_addc_u32 s9, s5, 0
  s_add_u32 m0, s24, 0
  s_nop 0
  global_load_lds_dwordx4 v2, s[8:9]

  s_add_u32 s8, s4, 65536
  s_addc_u32 s9, s5, 0
  s_add_u32 m0, s24, 1024
  s_nop 0
  global_load_lds_dwordx4 v2, s[8:9]

  s_add_u32 s8, s4, 131072
  s_addc_u32 s9, s5, 0
  s_add_u32 m0, s24, 2048
  s_nop 0
  global_load_lds_dwordx4 v2, s[8:9]

  s_add_u32 s8, s4, 196608
  s_addc_u32 s9, s5, 0
  s_add_u32 m0, s24, 3072
  s_nop 0
  global_load_lds_dwordx4 v2, s[8:9]

  s_add_u32 s8, s4, 262144
  s_addc_u32 s9, s5, 0
  s_add_u32 m0, s24, 4096
  s_nop 0
  global_load_lds_dwordx4 v2, s[8:9]

  s_add_u32 s8, s4, 327680
  s_addc_u32 s9, s5, 0
  s_add_u32 m0, s24, 5120
  s_nop 0
  global_load_lds_dwordx4 v2, s[8:9]

  s_add_u32 s8, s4, 393216
  s_addc_u32 s9, s5, 0
  s_add_u32 m0, s24, 6144
  s_nop 0
  global_load_lds_dwordx4 v2, s[8:9]

  s_add_u32 s8, s4, 458752
  s_addc_u32 s9, s5, 0
  s_add_u32 m0, s24, 7168
  s_nop 0
  global_load_lds_dwordx4 v2, s[8:9]

  s_add_u32 s8, s4, 524288
  s_addc_u32 s9, s5, 0
  s_add_u32 m0, s24, 8192
  s_nop 0
  global_load_lds_dwordx4 v2, s[8:9]

  s_add_u32 s8, s4, 589824
  s_addc_u32 s9, s5, 0
  s_add_u32 m0, s24, 9216
  s_nop 0
  global_load_lds_dwordx4 v2, s[8:9]

  s_add_u32 s8, s4, 655360
  s_addc_u32 s9, s5, 0
  s_add_u32 m0, s24, 10240
  s_nop 0
  global_load_lds_dwordx4 v2, s[8:9]

  s_add_u32 s8, s4, 720896
  s_addc_u32 s9, s5, 0
  s_add_u32 m0, s24, 11264
  s_nop 0
  global_load_lds_dwordx4 v2, s[8:9]

  s_add_u32 s8, s4, 786432
  s_addc_u32 s9, s5, 0
  s_add_u32 m0, s24, 12288
  s_nop 0
  global_load_lds_dwordx4 v2, s[8:9]

  s_add_u32 s8, s4, 851968
  s_addc_u32 s9, s5, 0
  s_add_u32 m0, s24, 13312
  s_nop 0
  global_load_lds_dwordx4 v2, s[8:9]

  s_add_u32 s8, s4, 917504
  s_addc_u32 s9, s5, 0
  s_add_u32 m0, s24, 14336
  s_nop 0
  global_load_lds_dwordx4 v2, s[8:9]

  s_add_u32 s8, s4, 983040
  s_addc_u32 s9, s5, 0
  s_add_u32 m0, s24, 15360
  s_nop 0
  global_load_lds_dwordx4 v2, s[8:9]

  s_add_u32 s8, s4, 1048576
  s_addc_u32 s9, s5, 0
  s_add_u32 m0, s24, 16384
  s_nop 0
  global_load_lds_dwordx4 v2, s[8:9]

  s_add_u32 s8, s4, 1114112
  s_addc_u32 s9, s5, 0
  s_add_u32 m0, s24, 17408
  s_nop 0
  global_load_lds_dwordx4 v2, s[8:9]

  s_add_u32 s8, s4, 1179648
  s_addc_u32 s9, s5, 0
  s_add_u32 m0, s24, 18432
  s_nop 0
  global_load_lds_dwordx4 v2, s[8:9]

  s_add_u32 s8, s4, 1245184
  s_addc_u32 s9, s5, 0
  s_add_u32 m0, s24, 19456
  s_nop 0
  global_load_lds_dwordx4 v2, s[8:9]

  s_add_u32 s8, s4, 1310720
  s_addc_u32 s9, s5, 0
  s_add_u32 m0, s24, 20480
  s_nop 0
  global_load_lds_dwordx4 v2, s[8:9]

  s_add_u32 s8, s4, 1376256
  s_addc_u32 s9, s5, 0
  s_add_u32 m0, s24, 21504
  s_nop 0
  global_load_lds_dwordx4 v2, s[8:9]

  s_add_u32 s8, s4, 1441792
  s_addc_u32 s9, s5, 0
  s_add_u32 m0, s24, 22528
  s_nop 0
  global_load_lds_dwordx4 v2, s[8:9]

  s_add_u32 s8, s4, 1507328
  s_addc_u32 s9, s5, 0
  s_add_u32 m0, s24, 23552
  s_nop 0
  global_load_lds_dwordx4 v2, s[8:9]

  s_add_u32 s8, s4, 1572864
  s_addc_u32 s9, s5, 0
  s_add_u32 m0, s24, 24576
  s_nop 0
  global_load_lds_dwordx4 v2, s[8:9]

  s_add_u32 s8, s4, 1638400
  s_addc_u32 s9, s5, 0
  s_add_u32 m0, s24, 25600
  s_nop 0
  global_load_lds_dwordx4 v2, s[8:9]

  s_add_u32 s8, s4, 1703936
  s_addc_u32 s9, s5, 0
  s_add_u32 m0, s24, 26624
  s_nop 0
  global_load_lds_dwordx4 v2, s[8:9]

  s_add_u32 s8, s4, 1769472
  s_addc_u32 s9, s5, 0
  s_add_u32 m0, s24, 27648
  s_nop 0
  global_load_lds_dwordx4 v2, s[8:9]

  s_add_u32 s8, s4, 1835008
  s_addc_u32 s9, s5, 0
  s_add_u32 m0, s24, 28672
  s_nop 0
  global_load_lds_dwordx4 v2, s[8:9]

  s_add_u32 s8, s4, 1900544
  s_addc_u32 s9, s5, 0
  s_add_u32 m0, s24, 29696
  s_nop 0
  global_load_lds_dwordx4 v2, s[8:9]

  s_add_u32 s8, s4, 1966080
  s_addc_u32 s9, s5, 0
  s_add_u32 m0, s24, 30720
  s_nop 0
  global_load_lds_dwordx4 v2, s[8:9]

  s_add_u32 s8, s4, 2031616
  s_addc_u32 s9, s5, 0
  s_add_u32 m0, s24, 31744
  s_nop 0
  global_load_lds_dwordx4 v2, s[8:9]

  s_add_u32 s8, s4, 2097152
  s_addc_u32 s9, s5, 0
  s_add_u32 m0, s24, 32768
  s_nop 0
  global_load_lds_dwordx4 v2, s[8:9]

  s_add_u32 s8, s4, 2162688
  s_addc_u32 s9, s5, 0
  s_add_u32 m0, s24, 33792
  s_nop 0
  global_load_lds_dwordx4 v2, s[8:9]

  s_add_u32 s8, s4, 2228224
  s_addc_u32 s9, s5, 0
  s_add_u32 m0, s24, 34816
  s_nop 0
  global_load_lds_dwordx4 v2, s[8:9]

  s_add_u32 s8, s4, 2293760
  s_addc_u32 s9, s5, 0
  s_add_u32 m0, s24, 35840
  s_nop 0
  global_load_lds_dwordx4 v2, s[8:9]

  s_cmp_eq_u32 s39, 1
  s_cbranch_scc0 mega_kernel_v_pre_b
  s_waitcnt vmcnt(36)
  v_lshlrev_b32 v64, 16, v40
  v_and_b32 v65, 0xffff0000, v40
  v_lshlrev_b32 v66, 16, v41
  v_and_b32 v67, 0xffff0000, v41
  v_lshlrev_b32 v68, 16, v42
  v_and_b32 v69, 0xffff0000, v42
  v_lshlrev_b32 v70, 16, v43
  v_and_b32 v71, 0xffff0000, v43
  v_lshlrev_b32 v72, 16, v44
  v_and_b32 v73, 0xffff0000, v44
  v_lshlrev_b32 v74, 16, v45
  v_and_b32 v75, 0xffff0000, v45
  v_lshlrev_b32 v76, 16, v46
  v_and_b32 v77, 0xffff0000, v46
  v_lshlrev_b32 v78, 16, v47
  v_and_b32 v79, 0xffff0000, v47
  v_lshlrev_b32 v80, 16, v48
  v_and_b32 v81, 0xffff0000, v48
  v_lshlrev_b32 v82, 16, v49
  v_and_b32 v83, 0xffff0000, v49
  v_lshlrev_b32 v84, 16, v50
  v_and_b32 v85, 0xffff0000, v50
  v_lshlrev_b32 v86, 16, v51
  v_and_b32 v87, 0xffff0000, v51
  v_lshlrev_b32 v88, 16, v52
  v_and_b32 v89, 0xffff0000, v52
  v_lshlrev_b32 v90, 16, v53
  v_and_b32 v91, 0xffff0000, v53
  v_lshlrev_b32 v92, 16, v54
  v_and_b32 v93, 0xffff0000, v54
  v_lshlrev_b32 v94, 16, v55
  v_and_b32 v95, 0xffff0000, v55
  v_pk_add_f32 v[24:25], v[64:65], v[66:67]
  v_pk_add_f32 v[26:27], v[68:69], v[70:71]
  v_pk_add_f32 v[24:25], v[24:25], v[72:73]
  v_pk_add_f32 v[26:27], v[26:27], v[74:75]
  v_pk_add_f32 v[24:25], v[24:25], v[76:77]
  v_pk_add_f32 v[26:27], v[26:27], v[78:79]
  v_pk_add_f32 v[24:25], v[24:25], v[80:81]
  v_pk_add_f32 v[26:27], v[26:27], v[82:83]
  v_pk_add_f32 v[24:25], v[24:25], v[84:85]
  v_pk_add_f32 v[26:27], v[26:27], v[86:87]
  v_pk_add_f32 v[24:25], v[24:25], v[88:89]
  v_pk_add_f32 v[26:27], v[26:27], v[90:91]
  v_pk_add_f32 v[24:25], v[24:25], v[92:93]
  v_pk_add_f32 v[26:27], v[26:27], v[94:95]
  v_pk_add_f32 v[24:25], v[24:25], v[26:27]
  v_add_f32 v24, v24, v25
  v_mov_b32 v25, v24
  s_nop 1
  v_permlane32_swap_b32 v24, v25
  v_add_f32 v24, v24, v25
  v_mov_b32 v25, v24
  s_nop 1
  v_permlane16_swap_b32 v24, v25
  v_add_f32 v24, v24, v25

  v_mul_f32 v24, 0x3c000000, v24
  v_pk_add_f32 v[64:65], v[64:65], v[24:25] op_sel_hi:[1,0] neg_lo:[0,1] neg_hi:[0,1]
  v_pk_add_f32 v[66:67], v[66:67], v[24:25] op_sel_hi:[1,0] neg_lo:[0,1] neg_hi:[0,1]
  v_pk_add_f32 v[68:69], v[68:69], v[24:25] op_sel_hi:[1,0] neg_lo:[0,1] neg_hi:[0,1]
  v_pk_add_f32 v[70:71], v[70:71], v[24:25] op_sel_hi:[1,0] neg_lo:[0,1] neg_hi:[0,1]
  v_pk_add_f32 v[72:73], v[72:73], v[24:25] op_sel_hi:[1,0] neg_lo:[0,1] neg_hi:[0,1]
  v_pk_add_f32 v[74:75], v[74:75], v[24:25] op_sel_hi:[1,0] neg_lo:[0,1] neg_hi:[0,1]
  v_pk_add_f32 v[76:77], v[76:77], v[24:25] op_sel_hi:[1,0] neg_lo:[0,1] neg_hi:[0,1]
  v_pk_add_f32 v[78:79], v[78:79], v[24:25] op_sel_hi:[1,0] neg_lo:[0,1] neg_hi:[0,1]
  v_pk_add_f32 v[80:81], v[80:81], v[24:25] op_sel_hi:[1,0] neg_lo:[0,1] neg_hi:[0,1]
  v_pk_add_f32 v[82:83], v[82:83], v[24:25] op_sel_hi:[1,0] neg_lo:[0,1] neg_hi:[0,1]
  v_pk_add_f32 v[84:85], v[84:85], v[24:25] op_sel_hi:[1,0] neg_lo:[0,1] neg_hi:[0,1]
  v_pk_add_f32 v[86:87], v[86:87], v[24:25] op_sel_hi:[1,0] neg_lo:[0,1] neg_hi:[0,1]
  v_pk_add_f32 v[88:89], v[88:89], v[24:25] op_sel_hi:[1,0] neg_lo:[0,1] neg_hi:[0,1]
  v_pk_add_f32 v[90:91], v[90:91], v[24:25] op_sel_hi:[1,0] neg_lo:[0,1] neg_hi:[0,1]
  v_pk_add_f32 v[92:93], v[92:93], v[24:25] op_sel_hi:[1,0] neg_lo:[0,1] neg_hi:[0,1]
  v_pk_add_f32 v[94:95], v[94:95], v[24:25] op_sel_hi:[1,0] neg_lo:[0,1] neg_hi:[0,1]
  v_pk_mul_f32 v[26:27], v[64:65], v[64:65]
  v_pk_mul_f32 v[28:29], v[66:67], v[66:67]
  v_pk_fma_f32 v[26:27], v[68:69], v[68:69], v[26:27]
  v_pk_fma_f32 v[28:29], v[70:71], v[70:71], v[28:29]
  v_pk_fma_f32 v[26:27], v[72:73], v[72:73], v[26:27]
  v_pk_fma_f32 v[28:29], v[74:75], v[74:75], v[28:29]
  v_pk_fma_f32 v[26:27], v[76:77], v[76:77], v[26:27]
  v_pk_fma_f32 v[28:29], v[78:79], v[78:79], v[28:29]
  v_pk_fma_f32 v[26:27], v[80:81], v[80:81], v[26:27]
  v_pk_fma_f32 v[28:29], v[82:83], v[82:83], v[28:29]
  v_pk_fma_f32 v[26:27], v[84:85], v[84:85], v[26:27]
  v_pk_fma_f32 v[28:29], v[86:87], v[86:87], v[28:29]
  v_pk_fma_f32 v[26:27], v[88:89], v[88:89], v[26:27]
  v_pk_fma_f32 v[28:29], v[90:91], v[90:91], v[28:29]
  v_pk_fma_f32 v[26:27], v[92:93], v[92:93], v[26:27]
  v_pk_fma_f32 v[28:29], v[94:95], v[94:95], v[28:29]
  v_pk_add_f32 v[26:27], v[26:27], v[28:29]
  v_add_f32 v25, v26, v27
  v_mov_b32 v26, v25
  s_nop 1
  v_permlane32_swap_b32 v25, v26
  v_add_f32 v25, v25, v26
  v_mov_b32 v26, v25
  s_nop 1
  v_permlane16_swap_b32 v25, v26
  v_add_f32 v25, v25, v26

  v_and_b32 v26, 15, v0
  v_lshlrev_b32 v26, 5, v26
  s_lshl_b32 s26, s18, 3
  v_add_u32 v27, s26, v26
  ds_write_b64 v27, v[24:25] offset:0
  s_waitcnt lgkmcnt(0)
  s_barrier
  ds_read_b128 v[28:31], v26 offset:0
  ds_read_b128 v[32:35], v26 offset:16
  s_waitcnt lgkmcnt(0)
  v_add_f32 v25, v28, v30
  v_add_f32 v26, v32, v34
  v_add_f32 v25, v25, v26
  v_mul_f32 v25, 0.25, v25
  v_add_f32 v29, v29, v31
  v_add_f32 v33, v33, v35
  v_add_f32 v29, v29, v33
  v_sub_f32 v28, v28, v25
  v_sub_f32 v30, v30, v25
  v_sub_f32 v32, v32, v25
  v_sub_f32 v34, v34, v25
  v_mul_f32 v28, v28, v28
  v_fmac_f32 v28, v30, v30
  v_fmac_f32 v28, v32, v32
  v_fmac_f32 v28, v34, v34
  v_fmac_f32 v29, 0x43000000, v28
  v_mul_f32 v29, 0x3b000000, v29
  v_add_f32 v30, 0x3727c5ac, v29
  v_rsq_f32 v30, v30
  v_sub_f32 v24, v24, v25
  v_mul_f32 v24, v24, v30

  v_pk_fma_f32 v[64:65], v[64:65], v[30:31], v[24:25] op_sel_hi:[1,0,0]
  v_pk_fma_f32 v[66:67], v[66:67], v[30:31], v[24:25] op_sel_hi:[1,0,0]
  v_pk_fma_f32 v[68:69], v[68:69], v[30:31], v[24:25] op_sel_hi:[1,0,0]
  v_pk_fma_f32 v[70:71], v[70:71], v[30:31], v[24:25] op_sel_hi:[1,0,0]
  v_pk_fma_f32 v[72:73], v[72:73], v[30:31], v[24:25] op_sel_hi:[1,0,0]
  v_pk_fma_f32 v[74:75], v[74:75], v[30:31], v[24:25] op_sel_hi:[1,0,0]
  v_pk_fma_f32 v[76:77], v[76:77], v[30:31], v[24:25] op_sel_hi:[1,0,0]
  v_pk_fma_f32 v[78:79], v[78:79], v[30:31], v[24:25] op_sel_hi:[1,0,0]
  v_pk_fma_f32 v[80:81], v[80:81], v[30:31], v[24:25] op_sel_hi:[1,0,0]
  v_pk_fma_f32 v[82:83], v[82:83], v[30:31], v[24:25] op_sel_hi:[1,0,0]
  v_pk_fma_f32 v[84:85], v[84:85], v[30:31], v[24:25] op_sel_hi:[1,0,0]
  v_pk_fma_f32 v[86:87], v[86:87], v[30:31], v[24:25] op_sel_hi:[1,0,0]
  v_pk_fma_f32 v[88:89], v[88:89], v[30:31], v[24:25] op_sel_hi:[1,0,0]
  v_pk_fma_f32 v[90:91], v[90:91], v[30:31], v[24:25] op_sel_hi:[1,0,0]
  v_pk_fma_f32 v[92:93], v[92:93], v[30:31], v[24:25] op_sel_hi:[1,0,0]
  v_pk_fma_f32 v[94:95], v[94:95], v[30:31], v[24:25] op_sel_hi:[1,0,0]
  v_cvt_pk_bf16_f32 v40, v64, v65
  v_cvt_pk_bf16_f32 v41, v66, v67
  v_cvt_pk_bf16_f32 v42, v68, v69
  v_cvt_pk_bf16_f32 v43, v70, v71
  v_cvt_pk_bf16_f32 v44, v72, v73
  v_cvt_pk_bf16_f32 v45, v74, v75
  v_cvt_pk_bf16_f32 v46, v76, v77
  v_cvt_pk_bf16_f32 v47, v78, v79
  v_cvt_pk_bf16_f32 v48, v80, v81
  v_cvt_pk_bf16_f32 v49, v82, v83
  v_cvt_pk_bf16_f32 v50, v84, v85
  v_cvt_pk_bf16_f32 v51, v86, v87
  v_cvt_pk_bf16_f32 v52, v88, v89
  v_cvt_pk_bf16_f32 v53, v90, v91
  v_cvt_pk_bf16_f32 v54, v92, v93
  v_cvt_pk_bf16_f32 v55, v94, v95
  v_lshlrev_b32 v6, 4, v0
  s_lshl_b32 s26, s17, 14
  s_lshl_b32 s27, s18, 12
  s_add_u32 s26, s26, s27
  s_add_u32 s26, s26, 0
  s_add_u32 s28, s12, s26
  s_addc_u32 s29, s13, 0

  global_store_dwordx4 v6, v[40:43], s[28:29] offset:0 sc1
  global_store_dwordx4 v6, v[44:47], s[28:29] offset:1024 sc1
  global_store_dwordx4 v6, v[48:51], s[28:29] offset:2048 sc1
  global_store_dwordx4 v6, v[52:55], s[28:29] offset:3072 sc1
mega_kernel_v_pre_b:
  s_waitcnt vmcnt(0)
  s_cmp_eq_u32 s39, 1
  s_cbranch_scc0 mega_kernel_v_pre_c
  s_barrier
  s_cmp_eq_u32 s18, 0
  s_cbranch_scc0 mega_kernel_v_pre_c
  v_mov_b32 v100, 32
  v_mov_b32 v101, 1
  v_cmp_eq_u32 vcc, 0, v0
  s_and_saveexec_b64 s[62:63], vcc
  global_atomic_add v100, v101, s[58:59]
  s_mov_b64 exec, s[62:63]

mega_kernel_v_pre_c:
  s_waitcnt vmcnt(32)
  ds_read_b64_tr_b16 a[0:1], v3 offset:0
  ds_read_b64_tr_b16 a[2:3], v3 offset:512
  ds_read_b64_tr_b16 a[4:5], v3 offset:8
  ds_read_b64_tr_b16 a[6:7], v3 offset:520
  ds_read_b64_tr_b16 a[8:9], v3 offset:64
  ds_read_b64_tr_b16 a[10:11], v3 offset:576
  ds_read_b64_tr_b16 a[12:13], v3 offset:72
  ds_read_b64_tr_b16 a[14:15], v3 offset:584
  s_waitcnt lgkmcnt(0)

  s_add_u32 s8, s4, 2359296
  s_addc_u32 s9, s5, 0
  s_add_u32 m0, s24, 0
  s_nop 0
  global_load_lds_dwordx4 v2, s[8:9]

  s_add_u32 s8, s4, 2424832
  s_addc_u32 s9, s5, 0
  s_add_u32 m0, s24, 1024
  s_nop 0
  global_load_lds_dwordx4 v2, s[8:9]

  s_add_u32 s8, s4, 2490368
  s_addc_u32 s9, s5, 0
  s_add_u32 m0, s24, 2048
  s_nop 0
  global_load_lds_dwordx4 v2, s[8:9]

  s_add_u32 s8, s4, 2555904
  s_addc_u32 s9, s5, 0
  s_add_u32 m0, s24, 3072
  s_nop 0
  global_load_lds_dwordx4 v2, s[8:9]

  s_waitcnt vmcnt(32)
  ds_read_b64_tr_b16 a[16:17], v3 offset:4096
  ds_read_b64_tr_b16 a[18:19], v3 offset:4608
  ds_read_b64_tr_b16 a[20:21], v3 offset:4104
  ds_read_b64_tr_b16 a[22:23], v3 offset:4616
  ds_read_b64_tr_b16 a[24:25], v3 offset:4160
  ds_read_b64_tr_b16 a[26:27], v3 offset:4672
  ds_read_b64_tr_b16 a[28:29], v3 offset:4168
  ds_read_b64_tr_b16 a[30:31], v3 offset:4680
  s_waitcnt lgkmcnt(0)

  s_add_u32 s8, s4, 2621440
  s_addc_u32 s9, s5, 0
  s_add_u32 m0, s24, 4096
  s_nop 0
  global_load_lds_dwordx4 v2, s[8:9]

  s_add_u32 s8, s4, 2686976
  s_addc_u32 s9, s5, 0
  s_add_u32 m0, s24, 5120
  s_nop 0
  global_load_lds_dwordx4 v2, s[8:9]

  s_add_u32 s8, s4, 2752512
  s_addc_u32 s9, s5, 0
  s_add_u32 m0, s24, 6144
  s_nop 0
  global_load_lds_dwordx4 v2, s[8:9]

  s_add_u32 s8, s4, 2818048
  s_addc_u32 s9, s5, 0
  s_add_u32 m0, s24, 7168
  s_nop 0
  global_load_lds_dwordx4 v2, s[8:9]

  s_waitcnt vmcnt(32)
  ds_read_b64_tr_b16 a[32:33], v3 offset:8192
  ds_read_b64_tr_b16 a[34:35], v3 offset:8704
  ds_read_b64_tr_b16 a[36:37], v3 offset:8200
  ds_read_b64_tr_b16 a[38:39], v3 offset:8712
  ds_read_b64_tr_b16 a[40:41], v3 offset:8256
  ds_read_b64_tr_b16 a[42:43], v3 offset:8768
  ds_read_b64_tr_b16 a[44:45], v3 offset:8264
  ds_read_b64_tr_b16 a[46:47], v3 offset:8776
  s_waitcnt lgkmcnt(0)

  s_add_u32 s8, s4, 2883584
  s_addc_u32 s9, s5, 0
  s_add_u32 m0, s24, 8192
  s_nop 0
  global_load_lds_dwordx4 v2, s[8:9]

  s_add_u32 s8, s4, 2949120
  s_addc_u32 s9, s5, 0
  s_add_u32 m0, s24, 9216
  s_nop 0
  global_load_lds_dwordx4 v2, s[8:9]

  s_add_u32 s8, s4, 3014656
  s_addc_u32 s9, s5, 0
  s_add_u32 m0, s24, 10240
  s_nop 0
  global_load_lds_dwordx4 v2, s[8:9]

  s_add_u32 s8, s4, 3080192
  s_addc_u32 s9, s5, 0
  s_add_u32 m0, s24, 11264
  s_nop 0
  global_load_lds_dwordx4 v2, s[8:9]

  s_waitcnt vmcnt(32)
  ds_read_b64_tr_b16 a[48:49], v3 offset:12288
  ds_read_b64_tr_b16 a[50:51], v3 offset:12800
  ds_read_b64_tr_b16 a[52:53], v3 offset:12296
  ds_read_b64_tr_b16 a[54:55], v3 offset:12808
  ds_read_b64_tr_b16 a[56:57], v3 offset:12352
  ds_read_b64_tr_b16 a[58:59], v3 offset:12864
  ds_read_b64_tr_b16 a[60:61], v3 offset:12360
  ds_read_b64_tr_b16 a[62:63], v3 offset:12872
  s_waitcnt lgkmcnt(0)

  s_add_u32 s8, s4, 3145728
  s_addc_u32 s9, s5, 0
  s_add_u32 m0, s24, 12288
  s_nop 0
  global_load_lds_dwordx4 v2, s[8:9]

  s_add_u32 s8, s4, 3211264
  s_addc_u32 s9, s5, 0
  s_add_u32 m0, s24, 13312
  s_nop 0
  global_load_lds_dwordx4 v2, s[8:9]

  s_add_u32 s8, s4, 3276800
  s_addc_u32 s9, s5, 0
  s_add_u32 m0, s24, 14336
  s_nop 0
  global_load_lds_dwordx4 v2, s[8:9]

  s_add_u32 s8, s4, 3342336
  s_addc_u32 s9, s5, 0
  s_add_u32 m0, s24, 15360
  s_nop 0
  global_load_lds_dwordx4 v2, s[8:9]

  s_waitcnt vmcnt(32)
  ds_read_b64_tr_b16 a[64:65], v3 offset:16384
  ds_read_b64_tr_b16 a[66:67], v3 offset:16896
  ds_read_b64_tr_b16 a[68:69], v3 offset:16392
  ds_read_b64_tr_b16 a[70:71], v3 offset:16904
  ds_read_b64_tr_b16 a[72:73], v3 offset:16448
  ds_read_b64_tr_b16 a[74:75], v3 offset:16960
  ds_read_b64_tr_b16 a[76:77], v3 offset:16456
  ds_read_b64_tr_b16 a[78:79], v3 offset:16968
  s_waitcnt lgkmcnt(0)

  s_add_u32 s8, s4, 3407872
  s_addc_u32 s9, s5, 0
  s_add_u32 m0, s24, 16384
  s_nop 0
  global_load_lds_dwordx4 v2, s[8:9]

  s_add_u32 s8, s4, 3473408
  s_addc_u32 s9, s5, 0
  s_add_u32 m0, s24, 17408
  s_nop 0
  global_load_lds_dwordx4 v2, s[8:9]

  s_add_u32 s8, s4, 3538944
  s_addc_u32 s9, s5, 0
  s_add_u32 m0, s24, 18432
  s_nop 0
  global_load_lds_dwordx4 v2, s[8:9]

  s_add_u32 s8, s4, 3604480
  s_addc_u32 s9, s5, 0
  s_add_u32 m0, s24, 19456
  s_nop 0
  global_load_lds_dwordx4 v2, s[8:9]

  s_waitcnt vmcnt(32)
  ds_read_b64_tr_b16 a[80:81], v3 offset:20480
  ds_read_b64_tr_b16 a[82:83], v3 offset:20992
  ds_read_b64_tr_b16 a[84:85], v3 offset:20488
  ds_read_b64_tr_b16 a[86:87], v3 offset:21000
  ds_read_b64_tr_b16 a[88:89], v3 offset:20544
  ds_read_b64_tr_b16 a[90:91], v3 offset:21056
  ds_read_b64_tr_b16 a[92:93], v3 offset:20552
  ds_read_b64_tr_b16 a[94:95], v3 offset:21064
  s_waitcnt lgkmcnt(0)

  s_add_u32 s8, s4, 3670016
  s_addc_u32 s9, s5, 0
  s_add_u32 m0, s24, 20480
  s_nop 0
  global_load_lds_dwordx4 v2, s[8:9]

  s_add_u32 s8, s4, 3735552
  s_addc_u32 s9, s5, 0
  s_add_u32 m0, s24, 21504
  s_nop 0
  global_load_lds_dwordx4 v2, s[8:9]

  s_add_u32 s8, s4, 3801088
  s_addc_u32 s9, s5, 0
  s_add_u32 m0, s24, 22528
  s_nop 0
  global_load_lds_dwordx4 v2, s[8:9]

  s_add_u32 s8, s4, 3866624
  s_addc_u32 s9, s5, 0
  s_add_u32 m0, s24, 23552
  s_nop 0
  global_load_lds_dwordx4 v2, s[8:9]

  s_waitcnt vmcnt(32)
  ds_read_b64_tr_b16 a[96:97], v3 offset:24576
  ds_read_b64_tr_b16 a[98:99], v3 offset:25088
  ds_read_b64_tr_b16 a[100:101], v3 offset:24584
  ds_read_b64_tr_b16 a[102:103], v3 offset:25096
  ds_read_b64_tr_b16 a[104:105], v3 offset:24640
  ds_read_b64_tr_b16 a[106:107], v3 offset:25152
  ds_read_b64_tr_b16 a[108:109], v3 offset:24648
  ds_read_b64_tr_b16 a[110:111], v3 offset:25160
  s_waitcnt lgkmcnt(0)

  s_add_u32 s8, s4, 3932160
  s_addc_u32 s9, s5, 0
  s_add_u32 m0, s24, 24576
  s_nop 0
  global_load_lds_dwordx4 v2, s[8:9]

  s_add_u32 s8, s4, 3997696
  s_addc_u32 s9, s5, 0
  s_add_u32 m0, s24, 25600
  s_nop 0
  global_load_lds_dwordx4 v2, s[8:9]

  s_add_u32 s8, s4, 4063232
  s_addc_u32 s9, s5, 0
  s_add_u32 m0, s24, 26624
  s_nop 0
  global_load_lds_dwordx4 v2, s[8:9]

  s_add_u32 s8, s4, 4128768
  s_addc_u32 s9, s5, 0
  s_add_u32 m0, s24, 27648
  s_nop 0
  global_load_lds_dwordx4 v2, s[8:9]

  s_waitcnt vmcnt(32)
  ds_read_b64_tr_b16 a[112:113], v3 offset:28672
  ds_read_b64_tr_b16 a[114:115], v3 offset:29184
  ds_read_b64_tr_b16 a[116:117], v3 offset:28680
  ds_read_b64_tr_b16 a[118:119], v3 offset:29192
  ds_read_b64_tr_b16 a[120:121], v3 offset:28736
  ds_read_b64_tr_b16 a[122:123], v3 offset:29248
  ds_read_b64_tr_b16 a[124:125], v3 offset:28744
  ds_read_b64_tr_b16 a[126:127], v3 offset:29256
  s_waitcnt vmcnt(28)
  ds_read_b64_tr_b16 a[128:129], v3 offset:32768
  ds_read_b64_tr_b16 a[130:131], v3 offset:33280
  ds_read_b64_tr_b16 a[132:133], v3 offset:32776
  ds_read_b64_tr_b16 a[134:135], v3 offset:33288
  ds_read_b64_tr_b16 a[136:137], v3 offset:32832
  ds_read_b64_tr_b16 a[138:139], v3 offset:33344
  ds_read_b64_tr_b16 a[140:141], v3 offset:32840
  ds_read_b64_tr_b16 a[142:143], v3 offset:33352
  s_waitcnt vmcnt(24)
  ds_read_b64_tr_b16 a[144:145], v3 offset:0
  ds_read_b64_tr_b16 a[146:147], v3 offset:512
  ds_read_b64_tr_b16 a[148:149], v3 offset:8
  ds_read_b64_tr_b16 a[150:151], v3 offset:520
  ds_read_b64_tr_b16 a[152:153], v3 offset:64
  ds_read_b64_tr_b16 a[154:155], v3 offset:576
  ds_read_b64_tr_b16 a[156:157], v3 offset:72
  ds_read_b64_tr_b16 a[158:159], v3 offset:584
  s_waitcnt vmcnt(20)
  ds_read_b64_tr_b16 a[160:161], v3 offset:4096
  ds_read_b64_tr_b16 a[162:163], v3 offset:4608
  ds_read_b64_tr_b16 a[164:165], v3 offset:4104
  ds_read_b64_tr_b16 a[166:167], v3 offset:4616
  ds_read_b64_tr_b16 a[168:169], v3 offset:4160
  ds_read_b64_tr_b16 a[170:171], v3 offset:4672
  ds_read_b64_tr_b16 a[172:173], v3 offset:4168
  ds_read_b64_tr_b16 a[174:175], v3 offset:4680
  s_waitcnt vmcnt(16)
  ds_read_b64_tr_b16 a[176:177], v3 offset:8192
  ds_read_b64_tr_b16 a[178:179], v3 offset:8704
  ds_read_b64_tr_b16 a[180:181], v3 offset:8200
  ds_read_b64_tr_b16 a[182:183], v3 offset:8712
  ds_read_b64_tr_b16 a[184:185], v3 offset:8256
  ds_read_b64_tr_b16 a[186:187], v3 offset:8768
  ds_read_b64_tr_b16 a[188:189], v3 offset:8264
  ds_read_b64_tr_b16 a[190:191], v3 offset:8776
  s_waitcnt vmcnt(12)
  ds_read_b64_tr_b16 a[192:193], v3 offset:12288
  ds_read_b64_tr_b16 a[194:195], v3 offset:12800
  ds_read_b64_tr_b16 a[196:197], v3 offset:12296
  ds_read_b64_tr_b16 a[198:199], v3 offset:12808
  ds_read_b64_tr_b16 a[200:201], v3 offset:12352
  ds_read_b64_tr_b16 a[202:203], v3 offset:12864
  ds_read_b64_tr_b16 a[204:205], v3 offset:12360
  ds_read_b64_tr_b16 a[206:207], v3 offset:12872
  s_waitcnt vmcnt(8)
  ds_read_b64_tr_b16 a[208:209], v3 offset:16384
  ds_read_b64_tr_b16 a[210:211], v3 offset:16896
  ds_read_b64_tr_b16 a[212:213], v3 offset:16392
  ds_read_b64_tr_b16 a[214:215], v3 offset:16904
  ds_read_b64_tr_b16 a[216:217], v3 offset:16448
  ds_read_b64_tr_b16 a[218:219], v3 offset:16960
  ds_read_b64_tr_b16 a[220:221], v3 offset:16456
  ds_read_b64_tr_b16 a[222:223], v3 offset:16968
  s_waitcnt vmcnt(4)
  ds_read_b64_tr_b16 a[224:225], v3 offset:20480
  ds_read_b64_tr_b16 a[226:227], v3 offset:20992
  ds_read_b64_tr_b16 a[228:229], v3 offset:20488
  ds_read_b64_tr_b16 a[230:231], v3 offset:21000
  ds_read_b64_tr_b16 a[232:233], v3 offset:20544
  ds_read_b64_tr_b16 a[234:235], v3 offset:21056
  ds_read_b64_tr_b16 a[236:237], v3 offset:20552
  ds_read_b64_tr_b16 a[238:239], v3 offset:21064
  s_waitcnt vmcnt(0)
  ds_read_b64_tr_b16 a[240:241], v3 offset:24576
  ds_read_b64_tr_b16 a[242:243], v3 offset:25088
  ds_read_b64_tr_b16 a[244:245], v3 offset:24584
  ds_read_b64_tr_b16 a[246:247], v3 offset:25096
  ds_read_b64_tr_b16 a[248:249], v3 offset:24640
  ds_read_b64_tr_b16 a[250:251], v3 offset:25152
  ds_read_b64_tr_b16 a[252:253], v3 offset:24648
  ds_read_b64_tr_b16 a[254:255], v3 offset:25160
  s_waitcnt lgkmcnt(0)
  s_barrier
  s_mov_b64 s[10:11], s[14:15]
  s_mov_b64 s[14:15], s[58:59]
  s_mov_b32 s28, 32
  s_cmp_eq_u32 s18, 0
  s_cbranch_scc0 mega_kernel_p1_3
  v_mov_b32 v2, s28
  s_mov_b32 s27, 0
mega_kernel_pl_4:
  global_load_dword v3, v2, s[14:15] sc1
  s_add_u32 s27, s27, 1
  s_cmp_gt_u32 s27, 50000000
  s_cbranch_scc1 mega_kernel_fail
  s_waitcnt vmcnt(0)
  v_readfirstlane_b32 s26, v3
  s_nop 3
  s_cmp_ge_u32 s26, 128
  s_cbranch_scc1 mega_kernel_pl_4_ok
  s_sleep 8
  s_branch mega_kernel_pl_4
mega_kernel_pl_4_ok:

mega_kernel_p1_3:
  s_barrier
  s_mov_b64 s[14:15], s[10:11]
  s_lshl_b32 s26, s18, 13
  s_mov_b32 s28, 0
  s_add_u32 s10, s28, s26
  s_add_u32 m0, s10, 0
  s_lshl_b32 s11, s37, 10
  s_add_u32 s11, s11, 0
  s_add_u32 s8, s6, s11
  s_addc_u32 s9, s7, 0
  global_load_lds_dwordx4 v1, s[8:9] sc1
  global_load_lds_dwordx4 v1, s[8:9] offset:1024 sc1
  global_load_lds_dwordx4 v1, s[8:9] offset:2048 sc1
  global_load_lds_dwordx4 v1, s[8:9] offset:3072 sc1
  s_add_u32 s10, s28, s26
  s_add_u32 m0, s10, 4096
  s_lshl_b32 s11, s37, 10
  s_add_u32 s11, s11, 4096
  s_add_u32 s8, s6, s11
  s_addc_u32 s9, s7, 0
  global_load_lds_dwordx4 v1, s[8:9] sc1
  global_load_lds_dwordx4 v1, s[8:9] offset:1024 sc1
  global_load_lds_dwordx4 v1, s[8:9] offset:2048 sc1
  global_load_lds_dwordx4 v1, s[8:9] offset:3072 sc1
  s_add_u32 s6, s6, s21
  s_addc_u32 s7, s7, 0
  s_mov_b32 s28, 32768
  s_add_u32 s10, s28, s26
  s_add_u32 m0, s10, 0
  s_lshl_b32 s11, s37, 10
  s_add_u32 s11, s11, 0
  s_add_u32 s8, s6, s11
  s_addc_u32 s9, s7, 0
  global_load_lds_dwordx4 v1, s[8:9] sc1
  global_load_lds_dwordx4 v1, s[8:9] offset:1024 sc1
  global_load_lds_dwordx4 v1, s[8:9] offset:2048 sc1
  global_load_lds_dwordx4 v1, s[8:9] offset:3072 sc1
  s_add_u32 s10, s28, s26
  s_add_u32 m0, s10, 4096
  s_lshl_b32 s11, s37, 10
  s_add_u32 s11, s11, 4096
  s_add_u32 s8, s6, s11
  s_addc_u32 s9, s7, 0
  global_load_lds_dwordx4 v1, s[8:9] sc1
  global_load_lds_dwordx4 v1, s[8:9] offset:1024 sc1
  global_load_lds_dwordx4 v1, s[8:9] offset:2048 sc1
  global_load_lds_dwordx4 v1, s[8:9] offset:3072 sc1
  s_add_u32 s6, s6, s21
  s_addc_u32 s7, s7, 0
  s_mov_b32 s19, 0
  s_mov_b32 s29, 0
  s_mov_b32 s28, 65536
  v_add_u32 v4, 4096, v1
  s_add_u32 s27, s19, 1
  s_cmp_lt_u32 s27, s20
  s_cbranch_scc1 mega_kernel_v_b0_w1
  s_waitcnt vmcnt(0)
mega_kernel_v_b0_w1:
  s_cmp_lt_u32 s19, 3
  s_cbranch_scc0 mega_kernel_v_b0_w2
  s_waitcnt vmcnt(8)
mega_kernel_v_b0_w2:
  s_waitcnt vmcnt(12)
  s_barrier
  s_add_u32 s27, s18, s16
  s_lshl_b32 s27, s27, 8
  s_add_u32 s27, s27, s19
  s_mov_b32 s10, 1664
  s_cmp_eq_u32 s27, 5
  s_cbranch_scc1 mega_kernel_v_b0_ye
  s_mov_b32 s10, s35
  s_cmp_eq_u32 s27, 1
  s_cbranch_scc0 mega_kernel_v_b0_ne
mega_kernel_v_b0_ye:
  v_mov_b32 v5, s10
  v_mov_b32 v6, 1
  v_cmp_eq_u32 vcc, 0, v0
  s_and_saveexec_b64 s[62:63], vcc
  global_atomic_add v5, v6, s[14:15]
  s_mov_b64 exec, s[62:63]
mega_kernel_v_b0_ne:
  v_add_u32 v5, s29, v1

  ds_read_b128 v[8:11], v5 offset:0
  ds_read_b128 v[12:15], v5 offset:16384
  ds_read_b128 v[16:19], v5 offset:1024
  ds_read_b128 v[20:23], v5 offset:17408
  ds_read_b128 v[24:27], v5 offset:2048
  ds_read_b128 v[28:31], v5 offset:18432
  s_waitcnt lgkmcnt(4)
  v_mfma_f32_16x16x32_bf16 v[40:43], v[8:11], a[0:3], 0
  ds_read_b128 v[32:35], v5 offset:3072
  ds_read_b128 v[36:39], v5 offset:19456
  v_mfma_f32_16x16x32_bf16 v[44:47], v[8:11], a[4:7], 0
  v_mfma_f32_16x16x32_bf16 v[48:51], v[8:11], a[8:11], 0
  v_mfma_f32_16x16x32_bf16 v[52:55], v[8:11], a[12:15], 0
  v_mfma_f32_16x16x32_bf16 v[56:59], v[12:15], a[0:3], 0
  v_mfma_f32_16x16x32_bf16 v[60:63], v[12:15], a[4:7], 0
  v_mfma_f32_16x16x32_bf16 v[64:67], v[12:15], a[8:11], 0
  v_mfma_f32_16x16x32_bf16 v[68:71], v[12:15], a[12:15], 0
  s_waitcnt lgkmcnt(4)
  v_mfma_f32_16x16x32_bf16 v[40:43], v[16:19], a[16:19], v[40:43]
  ds_read_b128 v[8:11], v5 offset:4096
  ds_read_b128 v[12:15], v5 offset:20480
  v_mfma_f32_16x16x32_bf16 v[44:47], v[16:19], a[20:23], v[44:47]
  v_mfma_f32_16x16x32_bf16 v[48:51], v[16:19], a[24:27], v[48:51]
  v_mfma_f32_16x16x32_bf16 v[52:55], v[16:19], a[28:31], v[52:55]
  v_mfma_f32_16x16x32_bf16 v[56:59], v[20:23], a[16:19], v[56:59]
  v_mfma_f32_16x16x32_bf16 v[60:63], v[20:23], a[20:23], v[60:63]
  v_mfma_f32_16x16x32_bf16 v[64:67], v[20:23], a[24:27], v[64:67]
  v_mfma_f32_16x16x32_bf16 v[68:71], v[20:23], a[28:31], v[68:71]
  s_waitcnt lgkmcnt(4)
  v_mfma_f32_16x16x32_bf16 v[40:43], v[24:27], a[32:35], v[40:43]
  ds_read_b128 v[16:19], v5 offset:5120
  ds_read_b128 v[20:23], v5 offset:21504
  v_mfma_f32_16x16x32_bf16 v[44:47], v[24:27], a[36:39], v[44:47]
  v_mfma_f32_16x16x32_bf16 v[48:51], v[24:27], a[40:43], v[48:51]
  v_mfma_f32_16x16x32_bf16 v[52:55], v[24:27], a[44:47], v[52:55]
  v_mfma_f32_16x16x32_bf16 v[56:59], v[28:31], a[32:35], v[56:59]
  v_mfma_f32_16x16x32_bf16 v[60:63], v[28:31], a[36:39], v[60:63]
  v_mfma_f32_16x16x32_bf16 v[64:67], v[28:31], a[40:43], v[64:67]
  v_mfma_f32_16x16x32_bf16 v[68:71], v[28:31], a[44:47], v[68:71]
  s_waitcnt lgkmcnt(4)
  v_mfma_f32_16x16x32_bf16 v[40:43], v[32:35], a[48:51], v[40:43]
  ds_read_b128 v[24:27], v5 offset:6144
  ds_read_b128 v[28:31], v5 offset:22528
  v_mfma_f32_16x16x32_bf16 v[44:47], v[32:35], a[52:55], v[44:47]
  v_mfma_f32_16x16x32_bf16 v[48:51], v[32:35], a[56:59], v[48:51]
  v_mfma_f32_16x16x32_bf16 v[52:55], v[32:35], a[60:63], v[52:55]
  v_mfma_f32_16x16x32_bf16 v[56:59], v[36:39], a[48:51], v[56:59]
  v_mfma_f32_16x16x32_bf16 v[60:63], v[36:39], a[52:55], v[60:63]
  v_mfma_f32_16x16x32_bf16 v[64:67], v[36:39], a[56:59], v[64:67]
  v_mfma_f32_16x16x32_bf16 v[68:71], v[36:39], a[60:63], v[68:71]
  s_waitcnt lgkmcnt(4)
  v_mfma_f32_16x16x32_bf16 v[40:43], v[8:11], a[64:67], v[40:43]
  ds_read_b128 v[32:35], v5 offset:7168
  ds_read_b128 v[36:39], v5 offset:23552
  v_mfma_f32_16x16x32_bf16 v[44:47], v[8:11], a[68:71], v[44:47]
  v_mfma_f32_16x16x32_bf16 v[48:51], v[8:11], a[72:75], v[48:51]
  v_mfma_f32_16x16x32_bf16 v[52:55], v[8:11], a[76:79], v[52:55]
  v_mfma_f32_16x16x32_bf16 v[56:59], v[12:15], a[64:67], v[56:59]
  v_mfma_f32_16x16x32_bf16 v[60:63], v[12:15], a[68:71], v[60:63]
  v_mfma_f32_16x16x32_bf16 v[64:67], v[12:15], a[72:75], v[64:67]
  v_mfma_f32_16x16x32_bf16 v[68:71], v[12:15], a[76:79], v[68:71]
  s_waitcnt lgkmcnt(4)
  v_mfma_f32_16x16x32_bf16 v[40:43], v[16:19], a[80:83], v[40:43]
  ds_read_b128 v[8:11], v5 offset:8192
  ds_read_b128 v[12:15], v5 offset:24576
  v_mfma_f32_16x16x32_bf16 v[44:47], v[16:19], a[84:87], v[44:47]
  v_mfma_f32_16x16x32_bf16 v[48:51], v[16:19], a[88:91], v[48:51]
  v_mfma_f32_16x16x32_bf16 v[52:55], v[16:19], a[92:95], v[52:55]
  v_mfma_f32_16x16x32_bf16 v[56:59], v[20:23], a[80:83], v[56:59]
  v_mfma_f32_16x16x32_bf16 v[60:63], v[20:23], a[84:87], v[60:63]
  v_mfma_f32_16x16x32_bf16 v[64:67], v[20:23], a[88:91], v[64:67]
  v_mfma_f32_16x16x32_bf16 v[68:71], v[20:23], a[92:95], v[68:71]
  s_add_u32 s27, s19, 2
  s_cmp_lt_u32 s27, s20
  s_cbranch_scc0 mega_kernel_v_b0_nd
  s_add_u32 s10, s28, s26
  s_add_u32 m0, s10, 0
  s_lshl_b32 s11, s37, 10
  s_add_u32 s11, s11, 0
  s_add_u32 s8, s6, s11
  s_addc_u32 s9, s7, 0
  global_load_lds_dwordx4 v1, s[8:9] sc1
  global_load_lds_dwordx4 v1, s[8:9] offset:1024 sc1
  global_load_lds_dwordx4 v1, s[8:9] offset:2048 sc1
  global_load_lds_dwordx4 v1, s[8:9] offset:3072 sc1
  s_add_u32 s10, s28, s26
  s_add_u32 m0, s10, 4096
  s_lshl_b32 s11, s37, 10
  s_add_u32 s11, s11, 4096
  s_add_u32 s8, s6, s11
  s_addc_u32 s9, s7, 0
  global_load_lds_dwordx4 v1, s[8:9] sc1
  global_load_lds_dwordx4 v1, s[8:9] offset:1024 sc1
  global_load_lds_dwordx4 v1, s[8:9] offset:2048 sc1
  global_load_lds_dwordx4 v1, s[8:9] offset:3072 sc1
  s_add_u32 s6, s6, s21
  s_addc_u32 s7, s7, 0
mega_kernel_v_b0_nd:
  s_waitcnt lgkmcnt(4)
  v_mfma_f32_16x16x32_bf16 v[40:43], v[24:27], a[96:99], v[40:43]
  ds_read_b128 v[16:19], v5 offset:9216
  ds_read_b128 v[20:23], v5 offset:25600
  v_mfma_f32_16x16x32_bf16 v[44:47], v[24:27], a[100:103], v[44:47]
  v_mfma_f32_16x16x32_bf16 v[48:51], v[24:27], a[104:107], v[48:51]
  v_mfma_f32_16x16x32_bf16 v[52:55], v[24:27], a[108:111], v[52:55]
  v_mfma_f32_16x16x32_bf16 v[56:59], v[28:31], a[96:99], v[56:59]
  v_mfma_f32_16x16x32_bf16 v[60:63], v[28:31], a[100:103], v[60:63]
  v_mfma_f32_16x16x32_bf16 v[64:67], v[28:31], a[104:107], v[64:67]
  v_mfma_f32_16x16x32_bf16 v[68:71], v[28:31], a[108:111], v[68:71]
  s_waitcnt lgkmcnt(4)
  v_mfma_f32_16x16x32_bf16 v[40:43], v[32:35], a[112:115], v[40:43]
  ds_read_b128 v[24:27], v5 offset:10240
  ds_read_b128 v[28:31], v5 offset:26624
  v_mfma_f32_16x16x32_bf16 v[44:47], v[32:35], a[116:119], v[44:47]
  v_mfma_f32_16x16x32_bf16 v[48:51], v[32:35], a[120:123], v[48:51]
  v_mfma_f32_16x16x32_bf16 v[52:55], v[32:35], a[124:127], v[52:55]
  v_mfma_f32_16x16x32_bf16 v[56:59], v[36:39], a[112:115], v[56:59]
  v_mfma_f32_16x16x32_bf16 v[60:63], v[36:39], a[116:119], v[60:63]
  v_mfma_f32_16x16x32_bf16 v[64:67], v[36:39], a[120:123], v[64:67]
  v_mfma_f32_16x16x32_bf16 v[68:71], v[36:39], a[124:127], v[68:71]
  s_waitcnt lgkmcnt(4)
  v_mfma_f32_16x16x32_bf16 v[40:43], v[8:11], a[128:131], v[40:43]
  ds_read_b128 v[32:35], v5 offset:11264
  ds_read_b128 v[36:39], v5 offset:27648
  v_mfma_f32_16x16x32_bf16 v[44:47], v[8:11], a[132:135], v[44:47]
  v_mfma_f32_16x16x32_bf16 v[48:51], v[8:11], a[136:139], v[48:51]
  v_mfma_f32_16x16x32_bf16 v[52:55], v[8:11], a[140:143], v[52:55]
  v_mfma_f32_16x16x32_bf16 v[56:59], v[12:15], a[128:131], v[56:59]
  v_mfma_f32_16x16x32_bf16 v[60:63], v[12:15], a[132:135], v[60:63]
  v_mfma_f32_16x16x32_bf16 v[64:67], v[12:15], a[136:139], v[64:67]
  v_mfma_f32_16x16x32_bf16 v[68:71], v[12:15], a[140:143], v[68:71]
  s_waitcnt lgkmcnt(4)
  v_mfma_f32_16x16x32_bf16 v[40:43], v[16:19], a[144:147], v[40:43]
  ds_read_b128 v[8:11], v5 offset:12288
  ds_read_b128 v[12:15], v5 offset:28672
  v_mfma_f32_16x16x32_bf16 v[44:47], v[16:19], a[148:151], v[44:47]
  v_mfma_f32_16x16x32_bf16 v[48:51], v[16:19], a[152:155], v[48:51]
  v_mfma_f32_16x16x32_bf16 v[52:55], v[16:19], a[156:159], v[52:55]
  v_mfma_f32_16x16x32_bf16 v[56:59], v[20:23], a[144:147], v[56:59]
  v_mfma_f32_16x16x32_bf16 v[60:63], v[20:23], a[148:151], v[60:63]
  v_mfma_f32_16x16x32_bf16 v[64:67], v[20:23], a[152:155], v[64:67]
  v_mfma_f32_16x16x32_bf16 v[68:71], v[20:23], a[156:159], v[68:71]
  s_waitcnt lgkmcnt(4)
  v_mfma_f32_16x16x32_bf16 v[40:43], v[24:27], a[160:163], v[40:43]
  ds_read_b128 v[16:19], v5 offset:13312
  ds_read_b128 v[20:23], v5 offset:29696
  v_mfma_f32_16x16x32_bf16 v[44:47], v[24:27], a[164:167], v[44:47]
  v_mfma_f32_16x16x32_bf16 v[48:51], v[24:27], a[168:171], v[48:51]
  v_mfma_f32_16x16x32_bf16 v[52:55], v[24:27], a[172:175], v[52:55]
  v_mfma_f32_16x16x32_bf16 v[56:59], v[28:31], a[160:163], v[56:59]
  v_mfma_f32_16x16x32_bf16 v[60:63], v[28:31], a[164:167], v[60:63]
  v_mfma_f32_16x16x32_bf16 v[64:67], v[28:31], a[168:171], v[64:67]
  v_mfma_f32_16x16x32_bf16 v[68:71], v[28:31], a[172:175], v[68:71]
  s_waitcnt lgkmcnt(4)
  v_mfma_f32_16x16x32_bf16 v[40:43], v[32:35], a[176:179], v[40:43]
  ds_read_b128 v[24:27], v5 offset:14336
  ds_read_b128 v[28:31], v5 offset:30720
  v_mfma_f32_16x16x32_bf16 v[44:47], v[32:35], a[180:183], v[44:47]
  v_mfma_f32_16x16x32_bf16 v[48:51], v[32:35], a[184:187], v[48:51]
  v_mfma_f32_16x16x32_bf16 v[52:55], v[32:35], a[188:191], v[52:55]
  v_mfma_f32_16x16x32_bf16 v[56:59], v[36:39], a[176:179], v[56:59]
  v_mfma_f32_16x16x32_bf16 v[60:63], v[36:39], a[180:183], v[60:63]
  v_mfma_f32_16x16x32_bf16 v[64:67], v[36:39], a[184:187], v[64:67]
  v_mfma_f32_16x16x32_bf16 v[68:71], v[36:39], a[188:191], v[68:71]
  s_waitcnt lgkmcnt(4)
  v_mfma_f32_16x16x32_bf16 v[40:43], v[8:11], a[192:195], v[40:43]
  ds_read_b128 v[32:35], v5 offset:15360
  ds_read_b128 v[36:39], v5 offset:31744
  v_mfma_f32_16x16x32_bf16 v[44:47], v[8:11], a[196:199], v[44:47]
  v_mfma_f32_16x16x32_bf16 v[48:51], v[8:11], a[200:203], v[48:51]
  v_mfma_f32_16x16x32_bf16 v[52:55], v[8:11], a[204:207], v[52:55]
  v_mfma_f32_16x16x32_bf16 v[56:59], v[12:15], a[192:195], v[56:59]
  v_mfma_f32_16x16x32_bf16 v[60:63], v[12:15], a[196:199], v[60:63]
  v_mfma_f32_16x16x32_bf16 v[64:67], v[12:15], a[200:203], v[64:67]
  v_mfma_f32_16x16x32_bf16 v[68:71], v[12:15], a[204:207], v[68:71]
  s_waitcnt lgkmcnt(4)
  v_mfma_f32_16x16x32_bf16 v[40:43], v[16:19], a[208:211], v[40:43]
  v_mfma_f32_16x16x32_bf16 v[44:47], v[16:19], a[212:215], v[44:47]
  v_mfma_f32_16x16x32_bf16 v[48:51], v[16:19], a[216:219], v[48:51]
  v_mfma_f32_16x16x32_bf16 v[52:55], v[16:19], a[220:223], v[52:55]
  v_mfma_f32_16x16x32_bf16 v[56:59], v[20:23], a[208:211], v[56:59]
  v_mfma_f32_16x16x32_bf16 v[60:63], v[20:23], a[212:215], v[60:63]
  v_mfma_f32_16x16x32_bf16 v[64:67], v[20:23], a[216:219], v[64:67]
  v_mfma_f32_16x16x32_bf16 v[68:71], v[20:23], a[220:223], v[68:71]
  s_waitcnt lgkmcnt(2)
  v_mfma_f32_16x16x32_bf16 v[40:43], v[24:27], a[224:227], v[40:43]
  v_mfma_f32_16x16x32_bf16 v[44:47], v[24:27], a[228:231], v[44:47]
  v_mfma_f32_16x16x32_bf16 v[48:51], v[24:27], a[232:235], v[48:51]
  v_mfma_f32_16x16x32_bf16 v[52:55], v[24:27], a[236:239], v[52:55]
  v_mfma_f32_16x16x32_bf16 v[56:59], v[28:31], a[224:227], v[56:59]
  v_mfma_f32_16x16x32_bf16 v[60:63], v[28:31], a[228:231], v[60:63]
  v_mfma_f32_16x16x32_bf16 v[64:67], v[28:31], a[232:235], v[64:67]
  v_mfma_f32_16x16x32_bf16 v[68:71], v[28:31], a[236:239], v[68:71]
  s_waitcnt lgkmcnt(0)
  v_mfma_f32_16x16x32_bf16 v[40:43], v[32:35], a[240:243], v[40:43]
  v_mfma_f32_16x16x32_bf16 v[44:47], v[32:35], a[244:247], v[44:47]
  v_mfma_f32_16x16x32_bf16 v[48:51], v[32:35], a[248:251], v[48:51]
  v_mfma_f32_16x16x32_bf16 v[52:55], v[32:35], a[252:255], v[52:55]
  v_mfma_f32_16x16x32_bf16 v[56:59], v[36:39], a[240:243], v[56:59]
  v_mfma_f32_16x16x32_bf16 v[60:63], v[36:39], a[244:247], v[60:63]
  v_mfma_f32_16x16x32_bf16 v[64:67], v[36:39], a[248:251], v[64:67]
  v_mfma_f32_16x16x32_bf16 v[68:71], v[36:39], a[252:255], v[68:71]
  s_add_u32 s29, s29, 32768
  s_cmp_eq_u32 s29, 98304
  s_cselect_b32 s29, 0, s29
  s_add_u32 s28, s28, 32768
  s_cmp_eq_u32 s28, 98304
  s_cselect_b32 s28, 0, s28
  s_add_u32 s19, s19, 1
  s_cmp_ge_u32 s19, s20

  s_nop 7
  v_cvt_pk_bf16_f32 v104, v40, v41
  v_cvt_pk_bf16_f32 v105, v42, v43
  v_cvt_pk_bf16_f32 v106, v56, v57
  v_cvt_pk_bf16_f32 v107, v58, v59
  global_store_dwordx4 v1, v[104:107], s[22:23] offset:0 sc1
  v_cvt_pk_bf16_f32 v108, v44, v45
  v_cvt_pk_bf16_f32 v109, v46, v47
  v_cvt_pk_bf16_f32 v110, v60, v61
  v_cvt_pk_bf16_f32 v111, v62, v63
  global_store_dwordx4 v1, v[108:111], s[22:23] offset:1024 sc1
  v_cvt_pk_bf16_f32 v104, v48, v49
  v_cvt_pk_bf16_f32 v105, v50, v51
  v_cvt_pk_bf16_f32 v106, v64, v65
  v_cvt_pk_bf16_f32 v107, v66, v67
  global_store_dwordx4 v1, v[104:107], s[22:23] offset:2048 sc1
  v_cvt_pk_bf16_f32 v108, v52, v53
  v_cvt_pk_bf16_f32 v109, v54, v55
  v_cvt_pk_bf16_f32 v110, v68, v69
  v_cvt_pk_bf16_f32 v111, v70, v71
  global_store_dwordx4 v1, v[108:111], s[22:23] offset:3072 sc1
  s_add_u32 s22, s22, s25
  s_addc_u32 s23, s23, 0
  s_waitcnt vmcnt(0)
  s_add_u32 s27, s19, 1
  s_cmp_lt_u32 s27, s20
  s_cbranch_scc1 mega_kernel_v_bx_w1
  s_waitcnt vmcnt(0)
mega_kernel_v_bx_w1:
  s_cmp_lt_u32 s19, 3
  s_cbranch_scc0 mega_kernel_v_bx_w2
  s_waitcnt vmcnt(8)
mega_kernel_v_bx_w2:
  s_waitcnt vmcnt(12)
  s_barrier
  s_add_u32 s27, s18, s16
  s_lshl_b32 s27, s27, 8
  s_add_u32 s27, s27, s19
  s_mov_b32 s10, 1664
  s_cmp_eq_u32 s27, 5
  s_cbranch_scc1 mega_kernel_v_bx_ye
  s_mov_b32 s10, s35
  s_cmp_eq_u32 s27, 1
  s_cbranch_scc0 mega_kernel_v_bx_ne
mega_kernel_v_bx_ye:
  v_mov_b32 v5, s10
  v_mov_b32 v6, 1
  v_cmp_eq_u32 vcc, 0, v0
  s_and_saveexec_b64 s[62:63], vcc
  global_atomic_add v5, v6, s[14:15]
  s_mov_b64 exec, s[62:63]
mega_kernel_v_bx_ne:
  v_add_u32 v5, s29, v1

  ds_read_b128 v[8:11], v5 offset:0
  ds_read_b128 v[12:15], v5 offset:16384
  ds_read_b128 v[16:19], v5 offset:1024
  ds_read_b128 v[20:23], v5 offset:17408
  ds_read_b128 v[24:27], v5 offset:2048
  ds_read_b128 v[28:31], v5 offset:18432
  s_waitcnt lgkmcnt(4)
  v_mfma_f32_16x16x32_bf16 v[72:75], v[8:11], a[0:3], 0
  ds_read_b128 v[32:35], v5 offset:3072
  ds_read_b128 v[36:39], v5 offset:19456
  v_mfma_f32_16x16x32_bf16 v[76:79], v[8:11], a[4:7], 0
  v_mfma_f32_16x16x32_bf16 v[80:83], v[8:11], a[8:11], 0
  v_mfma_f32_16x16x32_bf16 v[84:87], v[8:11], a[12:15], 0
  v_mfma_f32_16x16x32_bf16 v[88:91], v[12:15], a[0:3], 0
  v_mfma_f32_16x16x32_bf16 v[92:95], v[12:15], a[4:7], 0
  v_mfma_f32_16x16x32_bf16 v[96:99], v[12:15], a[8:11], 0
  v_mfma_f32_16x16x32_bf16 v[100:103], v[12:15], a[12:15], 0
  s_waitcnt lgkmcnt(4)
  v_mfma_f32_16x16x32_bf16 v[72:75], v[16:19], a[16:19], v[72:75]
  ds_read_b128 v[8:11], v5 offset:4096
  ds_read_b128 v[12:15], v5 offset:20480
  v_mfma_f32_16x16x32_bf16 v[76:79], v[16:19], a[20:23], v[76:79]
  v_mfma_f32_16x16x32_bf16 v[80:83], v[16:19], a[24:27], v[80:83]
  v_mfma_f32_16x16x32_bf16 v[84:87], v[16:19], a[28:31], v[84:87]
  v_mfma_f32_16x16x32_bf16 v[88:91], v[20:23], a[16:19], v[88:91]
  v_mfma_f32_16x16x32_bf16 v[92:95], v[20:23], a[20:23], v[92:95]
  v_mfma_f32_16x16x32_bf16 v[96:99], v[20:23], a[24:27], v[96:99]
  v_mfma_f32_16x16x32_bf16 v[100:103], v[20:23], a[28:31], v[100:103]
  s_waitcnt lgkmcnt(4)
  v_mfma_f32_16x16x32_bf16 v[72:75], v[24:27], a[32:35], v[72:75]
  ds_read_b128 v[16:19], v5 offset:5120
  ds_read_b128 v[20:23], v5 offset:21504
  v_mfma_f32_16x16x32_bf16 v[76:79], v[24:27], a[36:39], v[76:79]
  v_mfma_f32_16x16x32_bf16 v[80:83], v[24:27], a[40:43], v[80:83]
  v_mfma_f32_16x16x32_bf16 v[84:87], v[24:27], a[44:47], v[84:87]
  v_mfma_f32_16x16x32_bf16 v[88:91], v[28:31], a[32:35], v[88:91]
  v_mfma_f32_16x16x32_bf16 v[92:95], v[28:31], a[36:39], v[92:95]
  v_mfma_f32_16x16x32_bf16 v[96:99], v[28:31], a[40:43], v[96:99]
  v_mfma_f32_16x16x32_bf16 v[100:103], v[28:31], a[44:47], v[100:103]
  s_waitcnt lgkmcnt(4)
  v_mfma_f32_16x16x32_bf16 v[72:75], v[32:35], a[48:51], v[72:75]
  ds_read_b128 v[24:27], v5 offset:6144
  ds_read_b128 v[28:31], v5 offset:22528
  v_mfma_f32_16x16x32_bf16 v[76:79], v[32:35], a[52:55], v[76:79]
  v_mfma_f32_16x16x32_bf16 v[80:83], v[32:35], a[56:59], v[80:83]
  v_mfma_f32_16x16x32_bf16 v[84:87], v[32:35], a[60:63], v[84:87]
  v_mfma_f32_16x16x32_bf16 v[88:91], v[36:39], a[48:51], v[88:91]
  v_mfma_f32_16x16x32_bf16 v[92:95], v[36:39], a[52:55], v[92:95]
  v_mfma_f32_16x16x32_bf16 v[96:99], v[36:39], a[56:59], v[96:99]
  v_mfma_f32_16x16x32_bf16 v[100:103], v[36:39], a[60:63], v[100:103]
  s_waitcnt lgkmcnt(4)
  v_mfma_f32_16x16x32_bf16 v[72:75], v[8:11], a[64:67], v[72:75]
  ds_read_b128 v[32:35], v5 offset:7168
  ds_read_b128 v[36:39], v5 offset:23552
  v_mfma_f32_16x16x32_bf16 v[76:79], v[8:11], a[68:71], v[76:79]
  v_mfma_f32_16x16x32_bf16 v[80:83], v[8:11], a[72:75], v[80:83]
  v_mfma_f32_16x16x32_bf16 v[84:87], v[8:11], a[76:79], v[84:87]
  v_mfma_f32_16x16x32_bf16 v[88:91], v[12:15], a[64:67], v[88:91]
  v_mfma_f32_16x16x32_bf16 v[92:95], v[12:15], a[68:71], v[92:95]
  v_mfma_f32_16x16x32_bf16 v[96:99], v[12:15], a[72:75], v[96:99]
  v_mfma_f32_16x16x32_bf16 v[100:103], v[12:15], a[76:79], v[100:103]
  s_waitcnt lgkmcnt(4)
  v_mfma_f32_16x16x32_bf16 v[72:75], v[16:19], a[80:83], v[72:75]
  ds_read_b128 v[8:11], v5 offset:8192
  ds_read_b128 v[12:15], v5 offset:24576
  v_mfma_f32_16x16x32_bf16 v[76:79], v[16:19], a[84:87], v[76:79]
  v_mfma_f32_16x16x32_bf16 v[80:83], v[16:19], a[88:91], v[80:83]
  v_mfma_f32_16x16x32_bf16 v[84:87], v[16:19], a[92:95], v[84:87]
  v_mfma_f32_16x16x32_bf16 v[88:91], v[20:23], a[80:83], v[88:91]
  v_mfma_f32_16x16x32_bf16 v[92:95], v[20:23], a[84:87], v[92:95]
  v_mfma_f32_16x16x32_bf16 v[96:99], v[20:23], a[88:91], v[96:99]
  v_mfma_f32_16x16x32_bf16 v[100:103], v[20:23], a[92:95], v[100:103]
  s_add_u32 s27, s19, 2
  s_cmp_lt_u32 s27, s20
  s_cbranch_scc0 mega_kernel_v_bx_nd
  s_add_u32 s10, s28, s26
  s_add_u32 m0, s10, 0
  s_lshl_b32 s11, s37, 10
  s_add_u32 s11, s11, 0
  s_add_u32 s8, s6, s11
  s_addc_u32 s9, s7, 0
  global_load_lds_dwordx4 v1, s[8:9] sc1
  global_load_lds_dwordx4 v1, s[8:9] offset:1024 sc1
  global_load_lds_dwordx4 v1, s[8:9] offset:2048 sc1
  global_load_lds_dwordx4 v1, s[8:9] offset:3072 sc1
  s_add_u32 s10, s28, s26
  s_add_u32 m0, s10, 4096
  s_lshl_b32 s11, s37, 10
  s_add_u32 s11, s11, 4096
  s_add_u32 s8, s6, s11
  s_addc_u32 s9, s7, 0
  global_load_lds_dwordx4 v1, s[8:9] sc1
  global_load_lds_dwordx4 v1, s[8:9] offset:1024 sc1
  global_load_lds_dwordx4 v1, s[8:9] offset:2048 sc1
  global_load_lds_dwordx4 v1, s[8:9] offset:3072 sc1
  s_add_u32 s6, s6, s21
  s_addc_u32 s7, s7, 0
mega_kernel_v_bx_nd:
  s_waitcnt lgkmcnt(4)
  v_mfma_f32_16x16x32_bf16 v[72:75], v[24:27], a[96:99], v[72:75]
  ds_read_b128 v[16:19], v5 offset:9216
  ds_read_b128 v[20:23], v5 offset:25600
  v_mfma_f32_16x16x32_bf16 v[76:79], v[24:27], a[100:103], v[76:79]
  v_mfma_f32_16x16x32_bf16 v[80:83], v[24:27], a[104:107], v[80:83]
  v_mfma_f32_16x16x32_bf16 v[84:87], v[24:27], a[108:111], v[84:87]
  v_mfma_f32_16x16x32_bf16 v[88:91], v[28:31], a[96:99], v[88:91]
  v_mfma_f32_16x16x32_bf16 v[92:95], v[28:31], a[100:103], v[92:95]
  v_mfma_f32_16x16x32_bf16 v[96:99], v[28:31], a[104:107], v[96:99]
  v_mfma_f32_16x16x32_bf16 v[100:103], v[28:31], a[108:111], v[100:103]
  s_waitcnt lgkmcnt(4)
  v_mfma_f32_16x16x32_bf16 v[72:75], v[32:35], a[112:115], v[72:75]
  ds_read_b128 v[24:27], v5 offset:10240
  ds_read_b128 v[28:31], v5 offset:26624
  v_mfma_f32_16x16x32_bf16 v[76:79], v[32:35], a[116:119], v[76:79]
  v_mfma_f32_16x16x32_bf16 v[80:83], v[32:35], a[120:123], v[80:83]
  v_mfma_f32_16x16x32_bf16 v[84:87], v[32:35], a[124:127], v[84:87]
  v_mfma_f32_16x16x32_bf16 v[88:91], v[36:39], a[112:115], v[88:91]
  v_mfma_f32_16x16x32_bf16 v[92:95], v[36:39], a[116:119], v[92:95]
  v_mfma_f32_16x16x32_bf16 v[96:99], v[36:39], a[120:123], v[96:99]
  v_mfma_f32_16x16x32_bf16 v[100:103], v[36:39], a[124:127], v[100:103]
  s_waitcnt lgkmcnt(4)
  v_mfma_f32_16x16x32_bf16 v[72:75], v[8:11], a[128:131], v[72:75]
  ds_read_b128 v[32:35], v5 offset:11264
  ds_read_b128 v[36:39], v5 offset:27648
  v_mfma_f32_16x16x32_bf16 v[76:79], v[8:11], a[132:135], v[76:79]
  v_mfma_f32_16x16x32_bf16 v[80:83], v[8:11], a[136:139], v[80:83]
  v_mfma_f32_16x16x32_bf16 v[84:87], v[8:11], a[140:143], v[84:87]
  v_mfma_f32_16x16x32_bf16 v[88:91], v[12:15], a[128:131], v[88:91]
  v_mfma_f32_16x16x32_bf16 v[92:95], v[12:15], a[132:135], v[92:95]
  v_mfma_f32_16x16x32_bf16 v[96:99], v[12:15], a[136:139], v[96:99]
  v_mfma_f32_16x16x32_bf16 v[100:103], v[12:15], a[140:143], v[100:103]
  s_waitcnt lgkmcnt(4)
  v_mfma_f32_16x16x32_bf16 v[72:75], v[16:19], a[144:147], v[72:75]
  ds_read_b128 v[8:11], v5 offset:12288
  ds_read_b128 v[12:15], v5 offset:28672
  v_mfma_f32_16x16x32_bf16 v[76:79], v[16:19], a[148:151], v[76:79]
  v_mfma_f32_16x16x32_bf16 v[80:83], v[16:19], a[152:155], v[80:83]
  v_mfma_f32_16x16x32_bf16 v[84:87], v[16:19], a[156:159], v[84:87]
  v_mfma_f32_16x16x32_bf16 v[88:91], v[20:23], a[144:147], v[88:91]
  v_mfma_f32_16x16x32_bf16 v[92:95], v[20:23], a[148:151], v[92:95]
  v_mfma_f32_16x16x32_bf16 v[96:99], v[20:23], a[152:155], v[96:99]
  v_mfma_f32_16x16x32_bf16 v[100:103], v[20:23], a[156:159], v[100:103]
  s_waitcnt lgkmcnt(4)
  v_mfma_f32_16x16x32_bf16 v[72:75], v[24:27], a[160:163], v[72:75]
  ds_read_b128 v[16:19], v5 offset:13312
  ds_read_b128 v[20:23], v5 offset:29696
  v_mfma_f32_16x16x32_bf16 v[76:79], v[24:27], a[164:167], v[76:79]
  v_mfma_f32_16x16x32_bf16 v[80:83], v[24:27], a[168:171], v[80:83]
  v_mfma_f32_16x16x32_bf16 v[84:87], v[24:27], a[172:175], v[84:87]
  v_mfma_f32_16x16x32_bf16 v[88:91], v[28:31], a[160:163], v[88:91]
  v_mfma_f32_16x16x32_bf16 v[92:95], v[28:31], a[164:167], v[92:95]
  v_mfma_f32_16x16x32_bf16 v[96:99], v[28:31], a[168:171], v[96:99]
  v_mfma_f32_16x16x32_bf16 v[100:103], v[28:31], a[172:175], v[100:103]
  s_waitcnt lgkmcnt(4)
  v_mfma_f32_16x16x32_bf16 v[72:75], v[32:35], a[176:179], v[72:75]
  ds_read_b128 v[24:27], v5 offset:14336
  ds_read_b128 v[28:31], v5 offset:30720
  v_mfma_f32_16x16x32_bf16 v[76:79], v[32:35], a[180:183], v[76:79]
  v_mfma_f32_16x16x32_bf16 v[80:83], v[32:35], a[184:187], v[80:83]
  v_mfma_f32_16x16x32_bf16 v[84:87], v[32:35], a[188:191], v[84:87]
  v_mfma_f32_16x16x32_bf16 v[88:91], v[36:39], a[176:179], v[88:91]
  v_mfma_f32_16x16x32_bf16 v[92:95], v[36:39], a[180:183], v[92:95]
  v_mfma_f32_16x16x32_bf16 v[96:99], v[36:39], a[184:187], v[96:99]
  v_mfma_f32_16x16x32_bf16 v[100:103], v[36:39], a[188:191], v[100:103]
  s_waitcnt lgkmcnt(4)
  v_mfma_f32_16x16x32_bf16 v[72:75], v[8:11], a[192:195], v[72:75]
  ds_read_b128 v[32:35], v5 offset:15360
  ds_read_b128 v[36:39], v5 offset:31744
  v_mfma_f32_16x16x32_bf16 v[76:79], v[8:11], a[196:199], v[76:79]
  v_mfma_f32_16x16x32_bf16 v[80:83], v[8:11], a[200:203], v[80:83]
  v_mfma_f32_16x16x32_bf16 v[84:87], v[8:11], a[204:207], v[84:87]
  v_mfma_f32_16x16x32_bf16 v[88:91], v[12:15], a[192:195], v[88:91]
  v_mfma_f32_16x16x32_bf16 v[92:95], v[12:15], a[196:199], v[92:95]
  v_mfma_f32_16x16x32_bf16 v[96:99], v[12:15], a[200:203], v[96:99]
  v_mfma_f32_16x16x32_bf16 v[100:103], v[12:15], a[204:207], v[100:103]
  s_waitcnt lgkmcnt(4)
  v_mfma_f32_16x16x32_bf16 v[72:75], v[16:19], a[208:211], v[72:75]
  v_mfma_f32_16x16x32_bf16 v[76:79], v[16:19], a[212:215], v[76:79]
  v_mfma_f32_16x16x32_bf16 v[80:83], v[16:19], a[216:219], v[80:83]
  v_mfma_f32_16x16x32_bf16 v[84:87], v[16:19], a[220:223], v[84:87]
  v_mfma_f32_16x16x32_bf16 v[88:91], v[20:23], a[208:211], v[88:91]
  v_mfma_f32_16x16x32_bf16 v[92:95], v[20:23], a[212:215], v[92:95]
  v_mfma_f32_16x16x32_bf16 v[96:99], v[20:23], a[216:219], v[96:99]
  v_mfma_f32_16x16x32_bf16 v[100:103], v[20:23], a[220:223], v[100:103]
  s_waitcnt lgkmcnt(2)
  v_mfma_f32_16x16x32_bf16 v[72:75], v[24:27], a[224:227], v[72:75]
  v_mfma_f32_16x16x32_bf16 v[76:79], v[24:27], a[228:231], v[76:79]
  v_mfma_f32_16x16x32_bf16 v[80:83], v[24:27], a[232:235], v[80:83]
  v_mfma_f32_16x16x32_bf16 v[84:87], v[24:27], a[236:239], v[84:87]
  v_mfma_f32_16x16x32_bf16 v[88:91], v[28:31], a[224:227], v[88:91]
  v_mfma_f32_16x16x32_bf16 v[92:95], v[28:31], a[228:231], v[92:95]
  v_mfma_f32_16x16x32_bf16 v[96:99], v[28:31], a[232:235], v[96:99]
  v_mfma_f32_16x16x32_bf16 v[100:103], v[28:31], a[236:239], v[100:103]
  s_waitcnt lgkmcnt(0)
  v_mfma_f32_16x16x32_bf16 v[72:75], v[32:35], a[240:243], v[72:75]
  v_mfma_f32_16x16x32_bf16 v[76:79], v[32:35], a[244:247], v[76:79]
  v_mfma_f32_16x16x32_bf16 v[80:83], v[32:35], a[248:251], v[80:83]
  v_mfma_f32_16x16x32_bf16 v[84:87], v[32:35], a[252:255], v[84:87]
  v_mfma_f32_16x16x32_bf16 v[88:91], v[36:39], a[240:243], v[88:91]
  v_mfma_f32_16x16x32_bf16 v[92:95], v[36:39], a[244:247], v[92:95]
  v_mfma_f32_16x16x32_bf16 v[96:99], v[36:39], a[248:251], v[96:99]
  v_mfma_f32_16x16x32_bf16 v[100:103], v[36:39], a[252:255], v[100:103]
  s_add_u32 s29, s29, 32768
  s_cmp_eq_u32 s29, 98304
  s_cselect_b32 s29, 0, s29
  s_add_u32 s28, s28, 32768
  s_cmp_eq_u32 s28, 98304
  s_cselect_b32 s28, 0, s28
  s_add_u32 s19, s19, 1
  s_cmp_ge_u32 s19, s20

mega_kernel_v_loop:
  s_add_u32 s27, s19, 1
  s_cmp_lt_u32 s27, s20
  s_cbranch_scc1 mega_kernel_v_b2_w1
  s_waitcnt vmcnt(0)
mega_kernel_v_b2_w1:
  s_cmp_lt_u32 s19, 3
  s_cbranch_scc0 mega_kernel_v_b2_w2
  s_waitcnt vmcnt(8)
mega_kernel_v_b2_w2:
  s_waitcnt vmcnt(12)
  s_barrier
  s_add_u32 s27, s18, s16
  s_lshl_b32 s27, s27, 8
  s_add_u32 s27, s27, s19
  s_mov_b32 s10, 1664
  s_cmp_eq_u32 s27, 5
  s_cbranch_scc1 mega_kernel_v_b2_ye
  s_mov_b32 s10, s35
  s_cmp_eq_u32 s27, 1
  s_cbranch_scc0 mega_kernel_v_b2_ne
mega_kernel_v_b2_ye:
  v_mov_b32 v5, s10
  v_mov_b32 v6, 1
  v_cmp_eq_u32 vcc, 0, v0
  s_and_saveexec_b64 s[62:63], vcc
  global_atomic_add v5, v6, s[14:15]
  s_mov_b64 exec, s[62:63]
mega_kernel_v_b2_ne:
  v_add_u32 v5, s29, v1

  ds_read_b128 v[8:11], v5 offset:0
  ds_read_b128 v[12:15], v5 offset:16384
  ds_read_b128 v[16:19], v5 offset:1024
  ds_read_b128 v[20:23], v5 offset:17408
  ds_read_b128 v[24:27], v5 offset:2048
  ds_read_b128 v[28:31], v5 offset:18432
  s_waitcnt lgkmcnt(4)
  v_mfma_f32_16x16x32_bf16 v[40:43], v[8:11], a[0:3], 0
  ds_read_b128 v[32:35], v5 offset:3072
  ds_read_b128 v[36:39], v5 offset:19456
  v_mfma_f32_16x16x32_bf16 v[44:47], v[8:11], a[4:7], 0
  v_mfma_f32_16x16x32_bf16 v[48:51], v[8:11], a[8:11], 0
  v_mfma_f32_16x16x32_bf16 v[52:55], v[8:11], a[12:15], 0
  v_mfma_f32_16x16x32_bf16 v[56:59], v[12:15], a[0:3], 0
  v_cvt_pk_bf16_f32 v104, v72, v73
  v_mfma_f32_16x16x32_bf16 v[60:63], v[12:15], a[4:7], 0
  v_cvt_pk_bf16_f32 v105, v74, v75
  v_mfma_f32_16x16x32_bf16 v[64:67], v[12:15], a[8:11], 0
  v_cvt_pk_bf16_f32 v106, v88, v89
  v_mfma_f32_16x16x32_bf16 v[68:71], v[12:15], a[12:15], 0
  v_cvt_pk_bf16_f32 v107, v90, v91
  s_waitcnt lgkmcnt(4)
  v_mfma_f32_16x16x32_bf16 v[40:43], v[16:19], a[16:19], v[40:43]
  ds_read_b128 v[8:11], v5 offset:4096
  ds_read_b128 v[12:15], v5 offset:20480
  v_mfma_f32_16x16x32_bf16 v[44:47], v[16:19], a[20:23], v[44:47]
  global_store_dwordx4 v1, v[104:107], s[22:23] offset:0 sc1
  v_mfma_f32_16x16x32_bf16 v[48:51], v[16:19], a[24:27], v[48:51]
  v_cvt_pk_bf16_f32 v108, v76, v77
  v_mfma_f32_16x16x32_bf16 v[52:55], v[16:19], a[28:31], v[52:55]
  v_cvt_pk_bf16_f32 v109, v78, v79
  v_mfma_f32_16x16x32_bf16 v[56:59], v[20:23], a[16:19], v[56:59]
  v_cvt_pk_bf16_f32 v110, v92, v93
  v_mfma_f32_16x16x32_bf16 v[60:63], v[20:23], a[20:23], v[60:63]
  v_cvt_pk_bf16_f32 v111, v94, v95
  v_mfma_f32_16x16x32_bf16 v[64:67], v[20:23], a[24:27], v[64:67]
  global_store_dwordx4 v1, v[108:111], s[22:23] offset:1024 sc1
  v_mfma_f32_16x16x32_bf16 v[68:71], v[20:23], a[28:31], v[68:71]
  v_cvt_pk_bf16_f32 v104, v80, v81
  s_waitcnt lgkmcnt(4)
  v_mfma_f32_16x16x32_bf16 v[40:43], v[24:27], a[32:35], v[40:43]
  ds_read_b128 v[16:19], v5 offset:5120
  ds_read_b128 v[20:23], v5 offset:21504
  v_mfma_f32_16x16x32_bf16 v[44:47], v[24:27], a[36:39], v[44:47]
  v_cvt_pk_bf16_f32 v105, v82, v83
  v_mfma_f32_16x16x32_bf16 v[48:51], v[24:27], a[40:43], v[48:51]
  v_cvt_pk_bf16_f32 v106, v96, v97
  v_mfma_f32_16x16x32_bf16 v[52:55], v[24:27], a[44:47], v[52:55]
  v_cvt_pk_bf16_f32 v107, v98, v99
  v_mfma_f32_16x16x32_bf16 v[56:59], v[28:31], a[32:35], v[56:59]
  global_store_dwordx4 v1, v[104:107], s[22:23] offset:2048 sc1
  v_mfma_f32_16x16x32_bf16 v[60:63], v[28:31], a[36:39], v[60:63]
  v_cvt_pk_bf16_f32 v108, v84, v85
  v_mfma_f32_16x16x32_bf16 v[64:67], v[28:31], a[40:43], v[64:67]
  v_cvt_pk_bf16_f32 v109, v86, v87
  v_mfma_f32_16x16x32_bf16 v[68:71], v[28:31], a[44:47], v[68:71]
  v_cvt_pk_bf16_f32 v110, v100, v101
  s_waitcnt lgkmcnt(4)
  v_mfma_f32_16x16x32_bf16 v[40:43], v[32:35], a[48:51], v[40:43]
  ds_read_b128 v[24:27], v5 offset:6144
  ds_read_b128 v[28:31], v5 offset:22528
  v_mfma_f32_16x16x32_bf16 v[44:47], v[32:35], a[52:55], v[44:47]
  v_cvt_pk_bf16_f32 v111, v102, v103
  v_mfma_f32_16x16x32_bf16 v[48:51], v[32:35], a[56:59], v[48:51]
  global_store_dwordx4 v1, v[108:111], s[22:23] offset:3072 sc1
  s_add_u32 s22, s22, s25
  s_addc_u32 s23, s23, 0
  v_mfma_f32_16x16x32_bf16 v[52:55], v[32:35], a[60:63], v[52:55]
  v_mfma_f32_16x16x32_bf16 v[56:59], v[36:39], a[48:51], v[56:59]
  v_mfma_f32_16x16x32_bf16 v[60:63], v[36:39], a[52:55], v[60:63]
  v_mfma_f32_16x16x32_bf16 v[64:67], v[36:39], a[56:59], v[64:67]
  v_mfma_f32_16x16x32_bf16 v[68:71], v[36:39], a[60:63], v[68:71]
  s_waitcnt lgkmcnt(4)
  v_mfma_f32_16x16x32_bf16 v[40:43], v[8:11], a[64:67], v[40:43]
  ds_read_b128 v[32:35], v5 offset:7168
  ds_read_b128 v[36:39], v5 offset:23552
  v_mfma_f32_16x16x32_bf16 v[44:47], v[8:11], a[68:71], v[44:47]
  v_mfma_f32_16x16x32_bf16 v[48:51], v[8:11], a[72:75], v[48:51]
  v_mfma_f32_16x16x32_bf16 v[52:55], v[8:11], a[76:79], v[52:55]
  v_mfma_f32_16x16x32_bf16 v[56:59], v[12:15], a[64:67], v[56:59]
  v_mfma_f32_16x16x32_bf16 v[60:63], v[12:15], a[68:71], v[60:63]
  v_mfma_f32_16x16x32_bf16 v[64:67], v[12:15], a[72:75], v[64:67]
  v_mfma_f32_16x16x32_bf16 v[68:71], v[12:15], a[76:79], v[68:71]
  s_waitcnt lgkmcnt(4)
  v_mfma_f32_16x16x32_bf16 v[40:43], v[16:19], a[80:83], v[40:43]
  ds_read_b128 v[8:11], v5 offset:8192
  ds_read_b128 v[12:15], v5 offset:24576
  v_mfma_f32_16x16x32_bf16 v[44:47], v[16:19], a[84:87], v[44:47]
  v_mfma_f32_16x16x32_bf16 v[48:51], v[16:19], a[88:91], v[48:51]
  v_mfma_f32_16x16x32_bf16 v[52:55], v[16:19], a[92:95], v[52:55]
  v_mfma_f32_16x16x32_bf16 v[56:59], v[20:23], a[80:83], v[56:59]
  v_mfma_f32_16x16x32_bf16 v[60:63], v[20:23], a[84:87], v[60:63]
  v_mfma_f32_16x16x32_bf16 v[64:67], v[20:23], a[88:91], v[64:67]
  v_mfma_f32_16x16x32_bf16 v[68:71], v[20:23], a[92:95], v[68:71]
  s_add_u32 s27, s19, 2
  s_cmp_lt_u32 s27, s20
  s_cbranch_scc0 mega_kernel_v_b2_nd
  s_add_u32 s10, s28, s26
  s_add_u32 m0, s10, 0
  s_lshl_b32 s11, s37, 10
  s_add_u32 s11, s11, 0
  s_add_u32 s8, s6, s11
  s_addc_u32 s9, s7, 0
  global_load_lds_dwordx4 v1, s[8:9] sc1
  global_load_lds_dwordx4 v1, s[8:9] offset:1024 sc1
  global_load_lds_dwordx4 v1, s[8:9] offset:2048 sc1
  global_load_lds_dwordx4 v1, s[8:9] offset:3072 sc1
  s_add_u32 s10, s28, s26
  s_add_u32 m0, s10, 4096
  s_lshl_b32 s11, s37, 10
  s_add_u32 s11, s11, 4096
  s_add_u32 s8, s6, s11
  s_addc_u32 s9, s7, 0
  global_load_lds_dwordx4 v1, s[8:9] sc1
  global_load_lds_dwordx4 v1, s[8:9] offset:1024 sc1
  global_load_lds_dwordx4 v1, s[8:9] offset:2048 sc1
  global_load_lds_dwordx4 v1, s[8:9] offset:3072 sc1
  s_add_u32 s6, s6, s21
  s_addc_u32 s7, s7, 0
mega_kernel_v_b2_nd:
  s_waitcnt lgkmcnt(4)
  v_mfma_f32_16x16x32_bf16 v[40:43], v[24:27], a[96:99], v[40:43]
  ds_read_b128 v[16:19], v5 offset:9216
  ds_read_b128 v[20:23], v5 offset:25600
  v_mfma_f32_16x16x32_bf16 v[44:47], v[24:27], a[100:103], v[44:47]
  v_mfma_f32_16x16x32_bf16 v[48:51], v[24:27], a[104:107], v[48:51]
  v_mfma_f32_16x16x32_bf16 v[52:55], v[24:27], a[108:111], v[52:55]
  v_mfma_f32_16x16x32_bf16 v[56:59], v[28:31], a[96:99], v[56:59]
  v_mfma_f32_16x16x32_bf16 v[60:63], v[28:31], a[100:103], v[60:63]
  v_mfma_f32_16x16x32_bf16 v[64:67], v[28:31], a[104:107], v[64:67]
  v_mfma_f32_16x16x32_bf16 v[68:71], v[28:31], a[108:111], v[68:71]
  s_waitcnt lgkmcnt(4)
  v_mfma_f32_16x16x32_bf16 v[40:43], v[32:35], a[112:115], v[40:43]
  ds_read_b128 v[24:27], v5 offset:10240
  ds_read_b128 v[28:31], v5 offset:26624
  v_mfma_f32_16x16x32_bf16 v[44:47], v[32:35], a[116:119], v[44:47]
  v_mfma_f32_16x16x32_bf16 v[48:51], v[32:35], a[120:123], v[48:51]
  v_mfma_f32_16x16x32_bf16 v[52:55], v[32:35], a[124:127], v[52:55]
  v_mfma_f32_16x16x32_bf16 v[56:59], v[36:39], a[112:115], v[56:59]
  v_mfma_f32_16x16x32_bf16 v[60:63], v[36:39], a[116:119], v[60:63]
  v_mfma_f32_16x16x32_bf16 v[64:67], v[36:39], a[120:123], v[64:67]
  v_mfma_f32_16x16x32_bf16 v[68:71], v[36:39], a[124:127], v[68:71]
  s_waitcnt lgkmcnt(4)
  v_mfma_f32_16x16x32_bf16 v[40:43], v[8:11], a[128:131], v[40:43]
  ds_read_b128 v[32:35], v5 offset:11264
  ds_read_b128 v[36:39], v5 offset:27648
  v_mfma_f32_16x16x32_bf16 v[44:47], v[8:11], a[132:135], v[44:47]
  v_mfma_f32_16x16x32_bf16 v[48:51], v[8:11], a[136:139], v[48:51]
  v_mfma_f32_16x16x32_bf16 v[52:55], v[8:11], a[140:143], v[52:55]
  v_mfma_f32_16x16x32_bf16 v[56:59], v[12:15], a[128:131], v[56:59]
  v_mfma_f32_16x16x32_bf16 v[60:63], v[12:15], a[132:135], v[60:63]
  v_mfma_f32_16x16x32_bf16 v[64:67], v[12:15], a[136:139], v[64:67]
  v_mfma_f32_16x16x32_bf16 v[68:71], v[12:15], a[140:143], v[68:71]
  s_waitcnt lgkmcnt(4)
  v_mfma_f32_16x16x32_bf16 v[40:43], v[16:19], a[144:147], v[40:43]
  ds_read_b128 v[8:11], v5 offset:12288
  ds_read_b128 v[12:15], v5 offset:28672
  v_mfma_f32_16x16x32_bf16 v[44:47], v[16:19], a[148:151], v[44:47]
  v_mfma_f32_16x16x32_bf16 v[48:51], v[16:19], a[152:155], v[48:51]
  v_mfma_f32_16x16x32_bf16 v[52:55], v[16:19], a[156:159], v[52:55]
  v_mfma_f32_16x16x32_bf16 v[56:59], v[20:23], a[144:147], v[56:59]
  v_mfma_f32_16x16x32_bf16 v[60:63], v[20:23], a[148:151], v[60:63]
  v_mfma_f32_16x16x32_bf16 v[64:67], v[20:23], a[152:155], v[64:67]
  v_mfma_f32_16x16x32_bf16 v[68:71], v[20:23], a[156:159], v[68:71]
  s_waitcnt lgkmcnt(4)
  v_mfma_f32_16x16x32_bf16 v[40:43], v[24:27], a[160:163], v[40:43]
  ds_read_b128 v[16:19], v5 offset:13312
  ds_read_b128 v[20:23], v5 offset:29696
  v_mfma_f32_16x16x32_bf16 v[44:47], v[24:27], a[164:167], v[44:47]
  v_mfma_f32_16x16x32_bf16 v[48:51], v[24:27], a[168:171], v[48:51]
  v_mfma_f32_16x16x32_bf16 v[52:55], v[24:27], a[172:175], v[52:55]
  v_mfma_f32_16x16x32_bf16 v[56:59], v[28:31], a[160:163], v[56:59]
  v_mfma_f32_16x16x32_bf16 v[60:63], v[28:31], a[164:167], v[60:63]
  v_mfma_f32_16x16x32_bf16 v[64:67], v[28:31], a[168:171], v[64:67]
  v_mfma_f32_16x16x32_bf16 v[68:71], v[28:31], a[172:175], v[68:71]
  s_waitcnt lgkmcnt(4)
  v_mfma_f32_16x16x32_bf16 v[40:43], v[32:35], a[176:179], v[40:43]
  ds_read_b128 v[24:27], v5 offset:14336
  ds_read_b128 v[28:31], v5 offset:30720
  v_mfma_f32_16x16x32_bf16 v[44:47], v[32:35], a[180:183], v[44:47]
  v_mfma_f32_16x16x32_bf16 v[48:51], v[32:35], a[184:187], v[48:51]
  v_mfma_f32_16x16x32_bf16 v[52:55], v[32:35], a[188:191], v[52:55]
  v_mfma_f32_16x16x32_bf16 v[56:59], v[36:39], a[176:179], v[56:59]
  v_mfma_f32_16x16x32_bf16 v[60:63], v[36:39], a[180:183], v[60:63]
  v_mfma_f32_16x16x32_bf16 v[64:67], v[36:39], a[184:187], v[64:67]
  v_mfma_f32_16x16x32_bf16 v[68:71], v[36:39], a[188:191], v[68:71]
  s_waitcnt lgkmcnt(4)
  v_mfma_f32_16x16x32_bf16 v[40:43], v[8:11], a[192:195], v[40:43]
  ds_read_b128 v[32:35], v5 offset:15360
  ds_read_b128 v[36:39], v5 offset:31744
  v_mfma_f32_16x16x32_bf16 v[44:47], v[8:11], a[196:199], v[44:47]
  v_mfma_f32_16x16x32_bf16 v[48:51], v[8:11], a[200:203], v[48:51]
  v_mfma_f32_16x16x32_bf16 v[52:55], v[8:11], a[204:207], v[52:55]
  v_mfma_f32_16x16x32_bf16 v[56:59], v[12:15], a[192:195], v[56:59]
  v_mfma_f32_16x16x32_bf16 v[60:63], v[12:15], a[196:199], v[60:63]
  v_mfma_f32_16x16x32_bf16 v[64:67], v[12:15], a[200:203], v[64:67]
  v_mfma_f32_16x16x32_bf16 v[68:71], v[12:15], a[204:207], v[68:71]
  s_waitcnt lgkmcnt(4)
  v_mfma_f32_16x16x32_bf16 v[40:43], v[16:19], a[208:211], v[40:43]
  v_mfma_f32_16x16x32_bf16 v[44:47], v[16:19], a[212:215], v[44:47]
  v_mfma_f32_16x16x32_bf16 v[48:51], v[16:19], a[216:219], v[48:51]
  v_mfma_f32_16x16x32_bf16 v[52:55], v[16:19], a[220:223], v[52:55]
  v_mfma_f32_16x16x32_bf16 v[56:59], v[20:23], a[208:211], v[56:59]
  v_mfma_f32_16x16x32_bf16 v[60:63], v[20:23], a[212:215], v[60:63]
  v_mfma_f32_16x16x32_bf16 v[64:67], v[20:23], a[216:219], v[64:67]
  v_mfma_f32_16x16x32_bf16 v[68:71], v[20:23], a[220:223], v[68:71]
  s_waitcnt lgkmcnt(2)
  v_mfma_f32_16x16x32_bf16 v[40:43], v[24:27], a[224:227], v[40:43]
  v_mfma_f32_16x16x32_bf16 v[44:47], v[24:27], a[228:231], v[44:47]
  v_mfma_f32_16x16x32_bf16 v[48:51], v[24:27], a[232:235], v[48:51]
  v_mfma_f32_16x16x32_bf16 v[52:55], v[24:27], a[236:239], v[52:55]
  v_mfma_f32_16x16x32_bf16 v[56:59], v[28:31], a[224:227], v[56:59]
  v_mfma_f32_16x16x32_bf16 v[60:63], v[28:31], a[228:231], v[60:63]
  v_mfma_f32_16x16x32_bf16 v[64:67], v[28:31], a[232:235], v[64:67]
  v_mfma_f32_16x16x32_bf16 v[68:71], v[28:31], a[236:239], v[68:71]
  s_waitcnt lgkmcnt(0)
  v_mfma_f32_16x16x32_bf16 v[40:43], v[32:35], a[240:243], v[40:43]
  v_mfma_f32_16x16x32_bf16 v[44:47], v[32:35], a[244:247], v[44:47]
  v_mfma_f32_16x16x32_bf16 v[48:51], v[32:35], a[248:251], v[48:51]
  v_mfma_f32_16x16x32_bf16 v[52:55], v[32:35], a[252:255], v[52:55]
  v_mfma_f32_16x16x32_bf16 v[56:59], v[36:39], a[240:243], v[56:59]
  v_mfma_f32_16x16x32_bf16 v[60:63], v[36:39], a[244:247], v[60:63]
  v_mfma_f32_16x16x32_bf16 v[64:67], v[36:39], a[248:251], v[64:67]
  v_mfma_f32_16x16x32_bf16 v[68:71], v[36:39], a[252:255], v[68:71]
  s_add_u32 s29, s29, 32768
  s_cmp_eq_u32 s29, 98304
  s_cselect_b32 s29, 0, s29
  s_add_u32 s28, s28, 32768
  s_cmp_eq_u32 s28, 98304
  s_cselect_b32 s28, 0, s28
  s_add_u32 s19, s19, 1
  s_cmp_ge_u32 s19, s20

  s_cbranch_scc1 mega_kernel_v_t0
  s_add_u32 s27, s19, 1
  s_cmp_lt_u32 s27, s20
  s_cbranch_scc1 mega_kernel_v_b1_w1
  s_waitcnt vmcnt(0)
mega_kernel_v_b1_w1:
  s_cmp_lt_u32 s19, 3
  s_cbranch_scc0 mega_kernel_v_b1_w2
  s_waitcnt vmcnt(8)
mega_kernel_v_b1_w2:
  s_waitcnt vmcnt(12)
  s_barrier
  s_add_u32 s27, s18, s16
  s_lshl_b32 s27, s27, 8
  s_add_u32 s27, s27, s19
  s_mov_b32 s10, 1664
  s_cmp_eq_u32 s27, 5
  s_cbranch_scc1 mega_kernel_v_b1_ye
  s_mov_b32 s10, s35
  s_cmp_eq_u32 s27, 1
  s_cbranch_scc0 mega_kernel_v_b1_ne
mega_kernel_v_b1_ye:
  v_mov_b32 v5, s10
  v_mov_b32 v6, 1
  v_cmp_eq_u32 vcc, 0, v0
  s_and_saveexec_b64 s[62:63], vcc
  global_atomic_add v5, v6, s[14:15]
  s_mov_b64 exec, s[62:63]
mega_kernel_v_b1_ne:
  v_add_u32 v5, s29, v1

  ds_read_b128 v[8:11], v5 offset:0
  ds_read_b128 v[12:15], v5 offset:16384
  ds_read_b128 v[16:19], v5 offset:1024
  ds_read_b128 v[20:23], v5 offset:17408
  ds_read_b128 v[24:27], v5 offset:2048
  ds_read_b128 v[28:31], v5 offset:18432
  s_waitcnt lgkmcnt(4)
  v_mfma_f32_16x16x32_bf16 v[72:75], v[8:11], a[0:3], 0
  ds_read_b128 v[32:35], v5 offset:3072
  ds_read_b128 v[36:39], v5 offset:19456
  v_mfma_f32_16x16x32_bf16 v[76:79], v[8:11], a[4:7], 0
  v_mfma_f32_16x16x32_bf16 v[80:83], v[8:11], a[8:11], 0
  v_mfma_f32_16x16x32_bf16 v[84:87], v[8:11], a[12:15], 0
  v_mfma_f32_16x16x32_bf16 v[88:91], v[12:15], a[0:3], 0
  v_cvt_pk_bf16_f32 v104, v40, v41
  v_mfma_f32_16x16x32_bf16 v[92:95], v[12:15], a[4:7], 0
  v_cvt_pk_bf16_f32 v105, v42, v43
  v_mfma_f32_16x16x32_bf16 v[96:99], v[12:15], a[8:11], 0
  v_cvt_pk_bf16_f32 v106, v56, v57
  v_mfma_f32_16x16x32_bf16 v[100:103], v[12:15], a[12:15], 0
  v_cvt_pk_bf16_f32 v107, v58, v59
  s_waitcnt lgkmcnt(4)
  v_mfma_f32_16x16x32_bf16 v[72:75], v[16:19], a[16:19], v[72:75]
  ds_read_b128 v[8:11], v5 offset:4096
  ds_read_b128 v[12:15], v5 offset:20480
  v_mfma_f32_16x16x32_bf16 v[76:79], v[16:19], a[20:23], v[76:79]
  global_store_dwordx4 v1, v[104:107], s[22:23] offset:0 sc1
  v_mfma_f32_16x16x32_bf16 v[80:83], v[16:19], a[24:27], v[80:83]
  v_cvt_pk_bf16_f32 v108, v44, v45
  v_mfma_f32_16x16x32_bf16 v[84:87], v[16:19], a[28:31], v[84:87]
  v_cvt_pk_bf16_f32 v109, v46, v47
  v_mfma_f32_16x16x32_bf16 v[88:91], v[20:23], a[16:19], v[88:91]
  v_cvt_pk_bf16_f32 v110, v60, v61
  v_mfma_f32_16x16x32_bf16 v[92:95], v[20:23], a[20:23], v[92:95]
  v_cvt_pk_bf16_f32 v111, v62, v63
  v_mfma_f32_16x16x32_bf16 v[96:99], v[20:23], a[24:27], v[96:99]
  global_store_dwordx4 v1, v[108:111], s[22:23] offset:1024 sc1
  v_mfma_f32_16x16x32_bf16 v[100:103], v[20:23], a[28:31], v[100:103]
  v_cvt_pk_bf16_f32 v104, v48, v49
  s_waitcnt lgkmcnt(4)
  v_mfma_f32_16x16x32_bf16 v[72:75], v[24:27], a[32:35], v[72:75]
  ds_read_b128 v[16:19], v5 offset:5120
  ds_read_b128 v[20:23], v5 offset:21504
  v_mfma_f32_16x16x32_bf16 v[76:79], v[24:27], a[36:39], v[76:79]
  v_cvt_pk_bf16_f32 v105, v50, v51
  v_mfma_f32_16x16x32_bf16 v[80:83], v[24:27], a[40:43], v[80:83]
  v_cvt_pk_bf16_f32 v106, v64, v65
  v_mfma_f32_16x16x32_bf16 v[84:87], v[24:27], a[44:47], v[84:87]
  v_cvt_pk_bf16_f32 v107, v66, v67
  v_mfma_f32_16x16x32_bf16 v[88:91], v[28:31], a[32:35], v[88:91]
  global_store_dwordx4 v1, v[104:107], s[22:23] offset:2048 sc1
  v_mfma_f32_16x16x32_bf16 v[92:95], v[28:31], a[36:39], v[92:95]
  v_cvt_pk_bf16_f32 v108, v52, v53
  v_mfma_f32_16x16x32_bf16 v[96:99], v[28:31], a[40:43], v[96:99]
  v_cvt_pk_bf16_f32 v109, v54, v55
  v_mfma_f32_16x16x32_bf16 v[100:103], v[28:31], a[44:47], v[100:103]
  v_cvt_pk_bf16_f32 v110, v68, v69
  s_waitcnt lgkmcnt(4)
  v_mfma_f32_16x16x32_bf16 v[72:75], v[32:35], a[48:51], v[72:75]
  ds_read_b128 v[24:27], v5 offset:6144
  ds_read_b128 v[28:31], v5 offset:22528
  v_mfma_f32_16x16x32_bf16 v[76:79], v[32:35], a[52:55], v[76:79]
  v_cvt_pk_bf16_f32 v111, v70, v71
  v_mfma_f32_16x16x32_bf16 v[80:83], v[32:35], a[56:59], v[80:83]
  global_store_dwordx4 v1, v[108:111], s[22:23] offset:3072 sc1
  s_add_u32 s22, s22, s25
  s_addc_u32 s23, s23, 0
  v_mfma_f32_16x16x32_bf16 v[84:87], v[32:35], a[60:63], v[84:87]
  v_mfma_f32_16x16x32_bf16 v[88:91], v[36:39], a[48:51], v[88:91]
  v_mfma_f32_16x16x32_bf16 v[92:95], v[36:39], a[52:55], v[92:95]
  v_mfma_f32_16x16x32_bf16 v[96:99], v[36:39], a[56:59], v[96:99]
  v_mfma_f32_16x16x32_bf16 v[100:103], v[36:39], a[60:63], v[100:103]
  s_waitcnt lgkmcnt(4)
  v_mfma_f32_16x16x32_bf16 v[72:75], v[8:11], a[64:67], v[72:75]
  ds_read_b128 v[32:35], v5 offset:7168
  ds_read_b128 v[36:39], v5 offset:23552
  v_mfma_f32_16x16x32_bf16 v[76:79], v[8:11], a[68:71], v[76:79]
  v_mfma_f32_16x16x32_bf16 v[80:83], v[8:11], a[72:75], v[80:83]
  v_mfma_f32_16x16x32_bf16 v[84:87], v[8:11], a[76:79], v[84:87]
  v_mfma_f32_16x16x32_bf16 v[88:91], v[12:15], a[64:67], v[88:91]
  v_mfma_f32_16x16x32_bf16 v[92:95], v[12:15], a[68:71], v[92:95]
  v_mfma_f32_16x16x32_bf16 v[96:99], v[12:15], a[72:75], v[96:99]
  v_mfma_f32_16x16x32_bf16 v[100:103], v[12:15], a[76:79], v[100:103]
  s_waitcnt lgkmcnt(4)
  v_mfma_f32_16x16x32_bf16 v[72:75], v[16:19], a[80:83], v[72:75]
  ds_read_b128 v[8:11], v5 offset:8192
  ds_read_b128 v[12:15], v5 offset:24576
  v_mfma_f32_16x16x32_bf16 v[76:79], v[16:19], a[84:87], v[76:79]
  v_mfma_f32_16x16x32_bf16 v[80:83], v[16:19], a[88:91], v[80:83]
  v_mfma_f32_16x16x32_bf16 v[84:87], v[16:19], a[92:95], v[84:87]
  v_mfma_f32_16x16x32_bf16 v[88:91], v[20:23], a[80:83], v[88:91]
  v_mfma_f32_16x16x32_bf16 v[92:95], v[20:23], a[84:87], v[92:95]
  v_mfma_f32_16x16x32_bf16 v[96:99], v[20:23], a[88:91], v[96:99]
  v_mfma_f32_16x16x32_bf16 v[100:103], v[20:23], a[92:95], v[100:103]
  s_add_u32 s27, s19, 2
  s_cmp_lt_u32 s27, s20
  s_cbranch_scc0 mega_kernel_v_b1_nd
  s_add_u32 s10, s28, s26
  s_add_u32 m0, s10, 0
  s_lshl_b32 s11, s37, 10
  s_add_u32 s11, s11, 0
  s_add_u32 s8, s6, s11
  s_addc_u32 s9, s7, 0
  global_load_lds_dwordx4 v1, s[8:9] sc1
  global_load_lds_dwordx4 v1, s[8:9] offset:1024 sc1
  global_load_lds_dwordx4 v1, s[8:9] offset:2048 sc1
  global_load_lds_dwordx4 v1, s[8:9] offset:3072 sc1
  s_add_u32 s10, s28, s26
  s_add_u32 m0, s10, 4096
  s_lshl_b32 s11, s37, 10
  s_add_u32 s11, s11, 4096
  s_add_u32 s8, s6, s11
  s_addc_u32 s9, s7, 0
  global_load_lds_dwordx4 v1, s[8:9] sc1
  global_load_lds_dwordx4 v1, s[8:9] offset:1024 sc1
  global_load_lds_dwordx4 v1, s[8:9] offset:2048 sc1
  global_load_lds_dwordx4 v1, s[8:9] offset:3072 sc1
  s_add_u32 s6, s6, s21
  s_addc_u32 s7, s7, 0
mega_kernel_v_b1_nd:
  s_waitcnt lgkmcnt(4)
  v_mfma_f32_16x16x32_bf16 v[72:75], v[24:27], a[96:99], v[72:75]
  ds_read_b128 v[16:19], v5 offset:9216
  ds_read_b128 v[20:23], v5 offset:25600
  v_mfma_f32_16x16x32_bf16 v[76:79], v[24:27], a[100:103], v[76:79]
  v_mfma_f32_16x16x32_bf16 v[80:83], v[24:27], a[104:107], v[80:83]
  v_mfma_f32_16x16x32_bf16 v[84:87], v[24:27], a[108:111], v[84:87]
  v_mfma_f32_16x16x32_bf16 v[88:91], v[28:31], a[96:99], v[88:91]
  v_mfma_f32_16x16x32_bf16 v[92:95], v[28:31], a[100:103], v[92:95]
  v_mfma_f32_16x16x32_bf16 v[96:99], v[28:31], a[104:107], v[96:99]
  v_mfma_f32_16x16x32_bf16 v[100:103], v[28:31], a[108:111], v[100:103]
  s_waitcnt lgkmcnt(4)
  v_mfma_f32_16x16x32_bf16 v[72:75], v[32:35], a[112:115], v[72:75]
  ds_read_b128 v[24:27], v5 offset:10240
  ds_read_b128 v[28:31], v5 offset:26624
  v_mfma_f32_16x16x32_bf16 v[76:79], v[32:35], a[116:119], v[76:79]
  v_mfma_f32_16x16x32_bf16 v[80:83], v[32:35], a[120:123], v[80:83]
  v_mfma_f32_16x16x32_bf16 v[84:87], v[32:35], a[124:127], v[84:87]
  v_mfma_f32_16x16x32_bf16 v[88:91], v[36:39], a[112:115], v[88:91]
  v_mfma_f32_16x16x32_bf16 v[92:95], v[36:39], a[116:119], v[92:95]
  v_mfma_f32_16x16x32_bf16 v[96:99], v[36:39], a[120:123], v[96:99]
  v_mfma_f32_16x16x32_bf16 v[100:103], v[36:39], a[124:127], v[100:103]
  s_waitcnt lgkmcnt(4)
  v_mfma_f32_16x16x32_bf16 v[72:75], v[8:11], a[128:131], v[72:75]
  ds_read_b128 v[32:35], v5 offset:11264
  ds_read_b128 v[36:39], v5 offset:27648
  v_mfma_f32_16x16x32_bf16 v[76:79], v[8:11], a[132:135], v[76:79]
  v_mfma_f32_16x16x32_bf16 v[80:83], v[8:11], a[136:139], v[80:83]
  v_mfma_f32_16x16x32_bf16 v[84:87], v[8:11], a[140:143], v[84:87]
  v_mfma_f32_16x16x32_bf16 v[88:91], v[12:15], a[128:131], v[88:91]
  v_mfma_f32_16x16x32_bf16 v[92:95], v[12:15], a[132:135], v[92:95]
  v_mfma_f32_16x16x32_bf16 v[96:99], v[12:15], a[136:139], v[96:99]
  v_mfma_f32_16x16x32_bf16 v[100:103], v[12:15], a[140:143], v[100:103]
  s_waitcnt lgkmcnt(4)
  v_mfma_f32_16x16x32_bf16 v[72:75], v[16:19], a[144:147], v[72:75]
  ds_read_b128 v[8:11], v5 offset:12288
  ds_read_b128 v[12:15], v5 offset:28672
  v_mfma_f32_16x16x32_bf16 v[76:79], v[16:19], a[148:151], v[76:79]
  v_mfma_f32_16x16x32_bf16 v[80:83], v[16:19], a[152:155], v[80:83]
  v_mfma_f32_16x16x32_bf16 v[84:87], v[16:19], a[156:159], v[84:87]
  v_mfma_f32_16x16x32_bf16 v[88:91], v[20:23], a[144:147], v[88:91]
  v_mfma_f32_16x16x32_bf16 v[92:95], v[20:23], a[148:151], v[92:95]
  v_mfma_f32_16x16x32_bf16 v[96:99], v[20:23], a[152:155], v[96:99]
  v_mfma_f32_16x16x32_bf16 v[100:103], v[20:23], a[156:159], v[100:103]
  s_waitcnt lgkmcnt(4)
  v_mfma_f32_16x16x32_bf16 v[72:75], v[24:27], a[160:163], v[72:75]
  ds_read_b128 v[16:19], v5 offset:13312
  ds_read_b128 v[20:23], v5 offset:29696
  v_mfma_f32_16x16x32_bf16 v[76:79], v[24:27], a[164:167], v[76:79]
  v_mfma_f32_16x16x32_bf16 v[80:83], v[24:27], a[168:171], v[80:83]
  v_mfma_f32_16x16x32_bf16 v[84:87], v[24:27], a[172:175], v[84:87]
  v_mfma_f32_16x16x32_bf16 v[88:91], v[28:31], a[160:163], v[88:91]
  v_mfma_f32_16x16x32_bf16 v[92:95], v[28:31], a[164:167], v[92:95]
  v_mfma_f32_16x16x32_bf16 v[96:99], v[28:31], a[168:171], v[96:99]
  v_mfma_f32_16x16x32_bf16 v[100:103], v[28:31], a[172:175], v[100:103]
  s_waitcnt lgkmcnt(4)
  v_mfma_f32_16x16x32_bf16 v[72:75], v[32:35], a[176:179], v[72:75]
  ds_read_b128 v[24:27], v5 offset:14336
  ds_read_b128 v[28:31], v5 offset:30720
  v_mfma_f32_16x16x32_bf16 v[76:79], v[32:35], a[180:183], v[76:79]
  v_mfma_f32_16x16x32_bf16 v[80:83], v[32:35], a[184:187], v[80:83]
  v_mfma_f32_16x16x32_bf16 v[84:87], v[32:35], a[188:191], v[84:87]
  v_mfma_f32_16x16x32_bf16 v[88:91], v[36:39], a[176:179], v[88:91]
  v_mfma_f32_16x16x32_bf16 v[92:95], v[36:39], a[180:183], v[92:95]
  v_mfma_f32_16x16x32_bf16 v[96:99], v[36:39], a[184:187], v[96:99]
  v_mfma_f32_16x16x32_bf16 v[100:103], v[36:39], a[188:191], v[100:103]
  s_waitcnt lgkmcnt(4)
  v_mfma_f32_16x16x32_bf16 v[72:75], v[8:11], a[192:195], v[72:75]
  ds_read_b128 v[32:35], v5 offset:15360
  ds_read_b128 v[36:39], v5 offset:31744
  v_mfma_f32_16x16x32_bf16 v[76:79], v[8:11], a[196:199], v[76:79]
  v_mfma_f32_16x16x32_bf16 v[80:83], v[8:11], a[200:203], v[80:83]
  v_mfma_f32_16x16x32_bf16 v[84:87], v[8:11], a[204:207], v[84:87]
  v_mfma_f32_16x16x32_bf16 v[88:91], v[12:15], a[192:195], v[88:91]
  v_mfma_f32_16x16x32_bf16 v[92:95], v[12:15], a[196:199], v[92:95]
  v_mfma_f32_16x16x32_bf16 v[96:99], v[12:15], a[200:203], v[96:99]
  v_mfma_f32_16x16x32_bf16 v[100:103], v[12:15], a[204:207], v[100:103]
  s_waitcnt lgkmcnt(4)
  v_mfma_f32_16x16x32_bf16 v[72:75], v[16:19], a[208:211], v[72:75]
  v_mfma_f32_16x16x32_bf16 v[76:79], v[16:19], a[212:215], v[76:79]
  v_mfma_f32_16x16x32_bf16 v[80:83], v[16:19], a[216:219], v[80:83]
  v_mfma_f32_16x16x32_bf16 v[84:87], v[16:19], a[220:223], v[84:87]
  v_mfma_f32_16x16x32_bf16 v[88:91], v[20:23], a[208:211], v[88:91]
  v_mfma_f32_16x16x32_bf16 v[92:95], v[20:23], a[212:215], v[92:95]
  v_mfma_f32_16x16x32_bf16 v[96:99], v[20:23], a[216:219], v[96:99]
  v_mfma_f32_16x16x32_bf16 v[100:103], v[20:23], a[220:223], v[100:103]
  s_waitcnt lgkmcnt(2)
  v_mfma_f32_16x16x32_bf16 v[72:75], v[24:27], a[224:227], v[72:75]
  v_mfma_f32_16x16x32_bf16 v[76:79], v[24:27], a[228:231], v[76:79]
  v_mfma_f32_16x16x32_bf16 v[80:83], v[24:27], a[232:235], v[80:83]
  v_mfma_f32_16x16x32_bf16 v[84:87], v[24:27], a[236:239], v[84:87]
  v_mfma_f32_16x16x32_bf16 v[88:91], v[28:31], a[224:227], v[88:91]
  v_mfma_f32_16x16x32_bf16 v[92:95], v[28:31], a[228:231], v[92:95]
  v_mfma_f32_16x16x32_bf16 v[96:99], v[28:31], a[232:235], v[96:99]
  v_mfma_f32_16x16x32_bf16 v[100:103], v[28:31], a[236:239], v[100:103]
  s_waitcnt lgkmcnt(0)
  v_mfma_f32_16x16x32_bf16 v[72:75], v[32:35], a[240:243], v[72:75]
  v_mfma_f32_16x16x32_bf16 v[76:79], v[32:35], a[244:247], v[76:79]
  v_mfma_f32_16x16x32_bf16 v[80:83], v[32:35], a[248:251], v[80:83]
  v_mfma_f32_16x16x32_bf16 v[84:87], v[32:35], a[252:255], v[84:87]
  v_mfma_f32_16x16x32_bf16 v[88:91], v[36:39], a[240:243], v[88:91]
  v_mfma_f32_16x16x32_bf16 v[92:95], v[36:39], a[244:247], v[92:95]
  v_mfma_f32_16x16x32_bf16 v[96:99], v[36:39], a[248:251], v[96:99]
  v_mfma_f32_16x16x32_bf16 v[100:103], v[36:39], a[252:255], v[100:103]
  s_add_u32 s29, s29, 32768
  s_cmp_eq_u32 s29, 98304
  s_cselect_b32 s29, 0, s29
  s_add_u32 s28, s28, 32768
  s_cmp_eq_u32 s28, 98304
  s_cselect_b32 s28, 0, s28
  s_add_u32 s19, s19, 1
  s_cmp_ge_u32 s19, s20

  s_cbranch_scc0 mega_kernel_v_loop
  s_nop 7
  v_cvt_pk_bf16_f32 v104, v72, v73
  v_cvt_pk_bf16_f32 v105, v74, v75
  v_cvt_pk_bf16_f32 v106, v88, v89
  v_cvt_pk_bf16_f32 v107, v90, v91
  global_store_dwordx4 v1, v[104:107], s[22:23] offset:0 sc1
  v_cvt_pk_bf16_f32 v108, v76, v77
  v_cvt_pk_bf16_f32 v109, v78, v79
  v_cvt_pk_bf16_f32 v110, v92, v93
  v_cvt_pk_bf16_f32 v111, v94, v95
  global_store_dwordx4 v1, v[108:111], s[22:23] offset:1024 sc1
  v_cvt_pk_bf16_f32 v104, v80, v81
  v_cvt_pk_bf16_f32 v105, v82, v83
  v_cvt_pk_bf16_f32 v106, v96, v97
  v_cvt_pk_bf16_f32 v107, v98, v99
  global_store_dwordx4 v1, v[104:107], s[22:23] offset:2048 sc1
  v_cvt_pk_bf16_f32 v108, v84, v85
  v_cvt_pk_bf16_f32 v109, v86, v87
  v_cvt_pk_bf16_f32 v110, v100, v101
  v_cvt_pk_bf16_f32 v111, v102, v103
  global_store_dwordx4 v1, v[108:111], s[22:23] offset:3072 sc1
  s_add_u32 s22, s22, s25
  s_addc_u32 s23, s23, 0
  s_branch mega_kernel_v_done
mega_kernel_v_t0:
  s_nop 7
  v_cvt_pk_bf16_f32 v104, v40, v41
  v_cvt_pk_bf16_f32 v105, v42, v43
  v_cvt_pk_bf16_f32 v106, v56, v57
  v_cvt_pk_bf16_f32 v107, v58, v59
  global_store_dwordx4 v1, v[104:107], s[22:23] offset:0 sc1
  v_cvt_pk_bf16_f32 v108, v44, v45
  v_cvt_pk_bf16_f32 v109, v46, v47
  v_cvt_pk_bf16_f32 v110, v60, v61
  v_cvt_pk_bf16_f32 v111, v62, v63
  global_store_dwordx4 v1, v[108:111], s[22:23] offset:1024 sc1
  v_cvt_pk_bf16_f32 v104, v48, v49
  v_cvt_pk_bf16_f32 v105, v50, v51
  v_cvt_pk_bf16_f32 v106, v64, v65
  v_cvt_pk_bf16_f32 v107, v66, v67
  global_store_dwordx4 v1, v[104:107], s[22:23] offset:2048 sc1
  v_cvt_pk_bf16_f32 v108, v52, v53
  v_cvt_pk_bf16_f32 v109, v54, v55
  v_cvt_pk_bf16_f32 v110, v68, v69
  v_cvt_pk_bf16_f32 v111, v70, v71
  global_store_dwordx4 v1, v[108:111], s[22:23] offset:3072 sc1
  s_add_u32 s22, s22, s25
  s_addc_u32 s23, s23, 0
mega_kernel_v_done:
mega_kernel_Adone:
  s_lshl_b32 s28, s16, 8
  s_add_u32 s28, s28, s17
  s_cmp_lt_u32 s28, 128
  s_cbranch_scc0 mega_kernel_pre_z
  v_mov_b32 v100, -1
  v_mov_b32 v101, -1
  v_mov_b32 v102, -1
  v_mov_b32 v103, -1
  v_lshlrev_b32 v6, 4, v0
  s_cmp_lt_u32 s17, 96
  s_cbranch_scc0 mega_kernel_pre_y
  s_lshl_b32 s26, s17, 14
  s_lshl_b32 s28, s18, 12
  s_add_u32 s28, s28, s26
  s_add_u32 s28, s28, 63438848
  s_add_u32 s28, s12, s28
  s_addc_u32 s29, s13, 0

  global_store_dwordx4 v6, v[100:103], s[28:29] offset:0 sc1
  global_store_dwordx4 v6, v[100:103], s[28:29] offset:1024 sc1
  global_store_dwordx4 v6, v[100:103], s[28:29] offset:2048 sc1
  global_store_dwordx4 v6, v[100:103], s[28:29] offset:3072 sc1
mega_kernel_pre_y:
  s_cmp_lt_u32 s17, 30
  s_cbranch_scc1 mega_kernel_pre_z
  s_sub_u32 s26, s17, 30
  s_lshl_b32 s26, s26, 14
  s_mov_b32 s28, 0
  s_cmp_ge_u32 s26, 0
  s_cselect_b32 s28, 83361792, s28
  s_cmp_ge_u32 s26, 524288
  s_cselect_b32 s28, 154533888, s28
  s_cmp_ge_u32 s26, 655360
  s_cselect_b32 s28, 158597120, s28
  s_cmp_ge_u32 s26, 786432
  s_cselect_b32 s28, 103940096, s28
  s_cmp_ge_u32 s26, 917504
  s_cselect_b32 s28, 108003328, s28
  s_cmp_ge_u32 s26, 1048576
  s_cselect_b32 s28, 116260864, s28
  s_cmp_ge_u32 s26, 1179648
  s_cselect_b32 s28, 122421248, s28
  s_cmp_ge_u32 s26, 1310720
  s_cselect_b32 s28, 84623360, s28
  s_cmp_ge_u32 s26, 1376256
  s_cselect_b32 s28, 129466368, s28
  s_add_u32 s28, s28, s26
  s_lshl_b32 s26, s18, 12
  s_add_u32 s28, s28, s26
  s_add_u32 s28, s12, s28
  s_addc_u32 s29, s13, 0

  global_store_dwordx4 v6, v[100:103], s[28:29] offset:0 sc1
  global_store_dwordx4 v6, v[100:103], s[28:29] offset:1024 sc1
  global_store_dwordx4 v6, v[100:103], s[28:29] offset:2048 sc1
  global_store_dwordx4 v6, v[100:103], s[28:29] offset:3072 sc1
  s_nop 1
mega_kernel_pre_z:
  s_mov_b32 s28, 1280
  s_cmp_eq_u32 s16, 1
  s_cselect_b32 s28, 1408, s28
  s_waitcnt vmcnt(0)
  s_barrier
  s_cmp_eq_u32 s18, 0
  s_cbranch_scc0 mega_kernel_sg_5
  v_mov_b32 v2, s28
  v_mov_b32 v3, 1
  v_cmp_eq_u32 vcc, 0, v0
  s_and_saveexec_b64 s[62:63], vcc
  global_atomic_add v2, v3, s[14:15]

  s_mov_b64 exec, s[62:63]
mega_kernel_sg_5:

  s_cmp_eq_u32 s16, 1
  s_cbranch_scc1 mega_kernel_B
  s_cmp_ge_u32 s17, 96
  s_cbranch_scc1 mega_kernel_B
  s_mov_b32 s16, 1
  s_load_dwordx2 s[4:5], s[0:1], 16
  s_mul_hi_u32 s27, s17, 715827883
  s_mul_i32 s28, s27, 6
  s_sub_u32 s28, s17, s28
  s_mov_b32 s29, 0
  s_mov_b32 s30, 35651584
  s_mov_b32 s20, 10
  s_cmp_lt_u32 s28, 4
  s_cselect_b32 s20, 11, s20
  s_mov_b32 s21, 196608
  s_mov_b32 s25, 49152
  s_waitcnt lgkmcnt(0)
  s_branch mega_kernel_Aset
mega_kernel_B:

  s_cmp_lt_u32 s17, 35
  s_cbranch_scc1 mega_kernel_rW3
  s_cmp_lt_u32 s17, 75
  s_cbranch_scc1 mega_kernel_rW4
  s_cmp_lt_u32 s17, 95
  s_cbranch_scc1 mega_kernel_rW2
  s_cmp_lt_u32 s17, 96
  s_cbranch_scc1 mega_kernel_end
  s_cmp_lt_u32 s17, 160
  s_cbranch_scc1 mega_kernel_rWO
  s_cmp_lt_u32 s17, 184
  s_cbranch_scc1 mega_kernel_rAT
  s_cmp_lt_u32 s17, 224
  s_cbranch_scc1 mega_kernel_rW1
  s_branch mega_kernel_end
mega_kernel_rW3:
  s_sub_u32 s26, s17, 0
  s_mul_hi_u32 s20, s26, 858993460
  s_mul_i32 s27, s20, 5
  s_sub_u32 s22, s26, s27
  s_load_dwordx2 s[4:5], s[0:1], 80
  s_load_dwordx2 s[10:11], s[0:1], 0
  s_lshl_b32 s26, s20, 9
  s_lshl_b32 s27, s18, 7
  s_add_u32 s26, s26, s27
  s_waitcnt lgkmcnt(0)
  s_add_u32 s4, s4, s26
  s_addc_u32 s5, s5, 0

  v_lshrrev_b32 v5, 3, v0
  v_mov_b32 v6, 3584
  v_mul_lo_u32 v5, v5, v6
  v_and_b32 v6, 7, v0
  v_lshl_add_u32 v2, v6, 4, v5
  v_and_b32 v5, 15, v0
  v_lshrrev_b32 v6, 4, v0
  v_lshrrev_b32 v7, 2, v5
  v_lshl_add_u32 v7, v6, 3, v7
  v_mul_u32_u24 v7, 128, v7
  v_and_b32 v5, 3, v5
  v_lshl_add_u32 v7, v5, 4, v7
  s_mul_i32 s24, s18, 40960
  s_add_u32 s24, s24, 0
  v_add_u32 v3, s24, v7

  s_add_u32 s8, s4, 0
  s_addc_u32 s9, s5, 0
  s_add_u32 m0, s24, 0
  s_nop 0
  global_load_lds_dwordx4 v2, s[8:9]

  s_add_u32 s8, s4, 28672
  s_addc_u32 s9, s5, 0
  s_add_u32 m0, s24, 1024
  s_nop 0
  global_load_lds_dwordx4 v2, s[8:9]

  s_add_u32 s8, s4, 57344
  s_addc_u32 s9, s5, 0
  s_add_u32 m0, s24, 2048
  s_nop 0
  global_load_lds_dwordx4 v2, s[8:9]

  s_add_u32 s8, s4, 86016
  s_addc_u32 s9, s5, 0
  s_add_u32 m0, s24, 3072
  s_nop 0
  global_load_lds_dwordx4 v2, s[8:9]

  s_add_u32 s8, s4, 114688
  s_addc_u32 s9, s5, 0
  s_add_u32 m0, s24, 4096
  s_nop 0
  global_load_lds_dwordx4 v2, s[8:9]

  s_add_u32 s8, s4, 143360
  s_addc_u32 s9, s5, 0
  s_add_u32 m0, s24, 5120
  s_nop 0
  global_load_lds_dwordx4 v2, s[8:9]

  s_add_u32 s8, s4, 172032
  s_addc_u32 s9, s5, 0
  s_add_u32 m0, s24, 6144
  s_nop 0
  global_load_lds_dwordx4 v2, s[8:9]

  s_add_u32 s8, s4, 200704
  s_addc_u32 s9, s5, 0
  s_add_u32 m0, s24, 7168
  s_nop 0
  global_load_lds_dwordx4 v2, s[8:9]

  s_add_u32 s8, s4, 229376
  s_addc_u32 s9, s5, 0
  s_add_u32 m0, s24, 8192
  s_nop 0
  global_load_lds_dwordx4 v2, s[8:9]

  s_add_u32 s8, s4, 258048
  s_addc_u32 s9, s5, 0
  s_add_u32 m0, s24, 9216
  s_nop 0
  global_load_lds_dwordx4 v2, s[8:9]

  s_add_u32 s8, s4, 286720
  s_addc_u32 s9, s5, 0
  s_add_u32 m0, s24, 10240
  s_nop 0
  global_load_lds_dwordx4 v2, s[8:9]

  s_add_u32 s8, s4, 315392
  s_addc_u32 s9, s5, 0
  s_add_u32 m0, s24, 11264
  s_nop 0
  global_load_lds_dwordx4 v2, s[8:9]

  s_add_u32 s8, s4, 344064
  s_addc_u32 s9, s5, 0
  s_add_u32 m0, s24, 12288
  s_nop 0
  global_load_lds_dwordx4 v2, s[8:9]

  s_add_u32 s8, s4, 372736
  s_addc_u32 s9, s5, 0
  s_add_u32 m0, s24, 13312
  s_nop 0
  global_load_lds_dwordx4 v2, s[8:9]

  s_add_u32 s8, s4, 401408
  s_addc_u32 s9, s5, 0
  s_add_u32 m0, s24, 14336
  s_nop 0
  global_load_lds_dwordx4 v2, s[8:9]

  s_add_u32 s8, s4, 430080
  s_addc_u32 s9, s5, 0
  s_add_u32 m0, s24, 15360
  s_nop 0
  global_load_lds_dwordx4 v2, s[8:9]

  s_add_u32 s8, s4, 458752
  s_addc_u32 s9, s5, 0
  s_add_u32 m0, s24, 16384
  s_nop 0
  global_load_lds_dwordx4 v2, s[8:9]

  s_add_u32 s8, s4, 487424
  s_addc_u32 s9, s5, 0
  s_add_u32 m0, s24, 17408
  s_nop 0
  global_load_lds_dwordx4 v2, s[8:9]

  s_add_u32 s8, s4, 516096
  s_addc_u32 s9, s5, 0
  s_add_u32 m0, s24, 18432
  s_nop 0
  global_load_lds_dwordx4 v2, s[8:9]

  s_add_u32 s8, s4, 544768
  s_addc_u32 s9, s5, 0
  s_add_u32 m0, s24, 19456
  s_nop 0
  global_load_lds_dwordx4 v2, s[8:9]

  s_add_u32 s8, s4, 573440
  s_addc_u32 s9, s5, 0
  s_add_u32 m0, s24, 20480
  s_nop 0
  global_load_lds_dwordx4 v2, s[8:9]

  s_add_u32 s8, s4, 602112
  s_addc_u32 s9, s5, 0
  s_add_u32 m0, s24, 21504
  s_nop 0
  global_load_lds_dwordx4 v2, s[8:9]

  s_add_u32 s8, s4, 630784
  s_addc_u32 s9, s5, 0
  s_add_u32 m0, s24, 22528
  s_nop 0
  global_load_lds_dwordx4 v2, s[8:9]

  s_add_u32 s8, s4, 659456
  s_addc_u32 s9, s5, 0
  s_add_u32 m0, s24, 23552
  s_nop 0
  global_load_lds_dwordx4 v2, s[8:9]

  s_add_u32 s8, s4, 688128
  s_addc_u32 s9, s5, 0
  s_add_u32 m0, s24, 24576
  s_nop 0
  global_load_lds_dwordx4 v2, s[8:9]

  s_add_u32 s8, s4, 716800
  s_addc_u32 s9, s5, 0
  s_add_u32 m0, s24, 25600
  s_nop 0
  global_load_lds_dwordx4 v2, s[8:9]

  s_add_u32 s8, s4, 745472
  s_addc_u32 s9, s5, 0
  s_add_u32 m0, s24, 26624
  s_nop 0
  global_load_lds_dwordx4 v2, s[8:9]

  s_add_u32 s8, s4, 774144
  s_addc_u32 s9, s5, 0
  s_add_u32 m0, s24, 27648
  s_nop 0
  global_load_lds_dwordx4 v2, s[8:9]

  s_add_u32 s8, s4, 802816
  s_addc_u32 s9, s5, 0
  s_add_u32 m0, s24, 28672
  s_nop 0
  global_load_lds_dwordx4 v2, s[8:9]

  s_add_u32 s8, s4, 831488
  s_addc_u32 s9, s5, 0
  s_add_u32 m0, s24, 29696
  s_nop 0
  global_load_lds_dwordx4 v2, s[8:9]

  s_add_u32 s8, s4, 860160
  s_addc_u32 s9, s5, 0
  s_add_u32 m0, s24, 30720
  s_nop 0
  global_load_lds_dwordx4 v2, s[8:9]

  s_add_u32 s8, s4, 888832
  s_addc_u32 s9, s5, 0
  s_add_u32 m0, s24, 31744
  s_nop 0
  global_load_lds_dwordx4 v2, s[8:9]

  s_add_u32 s8, s4, 917504
  s_addc_u32 s9, s5, 0
  s_add_u32 m0, s24, 32768
  s_nop 0
  global_load_lds_dwordx4 v2, s[8:9]

  s_add_u32 s8, s4, 946176
  s_addc_u32 s9, s5, 0
  s_add_u32 m0, s24, 33792
  s_nop 0
  global_load_lds_dwordx4 v2, s[8:9]

  s_add_u32 s8, s4, 974848
  s_addc_u32 s9, s5, 0
  s_add_u32 m0, s24, 34816
  s_nop 0
  global_load_lds_dwordx4 v2, s[8:9]

  s_add_u32 s8, s4, 1003520
  s_addc_u32 s9, s5, 0
  s_add_u32 m0, s24, 35840
  s_nop 0
  global_load_lds_dwordx4 v2, s[8:9]

  s_add_u32 s8, s4, 1032192
  s_addc_u32 s9, s5, 0
  s_add_u32 m0, s24, 36864
  s_nop 0
  global_load_lds_dwordx4 v2, s[8:9]

  s_add_u32 s8, s4, 1060864
  s_addc_u32 s9, s5, 0
  s_add_u32 m0, s24, 37888
  s_nop 0
  global_load_lds_dwordx4 v2, s[8:9]

  s_add_u32 s8, s4, 1089536
  s_addc_u32 s9, s5, 0
  s_add_u32 m0, s24, 38912
  s_nop 0
  global_load_lds_dwordx4 v2, s[8:9]

  s_add_u32 s8, s4, 1118208
  s_addc_u32 s9, s5, 0
  s_add_u32 m0, s24, 39936
  s_nop 0
  global_load_lds_dwordx4 v2, s[8:9]

  s_waitcnt vmcnt(36)
  ds_read_b64_tr_b16 a[0:1], v3 offset:0
  ds_read_b64_tr_b16 a[2:3], v3 offset:512
  ds_read_b64_tr_b16 a[4:5], v3 offset:8
  ds_read_b64_tr_b16 a[6:7], v3 offset:520
  ds_read_b64_tr_b16 a[8:9], v3 offset:64
  ds_read_b64_tr_b16 a[10:11], v3 offset:576
  ds_read_b64_tr_b16 a[12:13], v3 offset:72
  ds_read_b64_tr_b16 a[14:15], v3 offset:584
  s_waitcnt lgkmcnt(0)

  s_add_u32 s8, s4, 1146880
  s_addc_u32 s9, s5, 0
  s_add_u32 m0, s24, 0
  s_nop 0
  global_load_lds_dwordx4 v2, s[8:9]

  s_add_u32 s8, s4, 1175552
  s_addc_u32 s9, s5, 0
  s_add_u32 m0, s24, 1024
  s_nop 0
  global_load_lds_dwordx4 v2, s[8:9]

  s_add_u32 s8, s4, 1204224
  s_addc_u32 s9, s5, 0
  s_add_u32 m0, s24, 2048
  s_nop 0
  global_load_lds_dwordx4 v2, s[8:9]

  s_add_u32 s8, s4, 1232896
  s_addc_u32 s9, s5, 0
  s_add_u32 m0, s24, 3072
  s_nop 0
  global_load_lds_dwordx4 v2, s[8:9]

  s_waitcnt vmcnt(36)
  ds_read_b64_tr_b16 a[16:17], v3 offset:4096
  ds_read_b64_tr_b16 a[18:19], v3 offset:4608
  ds_read_b64_tr_b16 a[20:21], v3 offset:4104
  ds_read_b64_tr_b16 a[22:23], v3 offset:4616
  ds_read_b64_tr_b16 a[24:25], v3 offset:4160
  ds_read_b64_tr_b16 a[26:27], v3 offset:4672
  ds_read_b64_tr_b16 a[28:29], v3 offset:4168
  ds_read_b64_tr_b16 a[30:31], v3 offset:4680
  s_waitcnt lgkmcnt(0)

  s_add_u32 s8, s4, 1261568
  s_addc_u32 s9, s5, 0
  s_add_u32 m0, s24, 4096
  s_nop 0
  global_load_lds_dwordx4 v2, s[8:9]

  s_add_u32 s8, s4, 1290240
  s_addc_u32 s9, s5, 0
  s_add_u32 m0, s24, 5120
  s_nop 0
  global_load_lds_dwordx4 v2, s[8:9]

  s_add_u32 s8, s4, 1318912
  s_addc_u32 s9, s5, 0
  s_add_u32 m0, s24, 6144
  s_nop 0
  global_load_lds_dwordx4 v2, s[8:9]

  s_add_u32 s8, s4, 1347584
  s_addc_u32 s9, s5, 0
  s_add_u32 m0, s24, 7168
  s_nop 0
  global_load_lds_dwordx4 v2, s[8:9]

  s_waitcnt vmcnt(36)
  ds_read_b64_tr_b16 a[32:33], v3 offset:8192
  ds_read_b64_tr_b16 a[34:35], v3 offset:8704
  ds_read_b64_tr_b16 a[36:37], v3 offset:8200
  ds_read_b64_tr_b16 a[38:39], v3 offset:8712
  ds_read_b64_tr_b16 a[40:41], v3 offset:8256
  ds_read_b64_tr_b16 a[42:43], v3 offset:8768
  ds_read_b64_tr_b16 a[44:45], v3 offset:8264
  ds_read_b64_tr_b16 a[46:47], v3 offset:8776
  s_waitcnt lgkmcnt(0)

  s_add_u32 s8, s4, 1376256
  s_addc_u32 s9, s5, 0
  s_add_u32 m0, s24, 8192
  s_nop 0
  global_load_lds_dwordx4 v2, s[8:9]

  s_add_u32 s8, s4, 1404928
  s_addc_u32 s9, s5, 0
  s_add_u32 m0, s24, 9216
  s_nop 0
  global_load_lds_dwordx4 v2, s[8:9]

  s_add_u32 s8, s4, 1433600
  s_addc_u32 s9, s5, 0
  s_add_u32 m0, s24, 10240
  s_nop 0
  global_load_lds_dwordx4 v2, s[8:9]

  s_add_u32 s8, s4, 1462272
  s_addc_u32 s9, s5, 0
  s_add_u32 m0, s24, 11264
  s_nop 0
  global_load_lds_dwordx4 v2, s[8:9]

  s_waitcnt vmcnt(36)
  ds_read_b64_tr_b16 a[48:49], v3 offset:12288
  ds_read_b64_tr_b16 a[50:51], v3 offset:12800
  ds_read_b64_tr_b16 a[52:53], v3 offset:12296
  ds_read_b64_tr_b16 a[54:55], v3 offset:12808
  ds_read_b64_tr_b16 a[56:57], v3 offset:12352
  ds_read_b64_tr_b16 a[58:59], v3 offset:12864
  ds_read_b64_tr_b16 a[60:61], v3 offset:12360
  ds_read_b64_tr_b16 a[62:63], v3 offset:12872
  s_waitcnt lgkmcnt(0)

  s_add_u32 s8, s4, 1490944
  s_addc_u32 s9, s5, 0
  s_add_u32 m0, s24, 12288
  s_nop 0
  global_load_lds_dwordx4 v2, s[8:9]

  s_add_u32 s8, s4, 1519616
  s_addc_u32 s9, s5, 0
  s_add_u32 m0, s24, 13312
  s_nop 0
  global_load_lds_dwordx4 v2, s[8:9]

  s_add_u32 s8, s4, 1548288
  s_addc_u32 s9, s5, 0
  s_add_u32 m0, s24, 14336
  s_nop 0
  global_load_lds_dwordx4 v2, s[8:9]

  s_add_u32 s8, s4, 1576960
  s_addc_u32 s9, s5, 0
  s_add_u32 m0, s24, 15360
  s_nop 0
  global_load_lds_dwordx4 v2, s[8:9]

  s_waitcnt vmcnt(36)
  ds_read_b64_tr_b16 a[64:65], v3 offset:16384
  ds_read_b64_tr_b16 a[66:67], v3 offset:16896
  ds_read_b64_tr_b16 a[68:69], v3 offset:16392
  ds_read_b64_tr_b16 a[70:71], v3 offset:16904
  ds_read_b64_tr_b16 a[72:73], v3 offset:16448
  ds_read_b64_tr_b16 a[74:75], v3 offset:16960
  ds_read_b64_tr_b16 a[76:77], v3 offset:16456
  ds_read_b64_tr_b16 a[78:79], v3 offset:16968
  s_waitcnt lgkmcnt(0)

  s_add_u32 s8, s4, 1605632
  s_addc_u32 s9, s5, 0
  s_add_u32 m0, s24, 16384
  s_nop 0
  global_load_lds_dwordx4 v2, s[8:9]

  s_add_u32 s8, s4, 1634304
  s_addc_u32 s9, s5, 0
  s_add_u32 m0, s24, 17408
  s_nop 0
  global_load_lds_dwordx4 v2, s[8:9]

  s_add_u32 s8, s4, 1662976
  s_addc_u32 s9, s5, 0
  s_add_u32 m0, s24, 18432
  s_nop 0
  global_load_lds_dwordx4 v2, s[8:9]

  s_add_u32 s8, s4, 1691648
  s_addc_u32 s9, s5, 0
  s_add_u32 m0, s24, 19456
  s_nop 0
  global_load_lds_dwordx4 v2, s[8:9]

  s_waitcnt vmcnt(36)
  ds_read_b64_tr_b16 a[80:81], v3 offset:20480
  ds_read_b64_tr_b16 a[82:83], v3 offset:20992
  ds_read_b64_tr_b16 a[84:85], v3 offset:20488
  ds_read_b64_tr_b16 a[86:87], v3 offset:21000
  ds_read_b64_tr_b16 a[88:89], v3 offset:20544
  ds_read_b64_tr_b16 a[90:91], v3 offset:21056
  ds_read_b64_tr_b16 a[92:93], v3 offset:20552
  ds_read_b64_tr_b16 a[94:95], v3 offset:21064
  s_waitcnt lgkmcnt(0)

  s_add_u32 s8, s4, 1720320
  s_addc_u32 s9, s5, 0
  s_add_u32 m0, s24, 20480
  s_nop 0
  global_load_lds_dwordx4 v2, s[8:9]

  s_add_u32 s8, s4, 1748992
  s_addc_u32 s9, s5, 0
  s_add_u32 m0, s24, 21504
  s_nop 0
  global_load_lds_dwordx4 v2, s[8:9]

  s_add_u32 s8, s4, 1777664
  s_addc_u32 s9, s5, 0
  s_add_u32 m0, s24, 22528
  s_nop 0
  global_load_lds_dwordx4 v2, s[8:9]

  s_add_u32 s8, s4, 1806336
  s_addc_u32 s9, s5, 0
  s_add_u32 m0, s24, 23552
  s_nop 0
  global_load_lds_dwordx4 v2, s[8:9]

  s_waitcnt vmcnt(36)
  ds_read_b64_tr_b16 a[96:97], v3 offset:24576
  ds_read_b64_tr_b16 a[98:99], v3 offset:25088
  ds_read_b64_tr_b16 a[100:101], v3 offset:24584
  ds_read_b64_tr_b16 a[102:103], v3 offset:25096
  ds_read_b64_tr_b16 a[104:105], v3 offset:24640
  ds_read_b64_tr_b16 a[106:107], v3 offset:25152
  ds_read_b64_tr_b16 a[108:109], v3 offset:24648
  ds_read_b64_tr_b16 a[110:111], v3 offset:25160
  s_waitcnt vmcnt(32)
  ds_read_b64_tr_b16 a[112:113], v3 offset:28672
  ds_read_b64_tr_b16 a[114:115], v3 offset:29184
  ds_read_b64_tr_b16 a[116:117], v3 offset:28680
  ds_read_b64_tr_b16 a[118:119], v3 offset:29192
  ds_read_b64_tr_b16 a[120:121], v3 offset:28736
  ds_read_b64_tr_b16 a[122:123], v3 offset:29248
  ds_read_b64_tr_b16 a[124:125], v3 offset:28744
  ds_read_b64_tr_b16 a[126:127], v3 offset:29256
  s_waitcnt vmcnt(28)
  ds_read_b64_tr_b16 a[128:129], v3 offset:32768
  ds_read_b64_tr_b16 a[130:131], v3 offset:33280
  ds_read_b64_tr_b16 a[132:133], v3 offset:32776
  ds_read_b64_tr_b16 a[134:135], v3 offset:33288
  ds_read_b64_tr_b16 a[136:137], v3 offset:32832
  ds_read_b64_tr_b16 a[138:139], v3 offset:33344
  ds_read_b64_tr_b16 a[140:141], v3 offset:32840
  ds_read_b64_tr_b16 a[142:143], v3 offset:33352
  s_waitcnt vmcnt(24)
  ds_read_b64_tr_b16 a[144:145], v3 offset:36864
  ds_read_b64_tr_b16 a[146:147], v3 offset:37376
  ds_read_b64_tr_b16 a[148:149], v3 offset:36872
  ds_read_b64_tr_b16 a[150:151], v3 offset:37384
  ds_read_b64_tr_b16 a[152:153], v3 offset:36928
  ds_read_b64_tr_b16 a[154:155], v3 offset:37440
  ds_read_b64_tr_b16 a[156:157], v3 offset:36936
  ds_read_b64_tr_b16 a[158:159], v3 offset:37448
  s_waitcnt vmcnt(20)
  ds_read_b64_tr_b16 a[160:161], v3 offset:0
  ds_read_b64_tr_b16 a[162:163], v3 offset:512
  ds_read_b64_tr_b16 a[164:165], v3 offset:8
  ds_read_b64_tr_b16 a[166:167], v3 offset:520
  ds_read_b64_tr_b16 a[168:169], v3 offset:64
  ds_read_b64_tr_b16 a[170:171], v3 offset:576
  ds_read_b64_tr_b16 a[172:173], v3 offset:72
  ds_read_b64_tr_b16 a[174:175], v3 offset:584
  s_waitcnt vmcnt(16)
  ds_read_b64_tr_b16 a[176:177], v3 offset:4096
  ds_read_b64_tr_b16 a[178:179], v3 offset:4608
  ds_read_b64_tr_b16 a[180:181], v3 offset:4104
  ds_read_b64_tr_b16 a[182:183], v3 offset:4616
  ds_read_b64_tr_b16 a[184:185], v3 offset:4160
  ds_read_b64_tr_b16 a[186:187], v3 offset:4672
  ds_read_b64_tr_b16 a[188:189], v3 offset:4168
  ds_read_b64_tr_b16 a[190:191], v3 offset:4680
  s_waitcnt vmcnt(12)
  ds_read_b64_tr_b16 a[192:193], v3 offset:8192
  ds_read_b64_tr_b16 a[194:195], v3 offset:8704
  ds_read_b64_tr_b16 a[196:197], v3 offset:8200
  ds_read_b64_tr_b16 a[198:199], v3 offset:8712
  ds_read_b64_tr_b16 a[200:201], v3 offset:8256
  ds_read_b64_tr_b16 a[202:203], v3 offset:8768
  ds_read_b64_tr_b16 a[204:205], v3 offset:8264
  ds_read_b64_tr_b16 a[206:207], v3 offset:8776
  s_waitcnt vmcnt(8)
  ds_read_b64_tr_b16 a[208:209], v3 offset:12288
  ds_read_b64_tr_b16 a[210:211], v3 offset:12800
  ds_read_b64_tr_b16 a[212:213], v3 offset:12296
  ds_read_b64_tr_b16 a[214:215], v3 offset:12808
  ds_read_b64_tr_b16 a[216:217], v3 offset:12352
  ds_read_b64_tr_b16 a[218:219], v3 offset:12864
  ds_read_b64_tr_b16 a[220:221], v3 offset:12360
  ds_read_b64_tr_b16 a[222:223], v3 offset:12872
  s_waitcnt vmcnt(4)
  ds_read_b64_tr_b16 a[224:225], v3 offset:16384
  ds_read_b64_tr_b16 a[226:227], v3 offset:16896
  ds_read_b64_tr_b16 a[228:229], v3 offset:16392
  ds_read_b64_tr_b16 a[230:231], v3 offset:16904
  ds_read_b64_tr_b16 a[232:233], v3 offset:16448
  ds_read_b64_tr_b16 a[234:235], v3 offset:16960
  ds_read_b64_tr_b16 a[236:237], v3 offset:16456
  ds_read_b64_tr_b16 a[238:239], v3 offset:16968
  s_waitcnt vmcnt(0)
  ds_read_b64_tr_b16 a[240:241], v3 offset:20480
  ds_read_b64_tr_b16 a[242:243], v3 offset:20992
  ds_read_b64_tr_b16 a[244:245], v3 offset:20488
  ds_read_b64_tr_b16 a[246:247], v3 offset:21000
  ds_read_b64_tr_b16 a[248:249], v3 offset:20544
  ds_read_b64_tr_b16 a[250:251], v3 offset:21056
  ds_read_b64_tr_b16 a[252:253], v3 offset:20552
  ds_read_b64_tr_b16 a[254:255], v3 offset:21064
  s_waitcnt lgkmcnt(0)
  s_barrier
  v_add_u32 v4, 4096, v1
  s_lshl_b32 s26, s18, 12
  v_add_u32 v6, s26, v1
  v_and_b32 v9, 15, v0
  v_lshlrev_b32 v9, 10, v9
  v_lshrrev_b32 v10, 4, v0
  v_lshl_add_u32 v9, v10, 4, v9
  s_lshl_b32 s26, s18, 8
  v_add_u32 v9, s26, v9
  s_mov_b32 s30, 0xc0135761
  s_mov_b32 s31, 0xbdd2d3e8
  s_lshl_b32 s25, s20, 2
  s_add_u32 s25, s25, s18
  s_lshl_b32 s25, s25, 11

  s_mov_b32 s19, s22
  s_mov_b32 s38, 0
mega_kernel_w3_tl:
  s_lshl_b32 s29, s19, 15
  s_lshl_b32 s28, s18, 13
  s_add_u32 s29, s29, s28
  s_lshl_b32 s28, s19, 7
  s_add_u32 s28, s28, 57344
  s_mov_b32 s37, 4
  s_cmp_ge_u32 s19, 124
  s_cselect_b32 s36, 16, 0
  s_add_u32 s28, s28, s36
  v_mov_b32 v2, s28
  s_mov_b32 s27, 0
mega_kernel_pl_6:
  global_load_dword v3, v2, s[14:15] sc1
  s_add_u32 s27, s27, 1
  s_cmp_gt_u32 s27, 50000000
  s_cbranch_scc1 mega_kernel_fail
  s_waitcnt vmcnt(0)
  v_readfirstlane_b32 s26, v3
  s_nop 3
  s_cmp_ge_u32 s26, s37
  s_cbranch_scc1 mega_kernel_pl_6_ok
  s_sleep 2
  s_branch mega_kernel_pl_6
mega_kernel_pl_6_ok:

mega_kernel_w3_st:
  s_add_u32 s27, s29, 113246208
  s_add_u32 s8, s12, s27
  s_addc_u32 s9, s13, 0
  global_load_dwordx4 v[32:35], v1, s[8:9] offset:0 sc1
  global_load_dwordx4 v[36:39], v1, s[8:9] offset:1024 sc1
  global_load_dwordx4 v[40:43], v1, s[8:9] offset:2048 sc1
  global_load_dwordx4 v[44:47], v1, s[8:9] offset:3072 sc1
  global_load_dwordx4 v[48:51], v4, s[8:9] offset:0 sc1
  global_load_dwordx4 v[52:55], v4, s[8:9] offset:1024 sc1
  global_load_dwordx4 v[56:59], v4, s[8:9] offset:2048 sc1
  global_load_dwordx4 v[60:63], v4, s[8:9] offset:3072 sc1
  s_waitcnt vmcnt(0)
  s_cmp_ge_u32 s19, 124
  s_cselect_b64 s[60:61], -1, 0
  v_max3_u32 v112, v32, v33, v34
  v_mov_b32 v113, v35
  v_max3_u32 v112, v112, v36, v37
  v_max3_u32 v113, v113, v38, v39
  v_max3_u32 v112, v112, v40, v41
  v_max3_u32 v113, v113, v42, v43
  v_max3_u32 v112, v112, v44, v45
  v_max3_u32 v113, v113, v46, v47
  v_max3_u32 v112, v112, v48, v49
  v_max3_u32 v113, v113, v50, v51
  v_max3_u32 v112, v112, v52, v53
  v_max3_u32 v113, v113, v54, v55
  v_max3_u32 v112, v112, v56, v57
  v_max3_u32 v113, v113, v58, v59
  v_max3_u32 v112, v112, v60, v61
  v_max3_u32 v113, v113, v62, v63
  v_max_u32 v112, v112, v113
  s_add_u32 s38, s38, 1
  s_cmp_gt_u32 s38, 50000000
  s_cbranch_scc1 mega_kernel_fail
  v_cmp_eq_u32 vcc, -1, v112
  s_nop 3
  s_and_b64 vcc, vcc, s[60:61]
  s_cbranch_vccnz mega_kernel_w3_st

  v_pk_add_f32 v[112:113], v[32:33], v[34:35]
  v_pk_add_f32 v[114:115], v[36:37], v[38:39]
  v_pk_add_f32 v[112:113], v[112:113], v[40:41]
  v_pk_add_f32 v[114:115], v[114:115], v[42:43]
  v_pk_add_f32 v[112:113], v[112:113], v[44:45]
  v_pk_add_f32 v[114:115], v[114:115], v[46:47]
  v_pk_add_f32 v[112:113], v[112:113], v[48:49]
  v_pk_add_f32 v[114:115], v[114:115], v[50:51]
  v_pk_add_f32 v[112:113], v[112:113], v[52:53]
  v_pk_add_f32 v[114:115], v[114:115], v[54:55]
  v_pk_add_f32 v[112:113], v[112:113], v[56:57]
  v_pk_add_f32 v[114:115], v[114:115], v[58:59]
  v_pk_add_f32 v[112:113], v[112:113], v[60:61]
  v_pk_add_f32 v[114:115], v[114:115], v[62:63]
  v_pk_add_f32 v[112:113], v[112:113], v[114:115]
  v_add_f32 v112, v112, v113
  v_mov_b32 v113, v112
  s_nop 1
  v_permlane32_swap_b32 v112, v113
  v_add_f32 v112, v112, v113
  v_mov_b32 v113, v112
  s_nop 1
  v_permlane16_swap_b32 v112, v113
  v_add_f32 v112, v112, v113

  v_mul_f32 v112, 0x3c000000, v112
  v_pk_add_f32 v[32:33], v[32:33], v[112:113] op_sel_hi:[1,0] neg_lo:[0,1] neg_hi:[0,1]
  v_pk_add_f32 v[34:35], v[34:35], v[112:113] op_sel_hi:[1,0] neg_lo:[0,1] neg_hi:[0,1]
  v_pk_add_f32 v[36:37], v[36:37], v[112:113] op_sel_hi:[1,0] neg_lo:[0,1] neg_hi:[0,1]
  v_pk_add_f32 v[38:39], v[38:39], v[112:113] op_sel_hi:[1,0] neg_lo:[0,1] neg_hi:[0,1]
  v_pk_add_f32 v[40:41], v[40:41], v[112:113] op_sel_hi:[1,0] neg_lo:[0,1] neg_hi:[0,1]
  v_pk_add_f32 v[42:43], v[42:43], v[112:113] op_sel_hi:[1,0] neg_lo:[0,1] neg_hi:[0,1]
  v_pk_add_f32 v[44:45], v[44:45], v[112:113] op_sel_hi:[1,0] neg_lo:[0,1] neg_hi:[0,1]
  v_pk_add_f32 v[46:47], v[46:47], v[112:113] op_sel_hi:[1,0] neg_lo:[0,1] neg_hi:[0,1]
  v_pk_add_f32 v[48:49], v[48:49], v[112:113] op_sel_hi:[1,0] neg_lo:[0,1] neg_hi:[0,1]
  v_pk_add_f32 v[50:51], v[50:51], v[112:113] op_sel_hi:[1,0] neg_lo:[0,1] neg_hi:[0,1]
  v_pk_add_f32 v[52:53], v[52:53], v[112:113] op_sel_hi:[1,0] neg_lo:[0,1] neg_hi:[0,1]
  v_pk_add_f32 v[54:55], v[54:55], v[112:113] op_sel_hi:[1,0] neg_lo:[0,1] neg_hi:[0,1]
  v_pk_add_f32 v[56:57], v[56:57], v[112:113] op_sel_hi:[1,0] neg_lo:[0,1] neg_hi:[0,1]
  v_pk_add_f32 v[58:59], v[58:59], v[112:113] op_sel_hi:[1,0] neg_lo:[0,1] neg_hi:[0,1]
  v_pk_add_f32 v[60:61], v[60:61], v[112:113] op_sel_hi:[1,0] neg_lo:[0,1] neg_hi:[0,1]
  v_pk_add_f32 v[62:63], v[62:63], v[112:113] op_sel_hi:[1,0] neg_lo:[0,1] neg_hi:[0,1]
  v_pk_mul_f32 v[114:115], v[32:33], v[32:33]
  v_pk_mul_f32 v[116:117], v[34:35], v[34:35]
  v_pk_fma_f32 v[114:115], v[36:37], v[36:37], v[114:115]
  v_pk_fma_f32 v[116:117], v[38:39], v[38:39], v[116:117]
  v_pk_fma_f32 v[114:115], v[40:41], v[40:41], v[114:115]
  v_pk_fma_f32 v[116:117], v[42:43], v[42:43], v[116:117]
  v_pk_fma_f32 v[114:115], v[44:45], v[44:45], v[114:115]
  v_pk_fma_f32 v[116:117], v[46:47], v[46:47], v[116:117]
  v_pk_fma_f32 v[114:115], v[48:49], v[48:49], v[114:115]
  v_pk_fma_f32 v[116:117], v[50:51], v[50:51], v[116:117]
  v_pk_fma_f32 v[114:115], v[52:53], v[52:53], v[114:115]
  v_pk_fma_f32 v[116:117], v[54:55], v[54:55], v[116:117]
  v_pk_fma_f32 v[114:115], v[56:57], v[56:57], v[114:115]
  v_pk_fma_f32 v[116:117], v[58:59], v[58:59], v[116:117]
  v_pk_fma_f32 v[114:115], v[60:61], v[60:61], v[114:115]
  v_pk_fma_f32 v[116:117], v[62:63], v[62:63], v[116:117]
  v_pk_add_f32 v[114:115], v[114:115], v[116:117]
  v_add_f32 v113, v114, v115
  v_mov_b32 v114, v113
  s_nop 1
  v_permlane32_swap_b32 v113, v114
  v_add_f32 v113, v113, v114
  v_mov_b32 v114, v113
  s_nop 1
  v_permlane16_swap_b32 v113, v114
  v_add_f32 v113, v113, v114

  v_and_b32 v114, 15, v0
  v_lshlrev_b32 v114, 5, v114
  s_lshl_b32 s26, s18, 3
  v_add_u32 v115, s26, v114
  ds_write_b64 v115, v[112:113] offset:16384
  s_waitcnt lgkmcnt(0)
  s_barrier
  ds_read_b128 v[116:119], v114 offset:16384
  ds_read_b128 v[120:123], v114 offset:16400
  s_waitcnt lgkmcnt(0)
  v_add_f32 v113, v116, v118
  v_add_f32 v114, v120, v122
  v_add_f32 v113, v113, v114
  v_mul_f32 v113, 0.25, v113
  v_add_f32 v117, v117, v119
  v_add_f32 v121, v121, v123
  v_add_f32 v117, v117, v121
  v_sub_f32 v116, v116, v113
  v_sub_f32 v118, v118, v113
  v_sub_f32 v120, v120, v113
  v_sub_f32 v122, v122, v113
  v_mul_f32 v116, v116, v116
  v_fmac_f32 v116, v118, v118
  v_fmac_f32 v116, v120, v120
  v_fmac_f32 v116, v122, v122
  v_fmac_f32 v117, 0x43000000, v116
  v_mul_f32 v117, 0x3b000000, v117
  v_add_f32 v118, 0x3727c5ac, v117
  v_rsq_f32 v118, v118
  v_sub_f32 v112, v112, v113
  v_mul_f32 v112, v112, v118

  v_pk_fma_f32 v[32:33], v[32:33], v[118:119], v[112:113] op_sel_hi:[1,0,0]
  v_pk_fma_f32 v[34:35], v[34:35], v[118:119], v[112:113] op_sel_hi:[1,0,0]
  v_pk_fma_f32 v[36:37], v[36:37], v[118:119], v[112:113] op_sel_hi:[1,0,0]
  v_pk_fma_f32 v[38:39], v[38:39], v[118:119], v[112:113] op_sel_hi:[1,0,0]
  v_pk_fma_f32 v[40:41], v[40:41], v[118:119], v[112:113] op_sel_hi:[1,0,0]
  v_pk_fma_f32 v[42:43], v[42:43], v[118:119], v[112:113] op_sel_hi:[1,0,0]
  v_pk_fma_f32 v[44:45], v[44:45], v[118:119], v[112:113] op_sel_hi:[1,0,0]
  v_pk_fma_f32 v[46:47], v[46:47], v[118:119], v[112:113] op_sel_hi:[1,0,0]
  v_pk_fma_f32 v[48:49], v[48:49], v[118:119], v[112:113] op_sel_hi:[1,0,0]
  v_pk_fma_f32 v[50:51], v[50:51], v[118:119], v[112:113] op_sel_hi:[1,0,0]
  v_pk_fma_f32 v[52:53], v[52:53], v[118:119], v[112:113] op_sel_hi:[1,0,0]
  v_pk_fma_f32 v[54:55], v[54:55], v[118:119], v[112:113] op_sel_hi:[1,0,0]
  v_pk_fma_f32 v[56:57], v[56:57], v[118:119], v[112:113] op_sel_hi:[1,0,0]
  v_pk_fma_f32 v[58:59], v[58:59], v[118:119], v[112:113] op_sel_hi:[1,0,0]
  v_pk_fma_f32 v[60:61], v[60:61], v[118:119], v[112:113] op_sel_hi:[1,0,0]
  v_pk_fma_f32 v[62:63], v[62:63], v[118:119], v[112:113] op_sel_hi:[1,0,0]
  v_cvt_pk_bf16_f32 v64, v32, v33
  v_cvt_pk_bf16_f32 v65, v34, v35
  v_cvt_pk_bf16_f32 v66, v36, v37
  v_cvt_pk_bf16_f32 v67, v38, v39
  v_cvt_pk_bf16_f32 v68, v40, v41
  v_cvt_pk_bf16_f32 v69, v42, v43
  v_cvt_pk_bf16_f32 v70, v44, v45
  v_cvt_pk_bf16_f32 v71, v46, v47
  v_cvt_pk_bf16_f32 v72, v48, v49
  v_cvt_pk_bf16_f32 v73, v50, v51
  v_cvt_pk_bf16_f32 v74, v52, v53
  v_cvt_pk_bf16_f32 v75, v54, v55
  v_cvt_pk_bf16_f32 v76, v56, v57
  v_cvt_pk_bf16_f32 v77, v58, v59
  v_cvt_pk_bf16_f32 v78, v60, v61
  v_cvt_pk_bf16_f32 v79, v62, v63
  ds_write_b128 v6, v[64:67] offset:0
  ds_write_b128 v6, v[68:71] offset:1024
  ds_write_b128 v6, v[72:75] offset:2048
  ds_write_b128 v6, v[76:79] offset:3072
  s_waitcnt lgkmcnt(0)
  s_barrier
  ds_read_b128 v[128:131], v1 offset:0
  ds_read_b128 v[132:135], v1 offset:1024
  ds_read_b128 v[136:139], v1 offset:2048
  ds_read_b128 v[140:143], v1 offset:3072
  ds_read_b128 v[144:147], v1 offset:4096
  ds_read_b128 v[148:151], v1 offset:5120
  ds_read_b128 v[152:155], v1 offset:6144
  ds_read_b128 v[156:159], v1 offset:7168
  ds_read_b128 v[160:163], v1 offset:8192
  ds_read_b128 v[164:167], v1 offset:9216
  ds_read_b128 v[168:171], v1 offset:10240
  ds_read_b128 v[172:175], v1 offset:11264
  ds_read_b128 v[176:179], v1 offset:12288
  ds_read_b128 v[180:183], v1 offset:13312
  ds_read_b128 v[184:187], v1 offset:14336
  ds_read_b128 v[188:191], v1 offset:15360
  s_waitcnt lgkmcnt(15)
  v_mfma_f32_16x16x32_bf16 v[192:195], a[0:3], v[128:131], 0
  v_mfma_f32_16x16x32_bf16 v[196:199], a[4:7], v[128:131], 0
  v_mfma_f32_16x16x32_bf16 v[200:203], a[8:11], v[128:131], 0
  v_mfma_f32_16x16x32_bf16 v[204:207], a[12:15], v[128:131], 0
  s_waitcnt lgkmcnt(14)
  v_mfma_f32_16x16x32_bf16 v[192:195], a[16:19], v[132:135], v[192:195]
  v_mfma_f32_16x16x32_bf16 v[196:199], a[20:23], v[132:135], v[196:199]
  v_mfma_f32_16x16x32_bf16 v[200:203], a[24:27], v[132:135], v[200:203]
  v_mfma_f32_16x16x32_bf16 v[204:207], a[28:31], v[132:135], v[204:207]
  s_waitcnt lgkmcnt(13)
  v_mfma_f32_16x16x32_bf16 v[192:195], a[32:35], v[136:139], v[192:195]
  v_mfma_f32_16x16x32_bf16 v[196:199], a[36:39], v[136:139], v[196:199]
  v_mfma_f32_16x16x32_bf16 v[200:203], a[40:43], v[136:139], v[200:203]
  v_mfma_f32_16x16x32_bf16 v[204:207], a[44:47], v[136:139], v[204:207]
  s_waitcnt lgkmcnt(12)
  v_mfma_f32_16x16x32_bf16 v[192:195], a[48:51], v[140:143], v[192:195]
  v_mfma_f32_16x16x32_bf16 v[196:199], a[52:55], v[140:143], v[196:199]
  v_mfma_f32_16x16x32_bf16 v[200:203], a[56:59], v[140:143], v[200:203]
  v_mfma_f32_16x16x32_bf16 v[204:207], a[60:63], v[140:143], v[204:207]
  s_waitcnt lgkmcnt(11)
  v_mfma_f32_16x16x32_bf16 v[192:195], a[64:67], v[144:147], v[192:195]
  v_mfma_f32_16x16x32_bf16 v[196:199], a[68:71], v[144:147], v[196:199]
  v_mfma_f32_16x16x32_bf16 v[200:203], a[72:75], v[144:147], v[200:203]
  v_mfma_f32_16x16x32_bf16 v[204:207], a[76:79], v[144:147], v[204:207]
  s_waitcnt lgkmcnt(10)
  v_mfma_f32_16x16x32_bf16 v[192:195], a[80:83], v[148:151], v[192:195]
  v_mfma_f32_16x16x32_bf16 v[196:199], a[84:87], v[148:151], v[196:199]
  v_mfma_f32_16x16x32_bf16 v[200:203], a[88:91], v[148:151], v[200:203]
  v_mfma_f32_16x16x32_bf16 v[204:207], a[92:95], v[148:151], v[204:207]
  s_waitcnt lgkmcnt(9)
  v_mfma_f32_16x16x32_bf16 v[192:195], a[96:99], v[152:155], v[192:195]
  v_mfma_f32_16x16x32_bf16 v[196:199], a[100:103], v[152:155], v[196:199]
  v_mfma_f32_16x16x32_bf16 v[200:203], a[104:107], v[152:155], v[200:203]
  v_mfma_f32_16x16x32_bf16 v[204:207], a[108:111], v[152:155], v[204:207]
  s_waitcnt lgkmcnt(8)
  v_mfma_f32_16x16x32_bf16 v[192:195], a[112:115], v[156:159], v[192:195]
  v_mfma_f32_16x16x32_bf16 v[196:199], a[116:119], v[156:159], v[196:199]
  v_mfma_f32_16x16x32_bf16 v[200:203], a[120:123], v[156:159], v[200:203]
  v_mfma_f32_16x16x32_bf16 v[204:207], a[124:127], v[156:159], v[204:207]
  s_waitcnt lgkmcnt(7)
  v_mfma_f32_16x16x32_bf16 v[192:195], a[128:131], v[160:163], v[192:195]
  v_mfma_f32_16x16x32_bf16 v[196:199], a[132:135], v[160:163], v[196:199]
  v_mfma_f32_16x16x32_bf16 v[200:203], a[136:139], v[160:163], v[200:203]
  v_mfma_f32_16x16x32_bf16 v[204:207], a[140:143], v[160:163], v[204:207]
  s_waitcnt lgkmcnt(6)
  v_mfma_f32_16x16x32_bf16 v[192:195], a[144:147], v[164:167], v[192:195]
  v_mfma_f32_16x16x32_bf16 v[196:199], a[148:151], v[164:167], v[196:199]
  v_mfma_f32_16x16x32_bf16 v[200:203], a[152:155], v[164:167], v[200:203]
  v_mfma_f32_16x16x32_bf16 v[204:207], a[156:159], v[164:167], v[204:207]
  s_waitcnt lgkmcnt(5)
  v_mfma_f32_16x16x32_bf16 v[192:195], a[160:163], v[168:171], v[192:195]
  v_mfma_f32_16x16x32_bf16 v[196:199], a[164:167], v[168:171], v[196:199]
  v_mfma_f32_16x16x32_bf16 v[200:203], a[168:171], v[168:171], v[200:203]
  v_mfma_f32_16x16x32_bf16 v[204:207], a[172:175], v[168:171], v[204:207]
  s_waitcnt lgkmcnt(4)
  v_mfma_f32_16x16x32_bf16 v[192:195], a[176:179], v[172:175], v[192:195]
  v_mfma_f32_16x16x32_bf16 v[196:199], a[180:183], v[172:175], v[196:199]
  v_mfma_f32_16x16x32_bf16 v[200:203], a[184:187], v[172:175], v[200:203]
  v_mfma_f32_16x16x32_bf16 v[204:207], a[188:191], v[172:175], v[204:207]
  s_waitcnt lgkmcnt(3)
  v_mfma_f32_16x16x32_bf16 v[192:195], a[192:195], v[176:179], v[192:195]
  v_mfma_f32_16x16x32_bf16 v[196:199], a[196:199], v[176:179], v[196:199]
  v_mfma_f32_16x16x32_bf16 v[200:203], a[200:203], v[176:179], v[200:203]
  v_mfma_f32_16x16x32_bf16 v[204:207], a[204:207], v[176:179], v[204:207]
  s_waitcnt lgkmcnt(2)
  v_mfma_f32_16x16x32_bf16 v[192:195], a[208:211], v[180:183], v[192:195]
  v_mfma_f32_16x16x32_bf16 v[196:199], a[212:215], v[180:183], v[196:199]
  v_mfma_f32_16x16x32_bf16 v[200:203], a[216:219], v[180:183], v[200:203]
  v_mfma_f32_16x16x32_bf16 v[204:207], a[220:223], v[180:183], v[204:207]
  s_waitcnt lgkmcnt(1)
  v_mfma_f32_16x16x32_bf16 v[192:195], a[224:227], v[184:187], v[192:195]
  v_mfma_f32_16x16x32_bf16 v[196:199], a[228:231], v[184:187], v[196:199]
  v_mfma_f32_16x16x32_bf16 v[200:203], a[232:235], v[184:187], v[200:203]
  v_mfma_f32_16x16x32_bf16 v[204:207], a[236:239], v[184:187], v[204:207]
  s_waitcnt lgkmcnt(0)
  v_mfma_f32_16x16x32_bf16 v[192:195], a[240:243], v[188:191], v[192:195]
  v_mfma_f32_16x16x32_bf16 v[196:199], a[244:247], v[188:191], v[196:199]
  v_mfma_f32_16x16x32_bf16 v[200:203], a[248:251], v[188:191], v[200:203]
  v_mfma_f32_16x16x32_bf16 v[204:207], a[252:255], v[188:191], v[204:207]
  s_nop 7
  s_mul_i32 s28, s19, 57344
  s_add_u32 s28, s28, s25
  s_add_u32 s27, s28, 123731968
  s_add_u32 s8, s12, s27
  s_addc_u32 s9, s13, 0
  v_mul_f32 v112, v192, v192
  v_mul_f32 v113, v193, v193
  v_mul_f32 v114, v194, v194
  v_mul_f32 v115, v195, v195
  v_mul_f32 v116, v196, v196
  v_mul_f32 v117, v197, v197
  v_mul_f32 v118, v198, v198
  v_mul_f32 v119, v199, v199
  v_mov_b32 v120, s30
  v_fma_f32 v112, v112, s31, v120
  v_fma_f32 v113, v113, s31, v120
  v_fma_f32 v114, v114, s31, v120
  v_fma_f32 v115, v115, s31, v120
  v_fma_f32 v116, v116, s31, v120
  v_fma_f32 v117, v117, s31, v120
  v_fma_f32 v118, v118, s31, v120
  v_fma_f32 v119, v119, s31, v120
  v_mul_f32 v112, v112, v192
  v_mul_f32 v113, v113, v193
  v_mul_f32 v114, v114, v194
  v_mul_f32 v115, v115, v195
  v_mul_f32 v116, v116, v196
  v_mul_f32 v117, v117, v197
  v_mul_f32 v118, v118, v198
  v_mul_f32 v119, v119, v199
  v_exp_f32 v112, v112
  v_exp_f32 v113, v113
  v_exp_f32 v114, v114
  v_exp_f32 v115, v115
  v_exp_f32 v116, v116
  v_exp_f32 v117, v117
  v_exp_f32 v118, v118
  v_exp_f32 v119, v119
  v_add_f32 v112, 1.0, v112
  v_add_f32 v113, 1.0, v113
  v_add_f32 v114, 1.0, v114
  v_add_f32 v115, 1.0, v115
  v_add_f32 v116, 1.0, v116
  v_add_f32 v117, 1.0, v117
  v_add_f32 v118, 1.0, v118
  v_add_f32 v119, 1.0, v119
  v_rcp_f32 v112, v112
  v_rcp_f32 v113, v113
  v_rcp_f32 v114, v114
  v_rcp_f32 v115, v115
  v_rcp_f32 v116, v116
  v_rcp_f32 v117, v117
  v_rcp_f32 v118, v118
  v_rcp_f32 v119, v119
  v_mul_f32 v192, v192, v112
  v_mul_f32 v193, v193, v113
  v_mul_f32 v194, v194, v114
  v_mul_f32 v195, v195, v115
  v_mul_f32 v196, v196, v116
  v_mul_f32 v197, v197, v117
  v_mul_f32 v198, v198, v118
  v_mul_f32 v199, v199, v119
  v_cvt_pk_bf16_f32 v64, v192, v193
  v_cvt_pk_bf16_f32 v65, v194, v195
  v_cvt_pk_bf16_f32 v66, v196, v197
  v_cvt_pk_bf16_f32 v67, v198, v199
  global_store_dwordx4 v1, v[64:67], s[8:9] offset:0 sc1
  v_mul_f32 v112, v200, v200
  v_mul_f32 v113, v201, v201
  v_mul_f32 v114, v202, v202
  v_mul_f32 v115, v203, v203
  v_mul_f32 v116, v204, v204
  v_mul_f32 v117, v205, v205
  v_mul_f32 v118, v206, v206
  v_mul_f32 v119, v207, v207
  v_mov_b32 v120, s30
  v_fma_f32 v112, v112, s31, v120
  v_fma_f32 v113, v113, s31, v120
  v_fma_f32 v114, v114, s31, v120
  v_fma_f32 v115, v115, s31, v120
  v_fma_f32 v116, v116, s31, v120
  v_fma_f32 v117, v117, s31, v120
  v_fma_f32 v118, v118, s31, v120
  v_fma_f32 v119, v119, s31, v120
  v_mul_f32 v112, v112, v200
  v_mul_f32 v113, v113, v201
  v_mul_f32 v114, v114, v202
  v_mul_f32 v115, v115, v203
  v_mul_f32 v116, v116, v204
  v_mul_f32 v117, v117, v205
  v_mul_f32 v118, v118, v206
  v_mul_f32 v119, v119, v207
  v_exp_f32 v112, v112
  v_exp_f32 v113, v113
  v_exp_f32 v114, v114
  v_exp_f32 v115, v115
  v_exp_f32 v116, v116
  v_exp_f32 v117, v117
  v_exp_f32 v118, v118
  v_exp_f32 v119, v119
  v_add_f32 v112, 1.0, v112
  v_add_f32 v113, 1.0, v113
  v_add_f32 v114, 1.0, v114
  v_add_f32 v115, 1.0, v115
  v_add_f32 v116, 1.0, v116
  v_add_f32 v117, 1.0, v117
  v_add_f32 v118, 1.0, v118
  v_add_f32 v119, 1.0, v119
  v_rcp_f32 v112, v112
  v_rcp_f32 v113, v113
  v_rcp_f32 v114, v114
  v_rcp_f32 v115, v115
  v_rcp_f32 v116, v116
  v_rcp_f32 v117, v117
  v_rcp_f32 v118, v118
  v_rcp_f32 v119, v119
  v_mul_f32 v200, v200, v112
  v_mul_f32 v201, v201, v113
  v_mul_f32 v202, v202, v114
  v_mul_f32 v203, v203, v115
  v_mul_f32 v204, v204, v116
  v_mul_f32 v205, v205, v117
  v_mul_f32 v206, v206, v118
  v_mul_f32 v207, v207, v119
  v_cvt_pk_bf16_f32 v68, v200, v201
  v_cvt_pk_bf16_f32 v69, v202, v203
  v_cvt_pk_bf16_f32 v70, v204, v205
  v_cvt_pk_bf16_f32 v71, v206, v207
  global_store_dwordx4 v1, v[68:71], s[8:9] offset:1024 sc1
  s_cmp_eq_u32 s18, 0
  s_cbranch_scc0 mega_kernel_ht_7
  s_lshl_b32 s60, s19, 7
  s_add_u32 s60, s60, 73744
  v_mov_b32 v2, s60
  v_mov_b32 v3, 1
  v_cmp_eq_u32 vcc, 0, v0
  s_and_saveexec_b64 s[62:63], vcc
  global_atomic_add v2, v3, s[14:15]
  s_mov_b64 exec, s[62:63]
mega_kernel_ht_7:

  s_lshl_b32 s28, s19, 7
  s_add_u32 s28, s28, 73728
  s_waitcnt vmcnt(0)
  s_barrier
  s_cmp_eq_u32 s18, 0
  s_cbranch_scc0 mega_kernel_sg_8
  v_mov_b32 v2, s28
  v_mov_b32 v3, 1
  v_cmp_eq_u32 vcc, 0, v0
  s_and_saveexec_b64 s[62:63], vcc
  global_atomic_add v2, v3, s[14:15]

  s_mov_b64 exec, s[62:63]
mega_kernel_sg_8:

  s_add_u32 s19, s19, 5
  s_cmp_lt_u32 s19, 128
  s_cbranch_scc1 mega_kernel_w3_tl
  s_branch mega_kernel_end
mega_kernel_rW4:
  s_sub_u32 s26, s17, 35
  s_mul_hi_u32 s20, s26, 858993460
  s_mul_i32 s27, s20, 5
  s_sub_u32 s22, s26, s27
  s_load_dwordx2 s[4:5], s[0:1], 88
  s_load_dwordx2 s[10:11], s[0:1], 96
  s_mul_i32 s26, s18, 458752
  s_lshl_b32 s27, s20, 7
  s_add_u32 s26, s26, s27
  s_mul_i32 s23, s18, 14336

  s_waitcnt lgkmcnt(0)
  s_add_u32 s4, s4, s26
  s_addc_u32 s5, s5, 0
  v_lshrrev_b32 v5, 3, v0
  v_mov_b32 v6, 1024
  v_mul_lo_u32 v5, v5, v6
  v_and_b32 v6, 7, v0
  v_lshl_add_u32 v2, v6, 4, v5
  v_and_b32 v5, 15, v0
  v_lshrrev_b32 v6, 4, v0
  v_lshrrev_b32 v7, 2, v5
  v_lshl_add_u32 v7, v6, 3, v7
  v_mul_u32_u24 v7, 128, v7
  v_and_b32 v5, 3, v5
  v_lshl_add_u32 v7, v5, 4, v7
  s_mul_i32 s24, s18, 40960
  s_add_u32 s24, s24, 0
  v_add_u32 v3, s24, v7

  s_add_u32 s8, s4, 0
  s_addc_u32 s9, s5, 0
  s_add_u32 m0, s24, 0
  s_nop 0
  global_load_lds_dwordx4 v2, s[8:9]

  s_add_u32 s8, s4, 8192
  s_addc_u32 s9, s5, 0
  s_add_u32 m0, s24, 1024
  s_nop 0
  global_load_lds_dwordx4 v2, s[8:9]

  s_add_u32 s8, s4, 16384
  s_addc_u32 s9, s5, 0
  s_add_u32 m0, s24, 2048
  s_nop 0
  global_load_lds_dwordx4 v2, s[8:9]

  s_add_u32 s8, s4, 24576
  s_addc_u32 s9, s5, 0
  s_add_u32 m0, s24, 3072
  s_nop 0
  global_load_lds_dwordx4 v2, s[8:9]

  s_add_u32 s8, s4, 32768
  s_addc_u32 s9, s5, 0
  s_add_u32 m0, s24, 4096
  s_nop 0
  global_load_lds_dwordx4 v2, s[8:9]

  s_add_u32 s8, s4, 40960
  s_addc_u32 s9, s5, 0
  s_add_u32 m0, s24, 5120
  s_nop 0
  global_load_lds_dwordx4 v2, s[8:9]

  s_add_u32 s8, s4, 49152
  s_addc_u32 s9, s5, 0
  s_add_u32 m0, s24, 6144
  s_nop 0
  global_load_lds_dwordx4 v2, s[8:9]

  s_add_u32 s8, s4, 57344
  s_addc_u32 s9, s5, 0
  s_add_u32 m0, s24, 7168
  s_nop 0
  global_load_lds_dwordx4 v2, s[8:9]

  s_add_u32 s8, s4, 65536
  s_addc_u32 s9, s5, 0
  s_add_u32 m0, s24, 8192
  s_nop 0
  global_load_lds_dwordx4 v2, s[8:9]

  s_add_u32 s8, s4, 73728
  s_addc_u32 s9, s5, 0
  s_add_u32 m0, s24, 9216
  s_nop 0
  global_load_lds_dwordx4 v2, s[8:9]

  s_add_u32 s8, s4, 81920
  s_addc_u32 s9, s5, 0
  s_add_u32 m0, s24, 10240
  s_nop 0
  global_load_lds_dwordx4 v2, s[8:9]

  s_add_u32 s8, s4, 90112
  s_addc_u32 s9, s5, 0
  s_add_u32 m0, s24, 11264
  s_nop 0
  global_load_lds_dwordx4 v2, s[8:9]

  s_add_u32 s8, s4, 98304
  s_addc_u32 s9, s5, 0
  s_add_u32 m0, s24, 12288
  s_nop 0
  global_load_lds_dwordx4 v2, s[8:9]

  s_add_u32 s8, s4, 106496
  s_addc_u32 s9, s5, 0
  s_add_u32 m0, s24, 13312
  s_nop 0
  global_load_lds_dwordx4 v2, s[8:9]

  s_add_u32 s8, s4, 114688
  s_addc_u32 s9, s5, 0
  s_add_u32 m0, s24, 14336
  s_nop 0
  global_load_lds_dwordx4 v2, s[8:9]

  s_add_u32 s8, s4, 122880
  s_addc_u32 s9, s5, 0
  s_add_u32 m0, s24, 15360
  s_nop 0
  global_load_lds_dwordx4 v2, s[8:9]

  s_add_u32 s8, s4, 131072
  s_addc_u32 s9, s5, 0
  s_add_u32 m0, s24, 16384
  s_nop 0
  global_load_lds_dwordx4 v2, s[8:9]

  s_add_u32 s8, s4, 139264
  s_addc_u32 s9, s5, 0
  s_add_u32 m0, s24, 17408
  s_nop 0
  global_load_lds_dwordx4 v2, s[8:9]

  s_add_u32 s8, s4, 147456
  s_addc_u32 s9, s5, 0
  s_add_u32 m0, s24, 18432
  s_nop 0
  global_load_lds_dwordx4 v2, s[8:9]

  s_add_u32 s8, s4, 155648
  s_addc_u32 s9, s5, 0
  s_add_u32 m0, s24, 19456
  s_nop 0
  global_load_lds_dwordx4 v2, s[8:9]

  s_add_u32 s8, s4, 163840
  s_addc_u32 s9, s5, 0
  s_add_u32 m0, s24, 20480
  s_nop 0
  global_load_lds_dwordx4 v2, s[8:9]

  s_add_u32 s8, s4, 172032
  s_addc_u32 s9, s5, 0
  s_add_u32 m0, s24, 21504
  s_nop 0
  global_load_lds_dwordx4 v2, s[8:9]

  s_add_u32 s8, s4, 180224
  s_addc_u32 s9, s5, 0
  s_add_u32 m0, s24, 22528
  s_nop 0
  global_load_lds_dwordx4 v2, s[8:9]

  s_add_u32 s8, s4, 188416
  s_addc_u32 s9, s5, 0
  s_add_u32 m0, s24, 23552
  s_nop 0
  global_load_lds_dwordx4 v2, s[8:9]

  s_add_u32 s8, s4, 196608
  s_addc_u32 s9, s5, 0
  s_add_u32 m0, s24, 24576
  s_nop 0
  global_load_lds_dwordx4 v2, s[8:9]

  s_add_u32 s8, s4, 204800
  s_addc_u32 s9, s5, 0
  s_add_u32 m0, s24, 25600
  s_nop 0
  global_load_lds_dwordx4 v2, s[8:9]

  s_add_u32 s8, s4, 212992
  s_addc_u32 s9, s5, 0
  s_add_u32 m0, s24, 26624
  s_nop 0
  global_load_lds_dwordx4 v2, s[8:9]

  s_add_u32 s8, s4, 221184
  s_addc_u32 s9, s5, 0
  s_add_u32 m0, s24, 27648
  s_nop 0
  global_load_lds_dwordx4 v2, s[8:9]

  s_add_u32 s8, s4, 229376
  s_addc_u32 s9, s5, 0
  s_add_u32 m0, s24, 28672
  s_nop 0
  global_load_lds_dwordx4 v2, s[8:9]

  s_add_u32 s8, s4, 237568
  s_addc_u32 s9, s5, 0
  s_add_u32 m0, s24, 29696
  s_nop 0
  global_load_lds_dwordx4 v2, s[8:9]

  s_add_u32 s8, s4, 245760
  s_addc_u32 s9, s5, 0
  s_add_u32 m0, s24, 30720
  s_nop 0
  global_load_lds_dwordx4 v2, s[8:9]

  s_add_u32 s8, s4, 253952
  s_addc_u32 s9, s5, 0
  s_add_u32 m0, s24, 31744
  s_nop 0
  global_load_lds_dwordx4 v2, s[8:9]

  s_add_u32 s8, s4, 262144
  s_addc_u32 s9, s5, 0
  s_add_u32 m0, s24, 32768
  s_nop 0
  global_load_lds_dwordx4 v2, s[8:9]

  s_add_u32 s8, s4, 270336
  s_addc_u32 s9, s5, 0
  s_add_u32 m0, s24, 33792
  s_nop 0
  global_load_lds_dwordx4 v2, s[8:9]

  s_add_u32 s8, s4, 278528
  s_addc_u32 s9, s5, 0
  s_add_u32 m0, s24, 34816
  s_nop 0
  global_load_lds_dwordx4 v2, s[8:9]

  s_add_u32 s8, s4, 286720
  s_addc_u32 s9, s5, 0
  s_add_u32 m0, s24, 35840
  s_nop 0
  global_load_lds_dwordx4 v2, s[8:9]

  s_add_u32 s8, s4, 294912
  s_addc_u32 s9, s5, 0
  s_add_u32 m0, s24, 36864
  s_nop 0
  global_load_lds_dwordx4 v2, s[8:9]

  s_add_u32 s8, s4, 303104
  s_addc_u32 s9, s5, 0
  s_add_u32 m0, s24, 37888
  s_nop 0
  global_load_lds_dwordx4 v2, s[8:9]

  s_add_u32 s8, s4, 311296
  s_addc_u32 s9, s5, 0
  s_add_u32 m0, s24, 38912
  s_nop 0
  global_load_lds_dwordx4 v2, s[8:9]

  s_add_u32 s8, s4, 319488
  s_addc_u32 s9, s5, 0
  s_add_u32 m0, s24, 39936
  s_nop 0
  global_load_lds_dwordx4 v2, s[8:9]

  s_waitcnt vmcnt(36)
  ds_read_b64_tr_b16 a[0:1], v3 offset:0
  ds_read_b64_tr_b16 a[2:3], v3 offset:512
  ds_read_b64_tr_b16 a[4:5], v3 offset:8
  ds_read_b64_tr_b16 a[6:7], v3 offset:520
  ds_read_b64_tr_b16 a[8:9], v3 offset:64
  ds_read_b64_tr_b16 a[10:11], v3 offset:576
  ds_read_b64_tr_b16 a[12:13], v3 offset:72
  ds_read_b64_tr_b16 a[14:15], v3 offset:584
  s_waitcnt lgkmcnt(0)

  s_add_u32 s8, s4, 327680
  s_addc_u32 s9, s5, 0
  s_add_u32 m0, s24, 0
  s_nop 0
  global_load_lds_dwordx4 v2, s[8:9]

  s_add_u32 s8, s4, 335872
  s_addc_u32 s9, s5, 0
  s_add_u32 m0, s24, 1024
  s_nop 0
  global_load_lds_dwordx4 v2, s[8:9]

  s_add_u32 s8, s4, 344064
  s_addc_u32 s9, s5, 0
  s_add_u32 m0, s24, 2048
  s_nop 0
  global_load_lds_dwordx4 v2, s[8:9]

  s_add_u32 s8, s4, 352256
  s_addc_u32 s9, s5, 0
  s_add_u32 m0, s24, 3072
  s_nop 0
  global_load_lds_dwordx4 v2, s[8:9]

  s_waitcnt vmcnt(36)
  ds_read_b64_tr_b16 a[16:17], v3 offset:4096
  ds_read_b64_tr_b16 a[18:19], v3 offset:4608
  ds_read_b64_tr_b16 a[20:21], v3 offset:4104
  ds_read_b64_tr_b16 a[22:23], v3 offset:4616
  ds_read_b64_tr_b16 a[24:25], v3 offset:4160
  ds_read_b64_tr_b16 a[26:27], v3 offset:4672
  ds_read_b64_tr_b16 a[28:29], v3 offset:4168
  ds_read_b64_tr_b16 a[30:31], v3 offset:4680
  s_waitcnt lgkmcnt(0)

  s_add_u32 s8, s4, 360448
  s_addc_u32 s9, s5, 0
  s_add_u32 m0, s24, 4096
  s_nop 0
  global_load_lds_dwordx4 v2, s[8:9]

  s_add_u32 s8, s4, 368640
  s_addc_u32 s9, s5, 0
  s_add_u32 m0, s24, 5120
  s_nop 0
  global_load_lds_dwordx4 v2, s[8:9]

  s_add_u32 s8, s4, 376832
  s_addc_u32 s9, s5, 0
  s_add_u32 m0, s24, 6144
  s_nop 0
  global_load_lds_dwordx4 v2, s[8:9]

  s_add_u32 s8, s4, 385024
  s_addc_u32 s9, s5, 0
  s_add_u32 m0, s24, 7168
  s_nop 0
  global_load_lds_dwordx4 v2, s[8:9]

  s_waitcnt vmcnt(36)
  ds_read_b64_tr_b16 a[32:33], v3 offset:8192
  ds_read_b64_tr_b16 a[34:35], v3 offset:8704
  ds_read_b64_tr_b16 a[36:37], v3 offset:8200
  ds_read_b64_tr_b16 a[38:39], v3 offset:8712
  ds_read_b64_tr_b16 a[40:41], v3 offset:8256
  ds_read_b64_tr_b16 a[42:43], v3 offset:8768
  ds_read_b64_tr_b16 a[44:45], v3 offset:8264
  ds_read_b64_tr_b16 a[46:47], v3 offset:8776
  s_waitcnt lgkmcnt(0)

  s_add_u32 s8, s4, 393216
  s_addc_u32 s9, s5, 0
  s_add_u32 m0, s24, 8192
  s_nop 0
  global_load_lds_dwordx4 v2, s[8:9]

  s_add_u32 s8, s4, 401408
  s_addc_u32 s9, s5, 0
  s_add_u32 m0, s24, 9216
  s_nop 0
  global_load_lds_dwordx4 v2, s[8:9]

  s_add_u32 s8, s4, 409600
  s_addc_u32 s9, s5, 0
  s_add_u32 m0, s24, 10240
  s_nop 0
  global_load_lds_dwordx4 v2, s[8:9]

  s_add_u32 s8, s4, 417792
  s_addc_u32 s9, s5, 0
  s_add_u32 m0, s24, 11264
  s_nop 0
  global_load_lds_dwordx4 v2, s[8:9]

  s_waitcnt vmcnt(36)
  ds_read_b64_tr_b16 a[48:49], v3 offset:12288
  ds_read_b64_tr_b16 a[50:51], v3 offset:12800
  ds_read_b64_tr_b16 a[52:53], v3 offset:12296
  ds_read_b64_tr_b16 a[54:55], v3 offset:12808
  ds_read_b64_tr_b16 a[56:57], v3 offset:12352
  ds_read_b64_tr_b16 a[58:59], v3 offset:12864
  ds_read_b64_tr_b16 a[60:61], v3 offset:12360
  ds_read_b64_tr_b16 a[62:63], v3 offset:12872
  s_waitcnt lgkmcnt(0)

  s_add_u32 s8, s4, 425984
  s_addc_u32 s9, s5, 0
  s_add_u32 m0, s24, 12288
  s_nop 0
  global_load_lds_dwordx4 v2, s[8:9]

  s_add_u32 s8, s4, 434176
  s_addc_u32 s9, s5, 0
  s_add_u32 m0, s24, 13312
  s_nop 0
  global_load_lds_dwordx4 v2, s[8:9]

  s_add_u32 s8, s4, 442368
  s_addc_u32 s9, s5, 0
  s_add_u32 m0, s24, 14336
  s_nop 0
  global_load_lds_dwordx4 v2, s[8:9]

  s_add_u32 s8, s4, 450560
  s_addc_u32 s9, s5, 0
  s_add_u32 m0, s24, 15360
  s_nop 0
  global_load_lds_dwordx4 v2, s[8:9]

  s_waitcnt vmcnt(36)
  ds_read_b64_tr_b16 a[64:65], v3 offset:16384
  ds_read_b64_tr_b16 a[66:67], v3 offset:16896
  ds_read_b64_tr_b16 a[68:69], v3 offset:16392
  ds_read_b64_tr_b16 a[70:71], v3 offset:16904
  ds_read_b64_tr_b16 a[72:73], v3 offset:16448
  ds_read_b64_tr_b16 a[74:75], v3 offset:16960
  ds_read_b64_tr_b16 a[76:77], v3 offset:16456
  ds_read_b64_tr_b16 a[78:79], v3 offset:16968
  s_waitcnt vmcnt(32)
  ds_read_b64_tr_b16 a[80:81], v3 offset:20480
  ds_read_b64_tr_b16 a[82:83], v3 offset:20992
  ds_read_b64_tr_b16 a[84:85], v3 offset:20488
  ds_read_b64_tr_b16 a[86:87], v3 offset:21000
  ds_read_b64_tr_b16 a[88:89], v3 offset:20544
  ds_read_b64_tr_b16 a[90:91], v3 offset:21056
  ds_read_b64_tr_b16 a[92:93], v3 offset:20552
  ds_read_b64_tr_b16 a[94:95], v3 offset:21064
  s_waitcnt vmcnt(28)
  ds_read_b64_tr_b16 a[96:97], v3 offset:24576
  ds_read_b64_tr_b16 a[98:99], v3 offset:25088
  ds_read_b64_tr_b16 a[100:101], v3 offset:24584
  ds_read_b64_tr_b16 a[102:103], v3 offset:25096
  ds_read_b64_tr_b16 a[104:105], v3 offset:24640
  ds_read_b64_tr_b16 a[106:107], v3 offset:25152
  ds_read_b64_tr_b16 a[108:109], v3 offset:24648
  ds_read_b64_tr_b16 a[110:111], v3 offset:25160
  s_waitcnt vmcnt(24)
  ds_read_b64_tr_b16 a[112:113], v3 offset:28672
  ds_read_b64_tr_b16 a[114:115], v3 offset:29184
  ds_read_b64_tr_b16 a[116:117], v3 offset:28680
  ds_read_b64_tr_b16 a[118:119], v3 offset:29192
  ds_read_b64_tr_b16 a[120:121], v3 offset:28736
  ds_read_b64_tr_b16 a[122:123], v3 offset:29248
  ds_read_b64_tr_b16 a[124:125], v3 offset:28744
  ds_read_b64_tr_b16 a[126:127], v3 offset:29256
  s_waitcnt vmcnt(20)
  ds_read_b64_tr_b16 a[128:129], v3 offset:32768
  ds_read_b64_tr_b16 a[130:131], v3 offset:33280
  ds_read_b64_tr_b16 a[132:133], v3 offset:32776
  ds_read_b64_tr_b16 a[134:135], v3 offset:33288
  ds_read_b64_tr_b16 a[136:137], v3 offset:32832
  ds_read_b64_tr_b16 a[138:139], v3 offset:33344
  ds_read_b64_tr_b16 a[140:141], v3 offset:32840
  ds_read_b64_tr_b16 a[142:143], v3 offset:33352
  s_waitcnt vmcnt(16)
  ds_read_b64_tr_b16 a[144:145], v3 offset:36864
  ds_read_b64_tr_b16 a[146:147], v3 offset:37376
  ds_read_b64_tr_b16 a[148:149], v3 offset:36872
  ds_read_b64_tr_b16 a[150:151], v3 offset:37384
  ds_read_b64_tr_b16 a[152:153], v3 offset:36928
  ds_read_b64_tr_b16 a[154:155], v3 offset:37440
  ds_read_b64_tr_b16 a[156:157], v3 offset:36936
  ds_read_b64_tr_b16 a[158:159], v3 offset:37448
  s_waitcnt vmcnt(12)
  ds_read_b64_tr_b16 a[160:161], v3 offset:0
  ds_read_b64_tr_b16 a[162:163], v3 offset:512
  ds_read_b64_tr_b16 a[164:165], v3 offset:8
  ds_read_b64_tr_b16 a[166:167], v3 offset:520
  ds_read_b64_tr_b16 a[168:169], v3 offset:64
  ds_read_b64_tr_b16 a[170:171], v3 offset:576
  ds_read_b64_tr_b16 a[172:173], v3 offset:72
  ds_read_b64_tr_b16 a[174:175], v3 offset:584
  s_waitcnt vmcnt(8)
  ds_read_b64_tr_b16 a[176:177], v3 offset:4096
  ds_read_b64_tr_b16 a[178:179], v3 offset:4608
  ds_read_b64_tr_b16 a[180:181], v3 offset:4104
  ds_read_b64_tr_b16 a[182:183], v3 offset:4616
  ds_read_b64_tr_b16 a[184:185], v3 offset:4160
  ds_read_b64_tr_b16 a[186:187], v3 offset:4672
  ds_read_b64_tr_b16 a[188:189], v3 offset:4168
  ds_read_b64_tr_b16 a[190:191], v3 offset:4680
  s_waitcnt vmcnt(4)
  ds_read_b64_tr_b16 a[192:193], v3 offset:8192
  ds_read_b64_tr_b16 a[194:195], v3 offset:8704
  ds_read_b64_tr_b16 a[196:197], v3 offset:8200
  ds_read_b64_tr_b16 a[198:199], v3 offset:8712
  ds_read_b64_tr_b16 a[200:201], v3 offset:8256
  ds_read_b64_tr_b16 a[202:203], v3 offset:8768
  ds_read_b64_tr_b16 a[204:205], v3 offset:8264
  ds_read_b64_tr_b16 a[206:207], v3 offset:8776
  s_waitcnt vmcnt(0)
  ds_read_b64_tr_b16 a[208:209], v3 offset:12288
  ds_read_b64_tr_b16 a[210:211], v3 offset:12800
  ds_read_b64_tr_b16 a[212:213], v3 offset:12296
  ds_read_b64_tr_b16 a[214:215], v3 offset:12808
  ds_read_b64_tr_b16 a[216:217], v3 offset:12352
  ds_read_b64_tr_b16 a[218:219], v3 offset:12864
  ds_read_b64_tr_b16 a[220:221], v3 offset:12360
  ds_read_b64_tr_b16 a[222:223], v3 offset:12872
  s_waitcnt lgkmcnt(0)
  s_barrier
  s_lshl_b32 s25, s20, 2
  s_add_u32 s25, s25, s18
  s_lshl_b32 s26, s18, 12
  v_add_u32 v6, s26, v1
  s_lshl_b32 s26, s18, 10
  v_add_u32 v7, s26, v1
  v_add_u32 v4, 4096, v1
  v_add_u32 v5, 8192, v1
  v_add_u32 v8, 12288, v1

  v_and_b32 v9, 15, v0
  v_lshlrev_b32 v9, 10, v9
  v_lshrrev_b32 v10, 4, v0
  v_lshl_add_u32 v9, v10, 4, v9
  s_lshr_b32 s26, s25, 1
  s_lshl_b32 s26, s26, 6
  s_and_b32 s27, s25, 1
  s_lshl_b32 s27, s27, 3
  s_add_u32 s26, s26, s27
  v_add_u32 v9, s26, v9

  s_mov_b32 s19, s22
  s_mov_b32 s38, 0
mega_kernel_w4_tl:
  s_lshl_b32 s28, s19, 7
  s_add_u32 s28, s28, 73728
  s_mov_b32 s37, 7
  s_cmp_ge_u32 s19, 124
  s_cselect_b32 s36, 16, 0
  s_add_u32 s28, s28, s36
  v_mov_b32 v2, s28
  s_mov_b32 s27, 0
mega_kernel_pl_9:
  global_load_dword v3, v2, s[14:15] sc1
  s_add_u32 s27, s27, 1
  s_cmp_gt_u32 s27, 50000000
  s_cbranch_scc1 mega_kernel_fail
  s_waitcnt vmcnt(0)
  v_readfirstlane_b32 s26, v3
  s_nop 3
  s_cmp_ge_u32 s26, s37
  s_cbranch_scc1 mega_kernel_pl_9_ok
  s_sleep 2
  s_branch mega_kernel_pl_9
mega_kernel_pl_9_ok:

mega_kernel_w4_st:
  s_lshl_b32 s28, s19, 15
  s_lshl_b32 s29, s25, 10
  s_add_u32 s28, s28, s29
  s_add_u32 s27, s28, 119537664
  s_add_u32 s8, s12, s27
  s_addc_u32 s9, s13, 0
  global_load_dwordx4 v[128:131], v1, s[8:9] sc1
  s_mul_i32 s28, s19, 57344
  s_add_u32 s28, s28, s23
  s_add_u32 s27, s28, 123731968
  s_add_u32 s6, s12, s27
  s_addc_u32 s7, s13, 0
  global_load_dwordx4 v[32:35], v1, s[6:7] offset:0 sc1
  global_load_dwordx4 v[36:39], v1, s[6:7] offset:1024 sc1
  global_load_dwordx4 v[40:43], v1, s[6:7] offset:2048 sc1
  global_load_dwordx4 v[44:47], v1, s[6:7] offset:3072 sc1
  global_load_dwordx4 v[48:51], v4, s[6:7] offset:0 sc1
  global_load_dwordx4 v[52:55], v4, s[6:7] offset:1024 sc1
  global_load_dwordx4 v[56:59], v4, s[6:7] offset:2048 sc1
  global_load_dwordx4 v[60:63], v4, s[6:7] offset:3072 sc1
  global_load_dwordx4 v[64:67], v5, s[6:7] offset:0 sc1
  global_load_dwordx4 v[68:71], v5, s[6:7] offset:1024 sc1
  global_load_dwordx4 v[72:75], v5, s[6:7] offset:2048 sc1
  global_load_dwordx4 v[76:79], v5, s[6:7] offset:3072 sc1
  global_load_dwordx4 v[80:83], v8, s[6:7] offset:0 sc1
  global_load_dwordx4 v[84:87], v8, s[6:7] offset:1024 sc1
  s_waitcnt vmcnt(13)
  v_mfma_f32_16x16x32_bf16 v[96:99], a[0:3], v[32:35], 0
  v_mfma_f32_16x16x32_bf16 v[100:103], a[4:7], v[32:35], 0
  v_mfma_f32_16x16x32_bf16 v[104:107], a[8:11], v[32:35], 0
  v_mfma_f32_16x16x32_bf16 v[108:111], a[12:15], v[32:35], 0
  s_waitcnt vmcnt(12)
  v_mfma_f32_16x16x32_bf16 v[96:99], a[16:19], v[36:39], v[96:99]
  v_mfma_f32_16x16x32_bf16 v[100:103], a[20:23], v[36:39], v[100:103]
  v_mfma_f32_16x16x32_bf16 v[104:107], a[24:27], v[36:39], v[104:107]
  v_mfma_f32_16x16x32_bf16 v[108:111], a[28:31], v[36:39], v[108:111]
  s_waitcnt vmcnt(11)
  v_mfma_f32_16x16x32_bf16 v[96:99], a[32:35], v[40:43], v[96:99]
  v_mfma_f32_16x16x32_bf16 v[100:103], a[36:39], v[40:43], v[100:103]
  v_mfma_f32_16x16x32_bf16 v[104:107], a[40:43], v[40:43], v[104:107]
  v_mfma_f32_16x16x32_bf16 v[108:111], a[44:47], v[40:43], v[108:111]
  s_waitcnt vmcnt(10)
  v_mfma_f32_16x16x32_bf16 v[96:99], a[48:51], v[44:47], v[96:99]
  v_mfma_f32_16x16x32_bf16 v[100:103], a[52:55], v[44:47], v[100:103]
  v_mfma_f32_16x16x32_bf16 v[104:107], a[56:59], v[44:47], v[104:107]
  v_mfma_f32_16x16x32_bf16 v[108:111], a[60:63], v[44:47], v[108:111]
  s_waitcnt vmcnt(9)
  v_mfma_f32_16x16x32_bf16 v[96:99], a[64:67], v[48:51], v[96:99]
  v_mfma_f32_16x16x32_bf16 v[100:103], a[68:71], v[48:51], v[100:103]
  v_mfma_f32_16x16x32_bf16 v[104:107], a[72:75], v[48:51], v[104:107]
  v_mfma_f32_16x16x32_bf16 v[108:111], a[76:79], v[48:51], v[108:111]
  s_waitcnt vmcnt(8)
  v_mfma_f32_16x16x32_bf16 v[96:99], a[80:83], v[52:55], v[96:99]
  v_mfma_f32_16x16x32_bf16 v[100:103], a[84:87], v[52:55], v[100:103]
  v_mfma_f32_16x16x32_bf16 v[104:107], a[88:91], v[52:55], v[104:107]
  v_mfma_f32_16x16x32_bf16 v[108:111], a[92:95], v[52:55], v[108:111]
  s_waitcnt vmcnt(7)
  v_mfma_f32_16x16x32_bf16 v[96:99], a[96:99], v[56:59], v[96:99]
  v_mfma_f32_16x16x32_bf16 v[100:103], a[100:103], v[56:59], v[100:103]
  v_mfma_f32_16x16x32_bf16 v[104:107], a[104:107], v[56:59], v[104:107]
  v_mfma_f32_16x16x32_bf16 v[108:111], a[108:111], v[56:59], v[108:111]
  s_waitcnt vmcnt(6)
  v_mfma_f32_16x16x32_bf16 v[96:99], a[112:115], v[60:63], v[96:99]
  v_mfma_f32_16x16x32_bf16 v[100:103], a[116:119], v[60:63], v[100:103]
  v_mfma_f32_16x16x32_bf16 v[104:107], a[120:123], v[60:63], v[104:107]
  v_mfma_f32_16x16x32_bf16 v[108:111], a[124:127], v[60:63], v[108:111]
  s_waitcnt vmcnt(5)
  v_mfma_f32_16x16x32_bf16 v[96:99], a[128:131], v[64:67], v[96:99]
  v_mfma_f32_16x16x32_bf16 v[100:103], a[132:135], v[64:67], v[100:103]
  v_mfma_f32_16x16x32_bf16 v[104:107], a[136:139], v[64:67], v[104:107]
  v_mfma_f32_16x16x32_bf16 v[108:111], a[140:143], v[64:67], v[108:111]
  s_waitcnt vmcnt(4)
  v_mfma_f32_16x16x32_bf16 v[96:99], a[144:147], v[68:71], v[96:99]
  v_mfma_f32_16x16x32_bf16 v[100:103], a[148:151], v[68:71], v[100:103]
  v_mfma_f32_16x16x32_bf16 v[104:107], a[152:155], v[68:71], v[104:107]
  v_mfma_f32_16x16x32_bf16 v[108:111], a[156:159], v[68:71], v[108:111]
  s_waitcnt vmcnt(3)
  v_mfma_f32_16x16x32_bf16 v[96:99], a[160:163], v[72:75], v[96:99]
  v_mfma_f32_16x16x32_bf16 v[100:103], a[164:167], v[72:75], v[100:103]
  v_mfma_f32_16x16x32_bf16 v[104:107], a[168:171], v[72:75], v[104:107]
  v_mfma_f32_16x16x32_bf16 v[108:111], a[172:175], v[72:75], v[108:111]
  s_waitcnt vmcnt(2)
  v_mfma_f32_16x16x32_bf16 v[96:99], a[176:179], v[76:79], v[96:99]
  v_mfma_f32_16x16x32_bf16 v[100:103], a[180:183], v[76:79], v[100:103]
  v_mfma_f32_16x16x32_bf16 v[104:107], a[184:187], v[76:79], v[104:107]
  v_mfma_f32_16x16x32_bf16 v[108:111], a[188:191], v[76:79], v[108:111]
  s_waitcnt vmcnt(1)
  v_mfma_f32_16x16x32_bf16 v[96:99], a[192:195], v[80:83], v[96:99]
  v_mfma_f32_16x16x32_bf16 v[100:103], a[196:199], v[80:83], v[100:103]
  v_mfma_f32_16x16x32_bf16 v[104:107], a[200:203], v[80:83], v[104:107]
  v_mfma_f32_16x16x32_bf16 v[108:111], a[204:207], v[80:83], v[108:111]
  s_waitcnt vmcnt(0)
  v_mfma_f32_16x16x32_bf16 v[96:99], a[208:211], v[84:87], v[96:99]
  v_mfma_f32_16x16x32_bf16 v[100:103], a[212:215], v[84:87], v[100:103]
  v_mfma_f32_16x16x32_bf16 v[104:107], a[216:219], v[84:87], v[104:107]
  v_mfma_f32_16x16x32_bf16 v[108:111], a[220:223], v[84:87], v[108:111]
  s_cmp_ge_u32 s19, 124
  s_cselect_b64 s[60:61], -1, 0
  v_max3_u32 v112, v32, v33, v34
  v_mov_b32 v113, v35
  v_max3_u32 v112, v112, v36, v37
  v_max3_u32 v113, v113, v38, v39
  v_max3_u32 v112, v112, v40, v41
  v_max3_u32 v113, v113, v42, v43
  v_max3_u32 v112, v112, v44, v45
  v_max3_u32 v113, v113, v46, v47
  v_max3_u32 v112, v112, v48, v49
  v_max3_u32 v113, v113, v50, v51
  v_max3_u32 v112, v112, v52, v53
  v_max3_u32 v113, v113, v54, v55
  v_max3_u32 v112, v112, v56, v57
  v_max3_u32 v113, v113, v58, v59
  v_max3_u32 v112, v112, v60, v61
  v_max3_u32 v113, v113, v62, v63
  v_max3_u32 v112, v112, v64, v65
  v_max3_u32 v113, v113, v66, v67
  v_max3_u32 v112, v112, v68, v69
  v_max3_u32 v113, v113, v70, v71
  v_max3_u32 v112, v112, v72, v73
  v_max3_u32 v113, v113, v74, v75
  v_max3_u32 v112, v112, v76, v77
  v_max3_u32 v113, v113, v78, v79
  v_max3_u32 v112, v112, v80, v81
  v_max3_u32 v113, v113, v82, v83
  v_max3_u32 v112, v112, v84, v85
  v_max3_u32 v113, v113, v86, v87
  v_max3_u32 v112, v112, v128, v129
  v_max3_u32 v113, v113, v130, v131
  v_max_u32 v112, v112, v113
  s_add_u32 s38, s38, 1
  s_cmp_gt_u32 s38, 50000000
  s_cbranch_scc1 mega_kernel_fail
  v_cmp_eq_u32 vcc, -1, v112
  s_nop 3
  s_and_b64 vcc, vcc, s[60:61]
  s_cbranch_vccnz mega_kernel_w4_st

  ds_write_b128 v6, v[96:99] offset:0
  ds_write_b128 v6, v[100:103] offset:1024
  ds_write_b128 v6, v[104:107] offset:2048
  ds_write_b128 v6, v[108:111] offset:3072
  s_waitcnt lgkmcnt(0)
  s_barrier
  ds_read_b128 v[112:115], v7 offset:0
  ds_read_b128 v[116:119], v7 offset:4096
  ds_read_b128 v[120:123], v7 offset:8192
  ds_read_b128 v[124:127], v7 offset:12288
  s_waitcnt lgkmcnt(2)
  v_pk_add_f32 v[112:113], v[112:113], v[116:117]
  v_pk_add_f32 v[114:115], v[114:115], v[118:119]
  s_waitcnt lgkmcnt(0)
  v_pk_add_f32 v[120:121], v[120:121], v[124:125]
  v_pk_add_f32 v[122:123], v[122:123], v[126:127]
  v_pk_add_f32 v[112:113], v[112:113], v[120:121]
  v_pk_add_f32 v[114:115], v[114:115], v[122:123]

  v_pk_add_f32 v[112:113], v[112:113], v[128:129]
  v_pk_add_f32 v[114:115], v[114:115], v[130:131]
  v_cvt_pk_bf16_f32 v116, v112, v113
  v_cvt_pk_bf16_f32 v117, v114, v115
  s_lshl_b32 s28, s19, 14
  s_add_u32 s8, s10, s28
  s_addc_u32 s9, s11, 0
  global_store_dwordx2 v9, v[116:117], s[8:9]
  s_barrier

  s_add_u32 s19, s19, 5
  s_cmp_lt_u32 s19, 128
  s_cbranch_scc1 mega_kernel_w4_tl
  s_branch mega_kernel_end
mega_kernel_rWO:
  s_sub_u32 s26, s17, 96
  s_mul_hi_u32 s20, s26, 1073741825
  s_mul_i32 s27, s20, 4
  s_sub_u32 s22, s26, s27
  s_lshr_b32 s21, s20, 3
  s_and_b32 s20, s20, 7
  s_load_dwordx2 s[4:5], s[0:1], 40
  s_lshl_b32 s26, s21, 21
  s_lshl_b32 s27, s18, 19
  s_add_u32 s26, s26, s27
  s_lshl_b32 s27, s20, 7
  s_add_u32 s26, s26, s27
  s_lshl_b32 s23, s21, 16
  s_lshl_b32 s27, s18, 14
  s_add_u32 s23, s23, s27

  s_waitcnt lgkmcnt(0)
  s_add_u32 s4, s4, s26
  s_addc_u32 s5, s5, 0
  v_lshrrev_b32 v5, 3, v0
  v_mov_b32 v6, 1024
  v_mul_lo_u32 v5, v5, v6
  v_and_b32 v6, 7, v0
  v_lshl_add_u32 v2, v6, 4, v5
  v_and_b32 v5, 15, v0
  v_lshrrev_b32 v6, 4, v0
  v_lshrrev_b32 v7, 2, v5
  v_lshl_add_u32 v7, v6, 3, v7
  v_mul_u32_u24 v7, 128, v7
  v_and_b32 v5, 3, v5
  v_lshl_add_u32 v7, v5, 4, v7
  s_mul_i32 s24, s18, 40960
  s_add_u32 s24, s24, 0
  v_add_u32 v3, s24, v7

  s_add_u32 s8, s4, 0
  s_addc_u32 s9, s5, 0
  s_add_u32 m0, s24, 0
  s_nop 0
  global_load_lds_dwordx4 v2, s[8:9]

  s_add_u32 s8, s4, 8192
  s_addc_u32 s9, s5, 0
  s_add_u32 m0, s24, 1024
  s_nop 0
  global_load_lds_dwordx4 v2, s[8:9]

  s_add_u32 s8, s4, 16384
  s_addc_u32 s9, s5, 0
  s_add_u32 m0, s24, 2048
  s_nop 0
  global_load_lds_dwordx4 v2, s[8:9]

  s_add_u32 s8, s4, 24576
  s_addc_u32 s9, s5, 0
  s_add_u32 m0, s24, 3072
  s_nop 0
  global_load_lds_dwordx4 v2, s[8:9]

  s_add_u32 s8, s4, 32768
  s_addc_u32 s9, s5, 0
  s_add_u32 m0, s24, 4096
  s_nop 0
  global_load_lds_dwordx4 v2, s[8:9]

  s_add_u32 s8, s4, 40960
  s_addc_u32 s9, s5, 0
  s_add_u32 m0, s24, 5120
  s_nop 0
  global_load_lds_dwordx4 v2, s[8:9]

  s_add_u32 s8, s4, 49152
  s_addc_u32 s9, s5, 0
  s_add_u32 m0, s24, 6144
  s_nop 0
  global_load_lds_dwordx4 v2, s[8:9]

  s_add_u32 s8, s4, 57344
  s_addc_u32 s9, s5, 0
  s_add_u32 m0, s24, 7168
  s_nop 0
  global_load_lds_dwordx4 v2, s[8:9]

  s_add_u32 s8, s4, 65536
  s_addc_u32 s9, s5, 0
  s_add_u32 m0, s24, 8192
  s_nop 0
  global_load_lds_dwordx4 v2, s[8:9]

  s_add_u32 s8, s4, 73728
  s_addc_u32 s9, s5, 0
  s_add_u32 m0, s24, 9216
  s_nop 0
  global_load_lds_dwordx4 v2, s[8:9]

  s_add_u32 s8, s4, 81920
  s_addc_u32 s9, s5, 0
  s_add_u32 m0, s24, 10240
  s_nop 0
  global_load_lds_dwordx4 v2, s[8:9]

  s_add_u32 s8, s4, 90112
  s_addc_u32 s9, s5, 0
  s_add_u32 m0, s24, 11264
  s_nop 0
  global_load_lds_dwordx4 v2, s[8:9]

  s_add_u32 s8, s4, 98304
  s_addc_u32 s9, s5, 0
  s_add_u32 m0, s24, 12288
  s_nop 0
  global_load_lds_dwordx4 v2, s[8:9]

  s_add_u32 s8, s4, 106496
  s_addc_u32 s9, s5, 0
  s_add_u32 m0, s24, 13312
  s_nop 0
  global_load_lds_dwordx4 v2, s[8:9]

  s_add_u32 s8, s4, 114688
  s_addc_u32 s9, s5, 0
  s_add_u32 m0, s24, 14336
  s_nop 0
  global_load_lds_dwordx4 v2, s[8:9]

  s_add_u32 s8, s4, 122880
  s_addc_u32 s9, s5, 0
  s_add_u32 m0, s24, 15360
  s_nop 0
  global_load_lds_dwordx4 v2, s[8:9]

  s_add_u32 s8, s4, 131072
  s_addc_u32 s9, s5, 0
  s_add_u32 m0, s24, 16384
  s_nop 0
  global_load_lds_dwordx4 v2, s[8:9]

  s_add_u32 s8, s4, 139264
  s_addc_u32 s9, s5, 0
  s_add_u32 m0, s24, 17408
  s_nop 0
  global_load_lds_dwordx4 v2, s[8:9]

  s_add_u32 s8, s4, 147456
  s_addc_u32 s9, s5, 0
  s_add_u32 m0, s24, 18432
  s_nop 0
  global_load_lds_dwordx4 v2, s[8:9]

  s_add_u32 s8, s4, 155648
  s_addc_u32 s9, s5, 0
  s_add_u32 m0, s24, 19456
  s_nop 0
  global_load_lds_dwordx4 v2, s[8:9]

  s_add_u32 s8, s4, 163840
  s_addc_u32 s9, s5, 0
  s_add_u32 m0, s24, 20480
  s_nop 0
  global_load_lds_dwordx4 v2, s[8:9]

  s_add_u32 s8, s4, 172032
  s_addc_u32 s9, s5, 0
  s_add_u32 m0, s24, 21504
  s_nop 0
  global_load_lds_dwordx4 v2, s[8:9]

  s_add_u32 s8, s4, 180224
  s_addc_u32 s9, s5, 0
  s_add_u32 m0, s24, 22528
  s_nop 0
  global_load_lds_dwordx4 v2, s[8:9]

  s_add_u32 s8, s4, 188416
  s_addc_u32 s9, s5, 0
  s_add_u32 m0, s24, 23552
  s_nop 0
  global_load_lds_dwordx4 v2, s[8:9]

  s_add_u32 s8, s4, 196608
  s_addc_u32 s9, s5, 0
  s_add_u32 m0, s24, 24576
  s_nop 0
  global_load_lds_dwordx4 v2, s[8:9]

  s_add_u32 s8, s4, 204800
  s_addc_u32 s9, s5, 0
  s_add_u32 m0, s24, 25600
  s_nop 0
  global_load_lds_dwordx4 v2, s[8:9]

  s_add_u32 s8, s4, 212992
  s_addc_u32 s9, s5, 0
  s_add_u32 m0, s24, 26624
  s_nop 0
  global_load_lds_dwordx4 v2, s[8:9]

  s_add_u32 s8, s4, 221184
  s_addc_u32 s9, s5, 0
  s_add_u32 m0, s24, 27648
  s_nop 0
  global_load_lds_dwordx4 v2, s[8:9]

  s_add_u32 s8, s4, 229376
  s_addc_u32 s9, s5, 0
  s_add_u32 m0, s24, 28672
  s_nop 0
  global_load_lds_dwordx4 v2, s[8:9]

  s_add_u32 s8, s4, 237568
  s_addc_u32 s9, s5, 0
  s_add_u32 m0, s24, 29696
  s_nop 0
  global_load_lds_dwordx4 v2, s[8:9]

  s_add_u32 s8, s4, 245760
  s_addc_u32 s9, s5, 0
  s_add_u32 m0, s24, 30720
  s_nop 0
  global_load_lds_dwordx4 v2, s[8:9]

  s_add_u32 s8, s4, 253952
  s_addc_u32 s9, s5, 0
  s_add_u32 m0, s24, 31744
  s_nop 0
  global_load_lds_dwordx4 v2, s[8:9]

  s_add_u32 s8, s4, 262144
  s_addc_u32 s9, s5, 0
  s_add_u32 m0, s24, 32768
  s_nop 0
  global_load_lds_dwordx4 v2, s[8:9]

  s_add_u32 s8, s4, 270336
  s_addc_u32 s9, s5, 0
  s_add_u32 m0, s24, 33792
  s_nop 0
  global_load_lds_dwordx4 v2, s[8:9]

  s_add_u32 s8, s4, 278528
  s_addc_u32 s9, s5, 0
  s_add_u32 m0, s24, 34816
  s_nop 0
  global_load_lds_dwordx4 v2, s[8:9]

  s_add_u32 s8, s4, 286720
  s_addc_u32 s9, s5, 0
  s_add_u32 m0, s24, 35840
  s_nop 0
  global_load_lds_dwordx4 v2, s[8:9]

  s_add_u32 s8, s4, 294912
  s_addc_u32 s9, s5, 0
  s_add_u32 m0, s24, 36864
  s_nop 0
  global_load_lds_dwordx4 v2, s[8:9]

  s_add_u32 s8, s4, 303104
  s_addc_u32 s9, s5, 0
  s_add_u32 m0, s24, 37888
  s_nop 0
  global_load_lds_dwordx4 v2, s[8:9]

  s_add_u32 s8, s4, 311296
  s_addc_u32 s9, s5, 0
  s_add_u32 m0, s24, 38912
  s_nop 0
  global_load_lds_dwordx4 v2, s[8:9]

  s_add_u32 s8, s4, 319488
  s_addc_u32 s9, s5, 0
  s_add_u32 m0, s24, 39936
  s_nop 0
  global_load_lds_dwordx4 v2, s[8:9]

  s_waitcnt vmcnt(36)
  ds_read_b64_tr_b16 a[0:1], v3 offset:0
  ds_read_b64_tr_b16 a[2:3], v3 offset:512
  ds_read_b64_tr_b16 a[4:5], v3 offset:8
  ds_read_b64_tr_b16 a[6:7], v3 offset:520
  ds_read_b64_tr_b16 a[8:9], v3 offset:64
  ds_read_b64_tr_b16 a[10:11], v3 offset:576
  ds_read_b64_tr_b16 a[12:13], v3 offset:72
  ds_read_b64_tr_b16 a[14:15], v3 offset:584
  s_waitcnt lgkmcnt(0)

  s_add_u32 s8, s4, 327680
  s_addc_u32 s9, s5, 0
  s_add_u32 m0, s24, 0
  s_nop 0
  global_load_lds_dwordx4 v2, s[8:9]

  s_add_u32 s8, s4, 335872
  s_addc_u32 s9, s5, 0
  s_add_u32 m0, s24, 1024
  s_nop 0
  global_load_lds_dwordx4 v2, s[8:9]

  s_add_u32 s8, s4, 344064
  s_addc_u32 s9, s5, 0
  s_add_u32 m0, s24, 2048
  s_nop 0
  global_load_lds_dwordx4 v2, s[8:9]

  s_add_u32 s8, s4, 352256
  s_addc_u32 s9, s5, 0
  s_add_u32 m0, s24, 3072
  s_nop 0
  global_load_lds_dwordx4 v2, s[8:9]

  s_waitcnt vmcnt(36)
  ds_read_b64_tr_b16 a[16:17], v3 offset:4096
  ds_read_b64_tr_b16 a[18:19], v3 offset:4608
  ds_read_b64_tr_b16 a[20:21], v3 offset:4104
  ds_read_b64_tr_b16 a[22:23], v3 offset:4616
  ds_read_b64_tr_b16 a[24:25], v3 offset:4160
  ds_read_b64_tr_b16 a[26:27], v3 offset:4672
  ds_read_b64_tr_b16 a[28:29], v3 offset:4168
  ds_read_b64_tr_b16 a[30:31], v3 offset:4680
  s_waitcnt lgkmcnt(0)

  s_add_u32 s8, s4, 360448
  s_addc_u32 s9, s5, 0
  s_add_u32 m0, s24, 4096
  s_nop 0
  global_load_lds_dwordx4 v2, s[8:9]

  s_add_u32 s8, s4, 368640
  s_addc_u32 s9, s5, 0
  s_add_u32 m0, s24, 5120
  s_nop 0
  global_load_lds_dwordx4 v2, s[8:9]

  s_add_u32 s8, s4, 376832
  s_addc_u32 s9, s5, 0
  s_add_u32 m0, s24, 6144
  s_nop 0
  global_load_lds_dwordx4 v2, s[8:9]

  s_add_u32 s8, s4, 385024
  s_addc_u32 s9, s5, 0
  s_add_u32 m0, s24, 7168
  s_nop 0
  global_load_lds_dwordx4 v2, s[8:9]

  s_waitcnt vmcnt(36)
  ds_read_b64_tr_b16 a[32:33], v3 offset:8192
  ds_read_b64_tr_b16 a[34:35], v3 offset:8704
  ds_read_b64_tr_b16 a[36:37], v3 offset:8200
  ds_read_b64_tr_b16 a[38:39], v3 offset:8712
  ds_read_b64_tr_b16 a[40:41], v3 offset:8256
  ds_read_b64_tr_b16 a[42:43], v3 offset:8768
  ds_read_b64_tr_b16 a[44:45], v3 offset:8264
  ds_read_b64_tr_b16 a[46:47], v3 offset:8776
  s_waitcnt lgkmcnt(0)

  s_add_u32 s8, s4, 393216
  s_addc_u32 s9, s5, 0
  s_add_u32 m0, s24, 8192
  s_nop 0
  global_load_lds_dwordx4 v2, s[8:9]

  s_add_u32 s8, s4, 401408
  s_addc_u32 s9, s5, 0
  s_add_u32 m0, s24, 9216
  s_nop 0
  global_load_lds_dwordx4 v2, s[8:9]

  s_add_u32 s8, s4, 409600
  s_addc_u32 s9, s5, 0
  s_add_u32 m0, s24, 10240
  s_nop 0
  global_load_lds_dwordx4 v2, s[8:9]

  s_add_u32 s8, s4, 417792
  s_addc_u32 s9, s5, 0
  s_add_u32 m0, s24, 11264
  s_nop 0
  global_load_lds_dwordx4 v2, s[8:9]

  s_waitcnt vmcnt(36)
  ds_read_b64_tr_b16 a[48:49], v3 offset:12288
  ds_read_b64_tr_b16 a[50:51], v3 offset:12800
  ds_read_b64_tr_b16 a[52:53], v3 offset:12296
  ds_read_b64_tr_b16 a[54:55], v3 offset:12808
  ds_read_b64_tr_b16 a[56:57], v3 offset:12352
  ds_read_b64_tr_b16 a[58:59], v3 offset:12864
  ds_read_b64_tr_b16 a[60:61], v3 offset:12360
  ds_read_b64_tr_b16 a[62:63], v3 offset:12872
  s_waitcnt lgkmcnt(0)

  s_add_u32 s8, s4, 425984
  s_addc_u32 s9, s5, 0
  s_add_u32 m0, s24, 12288
  s_nop 0
  global_load_lds_dwordx4 v2, s[8:9]

  s_add_u32 s8, s4, 434176
  s_addc_u32 s9, s5, 0
  s_add_u32 m0, s24, 13312
  s_nop 0
  global_load_lds_dwordx4 v2, s[8:9]

  s_add_u32 s8, s4, 442368
  s_addc_u32 s9, s5, 0
  s_add_u32 m0, s24, 14336
  s_nop 0
  global_load_lds_dwordx4 v2, s[8:9]

  s_add_u32 s8, s4, 450560
  s_addc_u32 s9, s5, 0
  s_add_u32 m0, s24, 15360
  s_nop 0
  global_load_lds_dwordx4 v2, s[8:9]

  s_waitcnt vmcnt(36)
  ds_read_b64_tr_b16 a[64:65], v3 offset:16384
  ds_read_b64_tr_b16 a[66:67], v3 offset:16896
  ds_read_b64_tr_b16 a[68:69], v3 offset:16392
  ds_read_b64_tr_b16 a[70:71], v3 offset:16904
  ds_read_b64_tr_b16 a[72:73], v3 offset:16448
  ds_read_b64_tr_b16 a[74:75], v3 offset:16960
  ds_read_b64_tr_b16 a[76:77], v3 offset:16456
  ds_read_b64_tr_b16 a[78:79], v3 offset:16968
  s_waitcnt lgkmcnt(0)

  s_add_u32 s8, s4, 458752
  s_addc_u32 s9, s5, 0
  s_add_u32 m0, s24, 16384
  s_nop 0
  global_load_lds_dwordx4 v2, s[8:9]

  s_add_u32 s8, s4, 466944
  s_addc_u32 s9, s5, 0
  s_add_u32 m0, s24, 17408
  s_nop 0
  global_load_lds_dwordx4 v2, s[8:9]

  s_add_u32 s8, s4, 475136
  s_addc_u32 s9, s5, 0
  s_add_u32 m0, s24, 18432
  s_nop 0
  global_load_lds_dwordx4 v2, s[8:9]

  s_add_u32 s8, s4, 483328
  s_addc_u32 s9, s5, 0
  s_add_u32 m0, s24, 19456
  s_nop 0
  global_load_lds_dwordx4 v2, s[8:9]

  s_waitcnt vmcnt(36)
  ds_read_b64_tr_b16 a[80:81], v3 offset:20480
  ds_read_b64_tr_b16 a[82:83], v3 offset:20992
  ds_read_b64_tr_b16 a[84:85], v3 offset:20488
  ds_read_b64_tr_b16 a[86:87], v3 offset:21000
  ds_read_b64_tr_b16 a[88:89], v3 offset:20544
  ds_read_b64_tr_b16 a[90:91], v3 offset:21056
  ds_read_b64_tr_b16 a[92:93], v3 offset:20552
  ds_read_b64_tr_b16 a[94:95], v3 offset:21064
  s_waitcnt lgkmcnt(0)

  s_add_u32 s8, s4, 491520
  s_addc_u32 s9, s5, 0
  s_add_u32 m0, s24, 20480
  s_nop 0
  global_load_lds_dwordx4 v2, s[8:9]

  s_add_u32 s8, s4, 499712
  s_addc_u32 s9, s5, 0
  s_add_u32 m0, s24, 21504
  s_nop 0
  global_load_lds_dwordx4 v2, s[8:9]

  s_add_u32 s8, s4, 507904
  s_addc_u32 s9, s5, 0
  s_add_u32 m0, s24, 22528
  s_nop 0
  global_load_lds_dwordx4 v2, s[8:9]

  s_add_u32 s8, s4, 516096
  s_addc_u32 s9, s5, 0
  s_add_u32 m0, s24, 23552
  s_nop 0
  global_load_lds_dwordx4 v2, s[8:9]

  s_waitcnt vmcnt(36)
  ds_read_b64_tr_b16 a[96:97], v3 offset:24576
  ds_read_b64_tr_b16 a[98:99], v3 offset:25088
  ds_read_b64_tr_b16 a[100:101], v3 offset:24584
  ds_read_b64_tr_b16 a[102:103], v3 offset:25096
  ds_read_b64_tr_b16 a[104:105], v3 offset:24640
  ds_read_b64_tr_b16 a[106:107], v3 offset:25152
  ds_read_b64_tr_b16 a[108:109], v3 offset:24648
  ds_read_b64_tr_b16 a[110:111], v3 offset:25160
  s_waitcnt vmcnt(32)
  ds_read_b64_tr_b16 a[112:113], v3 offset:28672
  ds_read_b64_tr_b16 a[114:115], v3 offset:29184
  ds_read_b64_tr_b16 a[116:117], v3 offset:28680
  ds_read_b64_tr_b16 a[118:119], v3 offset:29192
  ds_read_b64_tr_b16 a[120:121], v3 offset:28736
  ds_read_b64_tr_b16 a[122:123], v3 offset:29248
  ds_read_b64_tr_b16 a[124:125], v3 offset:28744
  ds_read_b64_tr_b16 a[126:127], v3 offset:29256
  s_waitcnt vmcnt(28)
  ds_read_b64_tr_b16 a[128:129], v3 offset:32768
  ds_read_b64_tr_b16 a[130:131], v3 offset:33280
  ds_read_b64_tr_b16 a[132:133], v3 offset:32776
  ds_read_b64_tr_b16 a[134:135], v3 offset:33288
  ds_read_b64_tr_b16 a[136:137], v3 offset:32832
  ds_read_b64_tr_b16 a[138:139], v3 offset:33344
  ds_read_b64_tr_b16 a[140:141], v3 offset:32840
  ds_read_b64_tr_b16 a[142:143], v3 offset:33352
  s_waitcnt vmcnt(24)
  ds_read_b64_tr_b16 a[144:145], v3 offset:36864
  ds_read_b64_tr_b16 a[146:147], v3 offset:37376
  ds_read_b64_tr_b16 a[148:149], v3 offset:36872
  ds_read_b64_tr_b16 a[150:151], v3 offset:37384
  ds_read_b64_tr_b16 a[152:153], v3 offset:36928
  ds_read_b64_tr_b16 a[154:155], v3 offset:37440
  ds_read_b64_tr_b16 a[156:157], v3 offset:36936
  ds_read_b64_tr_b16 a[158:159], v3 offset:37448
  s_waitcnt vmcnt(20)
  ds_read_b64_tr_b16 a[160:161], v3 offset:0
  ds_read_b64_tr_b16 a[162:163], v3 offset:512
  ds_read_b64_tr_b16 a[164:165], v3 offset:8
  ds_read_b64_tr_b16 a[166:167], v3 offset:520
  ds_read_b64_tr_b16 a[168:169], v3 offset:64
  ds_read_b64_tr_b16 a[170:171], v3 offset:576
  ds_read_b64_tr_b16 a[172:173], v3 offset:72
  ds_read_b64_tr_b16 a[174:175], v3 offset:584
  s_waitcnt vmcnt(16)
  ds_read_b64_tr_b16 a[176:177], v3 offset:4096
  ds_read_b64_tr_b16 a[178:179], v3 offset:4608
  ds_read_b64_tr_b16 a[180:181], v3 offset:4104
  ds_read_b64_tr_b16 a[182:183], v3 offset:4616
  ds_read_b64_tr_b16 a[184:185], v3 offset:4160
  ds_read_b64_tr_b16 a[186:187], v3 offset:4672
  ds_read_b64_tr_b16 a[188:189], v3 offset:4168
  ds_read_b64_tr_b16 a[190:191], v3 offset:4680
  s_waitcnt vmcnt(12)
  ds_read_b64_tr_b16 a[192:193], v3 offset:8192
  ds_read_b64_tr_b16 a[194:195], v3 offset:8704
  ds_read_b64_tr_b16 a[196:197], v3 offset:8200
  ds_read_b64_tr_b16 a[198:199], v3 offset:8712
  ds_read_b64_tr_b16 a[200:201], v3 offset:8256
  ds_read_b64_tr_b16 a[202:203], v3 offset:8768
  ds_read_b64_tr_b16 a[204:205], v3 offset:8264
  ds_read_b64_tr_b16 a[206:207], v3 offset:8776
  s_waitcnt vmcnt(8)
  ds_read_b64_tr_b16 a[208:209], v3 offset:12288
  ds_read_b64_tr_b16 a[210:211], v3 offset:12800
  ds_read_b64_tr_b16 a[212:213], v3 offset:12296
  ds_read_b64_tr_b16 a[214:215], v3 offset:12808
  ds_read_b64_tr_b16 a[216:217], v3 offset:12352
  ds_read_b64_tr_b16 a[218:219], v3 offset:12864
  ds_read_b64_tr_b16 a[220:221], v3 offset:12360
  ds_read_b64_tr_b16 a[222:223], v3 offset:12872
  s_waitcnt vmcnt(4)
  ds_read_b64_tr_b16 a[224:225], v3 offset:16384
  ds_read_b64_tr_b16 a[226:227], v3 offset:16896
  ds_read_b64_tr_b16 a[228:229], v3 offset:16392
  ds_read_b64_tr_b16 a[230:231], v3 offset:16904
  ds_read_b64_tr_b16 a[232:233], v3 offset:16448
  ds_read_b64_tr_b16 a[234:235], v3 offset:16960
  ds_read_b64_tr_b16 a[236:237], v3 offset:16456
  ds_read_b64_tr_b16 a[238:239], v3 offset:16968
  s_waitcnt vmcnt(0)
  ds_read_b64_tr_b16 a[240:241], v3 offset:20480
  ds_read_b64_tr_b16 a[242:243], v3 offset:20992
  ds_read_b64_tr_b16 a[244:245], v3 offset:20488
  ds_read_b64_tr_b16 a[246:247], v3 offset:21000
  ds_read_b64_tr_b16 a[248:249], v3 offset:20544
  ds_read_b64_tr_b16 a[250:251], v3 offset:21056
  ds_read_b64_tr_b16 a[252:253], v3 offset:20552
  ds_read_b64_tr_b16 a[254:255], v3 offset:21064
  s_waitcnt lgkmcnt(0)
  s_barrier
  s_lshl_b32 s25, s20, 2
  s_add_u32 s25, s25, s18
  s_lshl_b32 s26, s18, 12
  v_add_u32 v6, s26, v1
  s_lshl_b32 s26, s18, 10
  v_add_u32 v7, s26, v1
  v_add_u32 v4, 4096, v1
  v_add_u32 v5, 8192, v1
  v_add_u32 v8, 12288, v1

  s_mov_b32 s19, s22
  s_mov_b32 s38, 0
mega_kernel_wo_tl:
  s_lshr_b32 s28, s19, 1
  s_lshl_b32 s28, s28, 7
  s_add_u32 s28, s28, 8192
  s_mov_b32 s37, 8
  s_cmp_ge_u32 s19, 124
  s_cselect_b32 s36, 16, 0
  s_add_u32 s28, s28, s36
  v_mov_b32 v2, s28
  s_mov_b32 s27, 0
mega_kernel_pl_10:
  global_load_dword v3, v2, s[14:15] sc1
  s_add_u32 s27, s27, 1
  s_cmp_gt_u32 s27, 50000000
  s_cbranch_scc1 mega_kernel_fail
  s_waitcnt vmcnt(0)
  v_readfirstlane_b32 s26, v3
  s_nop 3
  s_cmp_ge_u32 s26, s37
  s_cbranch_scc1 mega_kernel_pl_10_ok
  s_sleep 2
  s_branch mega_kernel_pl_10
mega_kernel_pl_10_ok:

mega_kernel_wo_st:
  s_lshl_b32 s28, s19, 17
  s_add_u32 s28, s28, s23
  s_add_u32 s27, s28, 67108864
  s_add_u32 s6, s12, s27
  s_addc_u32 s7, s13, 0
  global_load_dwordx4 v[32:35], v1, s[6:7] offset:0 sc1
  global_load_dwordx4 v[36:39], v1, s[6:7] offset:1024 sc1
  global_load_dwordx4 v[40:43], v1, s[6:7] offset:2048 sc1
  global_load_dwordx4 v[44:47], v1, s[6:7] offset:3072 sc1
  global_load_dwordx4 v[48:51], v4, s[6:7] offset:0 sc1
  global_load_dwordx4 v[52:55], v4, s[6:7] offset:1024 sc1
  global_load_dwordx4 v[56:59], v4, s[6:7] offset:2048 sc1
  global_load_dwordx4 v[60:63], v4, s[6:7] offset:3072 sc1
  global_load_dwordx4 v[64:67], v5, s[6:7] offset:0 sc1
  global_load_dwordx4 v[68:71], v5, s[6:7] offset:1024 sc1
  global_load_dwordx4 v[72:75], v5, s[6:7] offset:2048 sc1
  global_load_dwordx4 v[76:79], v5, s[6:7] offset:3072 sc1
  global_load_dwordx4 v[80:83], v8, s[6:7] offset:0 sc1
  global_load_dwordx4 v[84:87], v8, s[6:7] offset:1024 sc1
  global_load_dwordx4 v[88:91], v8, s[6:7] offset:2048 sc1
  global_load_dwordx4 v[92:95], v8, s[6:7] offset:3072 sc1
  s_waitcnt vmcnt(15)
  v_mfma_f32_16x16x32_bf16 v[96:99], a[0:3], v[32:35], 0
  v_mfma_f32_16x16x32_bf16 v[100:103], a[4:7], v[32:35], 0
  v_mfma_f32_16x16x32_bf16 v[104:107], a[8:11], v[32:35], 0
  v_mfma_f32_16x16x32_bf16 v[108:111], a[12:15], v[32:35], 0
  s_waitcnt vmcnt(14)
  v_mfma_f32_16x16x32_bf16 v[96:99], a[16:19], v[36:39], v[96:99]
  v_mfma_f32_16x16x32_bf16 v[100:103], a[20:23], v[36:39], v[100:103]
  v_mfma_f32_16x16x32_bf16 v[104:107], a[24:27], v[36:39], v[104:107]
  v_mfma_f32_16x16x32_bf16 v[108:111], a[28:31], v[36:39], v[108:111]
  s_waitcnt vmcnt(13)
  v_mfma_f32_16x16x32_bf16 v[96:99], a[32:35], v[40:43], v[96:99]
  v_mfma_f32_16x16x32_bf16 v[100:103], a[36:39], v[40:43], v[100:103]
  v_mfma_f32_16x16x32_bf16 v[104:107], a[40:43], v[40:43], v[104:107]
  v_mfma_f32_16x16x32_bf16 v[108:111], a[44:47], v[40:43], v[108:111]
  s_waitcnt vmcnt(12)
  v_mfma_f32_16x16x32_bf16 v[96:99], a[48:51], v[44:47], v[96:99]
  v_mfma_f32_16x16x32_bf16 v[100:103], a[52:55], v[44:47], v[100:103]
  v_mfma_f32_16x16x32_bf16 v[104:107], a[56:59], v[44:47], v[104:107]
  v_mfma_f32_16x16x32_bf16 v[108:111], a[60:63], v[44:47], v[108:111]
  s_waitcnt vmcnt(11)
  v_mfma_f32_16x16x32_bf16 v[96:99], a[64:67], v[48:51], v[96:99]
  v_mfma_f32_16x16x32_bf16 v[100:103], a[68:71], v[48:51], v[100:103]
  v_mfma_f32_16x16x32_bf16 v[104:107], a[72:75], v[48:51], v[104:107]
  v_mfma_f32_16x16x32_bf16 v[108:111], a[76:79], v[48:51], v[108:111]
  s_waitcnt vmcnt(10)
  v_mfma_f32_16x16x32_bf16 v[96:99], a[80:83], v[52:55], v[96:99]
  v_mfma_f32_16x16x32_bf16 v[100:103], a[84:87], v[52:55], v[100:103]
  v_mfma_f32_16x16x32_bf16 v[104:107], a[88:91], v[52:55], v[104:107]
  v_mfma_f32_16x16x32_bf16 v[108:111], a[92:95], v[52:55], v[108:111]
  s_waitcnt vmcnt(9)
  v_mfma_f32_16x16x32_bf16 v[96:99], a[96:99], v[56:59], v[96:99]
  v_mfma_f32_16x16x32_bf16 v[100:103], a[100:103], v[56:59], v[100:103]
  v_mfma_f32_16x16x32_bf16 v[104:107], a[104:107], v[56:59], v[104:107]
  v_mfma_f32_16x16x32_bf16 v[108:111], a[108:111], v[56:59], v[108:111]
  s_waitcnt vmcnt(8)
  v_mfma_f32_16x16x32_bf16 v[96:99], a[112:115], v[60:63], v[96:99]
  v_mfma_f32_16x16x32_bf16 v[100:103], a[116:119], v[60:63], v[100:103]
  v_mfma_f32_16x16x32_bf16 v[104:107], a[120:123], v[60:63], v[104:107]
  v_mfma_f32_16x16x32_bf16 v[108:111], a[124:127], v[60:63], v[108:111]
  s_waitcnt vmcnt(7)
  v_mfma_f32_16x16x32_bf16 v[96:99], a[128:131], v[64:67], v[96:99]
  v_mfma_f32_16x16x32_bf16 v[100:103], a[132:135], v[64:67], v[100:103]
  v_mfma_f32_16x16x32_bf16 v[104:107], a[136:139], v[64:67], v[104:107]
  v_mfma_f32_16x16x32_bf16 v[108:111], a[140:143], v[64:67], v[108:111]
  s_waitcnt vmcnt(6)
  v_mfma_f32_16x16x32_bf16 v[96:99], a[144:147], v[68:71], v[96:99]
  v_mfma_f32_16x16x32_bf16 v[100:103], a[148:151], v[68:71], v[100:103]
  v_mfma_f32_16x16x32_bf16 v[104:107], a[152:155], v[68:71], v[104:107]
  v_mfma_f32_16x16x32_bf16 v[108:111], a[156:159], v[68:71], v[108:111]
  s_waitcnt vmcnt(5)
  v_mfma_f32_16x16x32_bf16 v[96:99], a[160:163], v[72:75], v[96:99]
  v_mfma_f32_16x16x32_bf16 v[100:103], a[164:167], v[72:75], v[100:103]
  v_mfma_f32_16x16x32_bf16 v[104:107], a[168:171], v[72:75], v[104:107]
  v_mfma_f32_16x16x32_bf16 v[108:111], a[172:175], v[72:75], v[108:111]
  s_waitcnt vmcnt(4)
  v_mfma_f32_16x16x32_bf16 v[96:99], a[176:179], v[76:79], v[96:99]
  v_mfma_f32_16x16x32_bf16 v[100:103], a[180:183], v[76:79], v[100:103]
  v_mfma_f32_16x16x32_bf16 v[104:107], a[184:187], v[76:79], v[104:107]
  v_mfma_f32_16x16x32_bf16 v[108:111], a[188:191], v[76:79], v[108:111]
  s_waitcnt vmcnt(3)
  v_mfma_f32_16x16x32_bf16 v[96:99], a[192:195], v[80:83], v[96:99]
  v_mfma_f32_16x16x32_bf16 v[100:103], a[196:199], v[80:83], v[100:103]
  v_mfma_f32_16x16x32_bf16 v[104:107], a[200:203], v[80:83], v[104:107]
  v_mfma_f32_16x16x32_bf16 v[108:111], a[204:207], v[80:83], v[108:111]
  s_waitcnt vmcnt(2)
  v_mfma_f32_16x16x32_bf16 v[96:99], a[208:211], v[84:87], v[96:99]
  v_mfma_f32_16x16x32_bf16 v[100:103], a[212:215], v[84:87], v[100:103]
  v_mfma_f32_16x16x32_bf16 v[104:107], a[216:219], v[84:87], v[104:107]
  v_mfma_f32_16x16x32_bf16 v[108:111], a[220:223], v[84:87], v[108:111]
  s_waitcnt vmcnt(1)
  v_mfma_f32_16x16x32_bf16 v[96:99], a[224:227], v[88:91], v[96:99]
  v_mfma_f32_16x16x32_bf16 v[100:103], a[228:231], v[88:91], v[100:103]
  v_mfma_f32_16x16x32_bf16 v[104:107], a[232:235], v[88:91], v[104:107]
  v_mfma_f32_16x16x32_bf16 v[108:111], a[236:239], v[88:91], v[108:111]
  s_waitcnt vmcnt(0)
  v_mfma_f32_16x16x32_bf16 v[96:99], a[240:243], v[92:95], v[96:99]
  v_mfma_f32_16x16x32_bf16 v[100:103], a[244:247], v[92:95], v[100:103]
  v_mfma_f32_16x16x32_bf16 v[104:107], a[248:251], v[92:95], v[104:107]
  v_mfma_f32_16x16x32_bf16 v[108:111], a[252:255], v[92:95], v[108:111]
  s_cmp_ge_u32 s19, 124
  s_cselect_b64 s[60:61], -1, 0
  v_max3_u32 v112, v32, v33, v34
  v_mov_b32 v113, v35
  v_max3_u32 v112, v112, v36, v37
  v_max3_u32 v113, v113, v38, v39
  v_max3_u32 v112, v112, v40, v41
  v_max3_u32 v113, v113, v42, v43
  v_max3_u32 v112, v112, v44, v45
  v_max3_u32 v113, v113, v46, v47
  v_max3_u32 v112, v112, v48, v49
  v_max3_u32 v113, v113, v50, v51
  v_max3_u32 v112, v112, v52, v53
  v_max3_u32 v113, v113, v54, v55
  v_max3_u32 v112, v112, v56, v57
  v_max3_u32 v113, v113, v58, v59
  v_max3_u32 v112, v112, v60, v61
  v_max3_u32 v113, v113, v62, v63
  v_max3_u32 v112, v112, v64, v65
  v_max3_u32 v113, v113, v66, v67
  v_max3_u32 v112, v112, v68, v69
  v_max3_u32 v113, v113, v70, v71
  v_max3_u32 v112, v112, v72, v73
  v_max3_u32 v113, v113, v74, v75
  v_max3_u32 v112, v112, v76, v77
  v_max3_u32 v113, v113, v78, v79
  v_max3_u32 v112, v112, v80, v81
  v_max3_u32 v113, v113, v82, v83
  v_max3_u32 v112, v112, v84, v85
  v_max3_u32 v113, v113, v86, v87
  v_max3_u32 v112, v112, v88, v89
  v_max3_u32 v113, v113, v90, v91
  v_max3_u32 v112, v112, v92, v93
  v_max3_u32 v113, v113, v94, v95
  v_max_u32 v112, v112, v113
  s_add_u32 s38, s38, 1
  s_cmp_gt_u32 s38, 50000000
  s_cbranch_scc1 mega_kernel_fail
  v_cmp_eq_u32 vcc, -1, v112
  s_nop 3
  s_and_b64 vcc, vcc, s[60:61]
  s_cbranch_vccnz mega_kernel_wo_st

  ds_write_b128 v6, v[96:99] offset:0
  ds_write_b128 v6, v[100:103] offset:1024
  ds_write_b128 v6, v[104:107] offset:2048
  ds_write_b128 v6, v[108:111] offset:3072
  s_waitcnt lgkmcnt(0)
  s_barrier
  ds_read_b128 v[112:115], v7 offset:0
  ds_read_b128 v[116:119], v7 offset:4096
  ds_read_b128 v[120:123], v7 offset:8192
  ds_read_b128 v[124:127], v7 offset:12288
  s_waitcnt lgkmcnt(2)
  v_pk_add_f32 v[112:113], v[112:113], v[116:117]
  v_pk_add_f32 v[114:115], v[114:115], v[118:119]
  s_waitcnt lgkmcnt(0)
  v_pk_add_f32 v[120:121], v[120:121], v[124:125]
  v_pk_add_f32 v[122:123], v[122:123], v[126:127]
  v_pk_add_f32 v[112:113], v[112:113], v[120:121]
  v_pk_add_f32 v[114:115], v[114:115], v[122:123]

  s_lshl_b32 s28, s19, 15
  s_lshl_b32 s29, s25, 10
  s_add_u32 s28, s28, s29
  s_lshl_b32 s29, s21, 22
  s_add_u32 s28, s28, s29
  s_add_u32 s27, s28, 150994944
  s_add_u32 s8, s12, s27
  s_addc_u32 s9, s13, 0
  global_store_dwordx4 v1, v[112:115], s[8:9] sc1
  s_cmp_eq_u32 s18, 0
  s_cbranch_scc0 mega_kernel_ht_11
  s_lshl_b32 s60, s19, 7
  s_add_u32 s60, s60, 24592
  v_mov_b32 v2, s60
  v_mov_b32 v3, 1
  v_cmp_eq_u32 vcc, 0, v0
  s_and_saveexec_b64 s[62:63], vcc
  global_atomic_add v2, v3, s[14:15]
  s_mov_b64 exec, s[62:63]
mega_kernel_ht_11:

  s_lshl_b32 s28, s19, 7
  s_add_u32 s28, s28, 24576
  s_waitcnt vmcnt(0)
  s_barrier
  s_cmp_eq_u32 s18, 0
  s_cbranch_scc0 mega_kernel_sg_12
  v_mov_b32 v2, s28
  v_mov_b32 v3, 1
  v_cmp_eq_u32 vcc, 0, v0
  s_and_saveexec_b64 s[62:63], vcc
  global_atomic_add v2, v3, s[14:15]

  s_mov_b64 exec, s[62:63]
mega_kernel_sg_12:

  s_add_u32 s19, s19, 4
  s_cmp_lt_u32 s19, 128
  s_cbranch_scc1 mega_kernel_wo_tl
  s_branch mega_kernel_end
mega_kernel_rAT:
  s_sub_u32 s26, s17, 160
  s_mul_hi_u32 s20, s26, 1431655766
  s_mul_i32 s27, s20, 3
  s_sub_u32 s22, s26, s27
  s_lshl_b32 s20, s20, 2
  s_add_u32 s20, s20, s18
  v_add_u32 v4, 4096, v1
  v_and_b32 v5, 15, v0
  v_lshrrev_b32 v6, 4, v0
  s_lshl_b32 s23, s18, 12
  v_lshlrev_b32 v7, 5, v5
  v_lshl_add_u32 v7, v6, 3, v7
  v_add_u32 v11, s23, v7
  v_lshrrev_b32 v7, 2, v5
  v_lshl_add_u32 v7, v6, 3, v7
  v_lshlrev_b32 v7, 5, v7
  v_and_b32 v196, 3, v5
  v_lshl_add_u32 v7, v196, 3, v7
  v_add_u32 v10, s23, v7
  v_mov_b32 v161, 0
  v_mov_b32 v163, 0
  v_mov_b32 v166, 0
  v_mov_b32 v167, 0
  v_lshlrev_b32 v6, 2, v6
  s_mov_b32 s24, 0x3e0293ee
  s_mov_b32 s25, 0xff7fffff
  s_mov_b32 s28, 1408

  s_cmp_eq_u32 s18, 0
  s_cbranch_scc0 mega_kernel_p1_13
  v_mov_b32 v2, s28
  s_mov_b32 s27, 0
mega_kernel_pl_14:
  global_load_dword v3, v2, s[14:15] sc1
  s_add_u32 s27, s27, 1
  s_cmp_gt_u32 s27, 50000000
  s_cbranch_scc1 mega_kernel_fail
  s_waitcnt vmcnt(0)
  v_readfirstlane_b32 s26, v3
  s_nop 3
  s_cmp_ge_u32 s26, 96
  s_cbranch_scc1 mega_kernel_pl_14_ok
  s_sleep 16
  s_branch mega_kernel_pl_14
mega_kernel_pl_14_ok:

mega_kernel_p1_13:
  s_barrier
  s_mov_b32 s28, 1280
  s_cmp_eq_u32 s18, 0
  s_cbranch_scc0 mega_kernel_p1_15
  v_mov_b32 v2, s28
  s_mov_b32 s27, 0
mega_kernel_pl_16:
  global_load_dword v3, v2, s[14:15] sc1
  s_add_u32 s27, s27, 1
  s_cmp_gt_u32 s27, 50000000
  s_cbranch_scc1 mega_kernel_fail
  s_waitcnt vmcnt(0)
  v_readfirstlane_b32 s26, v3
  s_nop 3
  s_cmp_ge_u32 s26, 224
  s_cbranch_scc1 mega_kernel_pl_16_ok
  s_sleep 16
  s_branch mega_kernel_pl_16
mega_kernel_pl_16_ok:

mega_kernel_p1_15:
  s_barrier
  s_mov_b32 s19, s22
  s_mov_b32 s38, 0
mega_kernel_at_tl:
  s_lshl_b32 s21, s20, 19
  s_lshl_b32 s28, s19, 13
  s_add_u32 s21, s21, s28
  s_add_u32 s27, s21, 35651584
  s_add_u32 s4, s12, s27
  s_addc_u32 s5, s13, 0
  global_load_dwordx4 v[12:15], v1, s[4:5] offset:0 sc1
  global_load_dwordx4 v[16:19], v1, s[4:5] offset:1024 sc1
  global_load_dwordx4 v[20:23], v1, s[4:5] offset:2048 sc1
  global_load_dwordx4 v[24:27], v1, s[4:5] offset:3072 sc1
  global_load_dwordx4 v[28:31], v4, s[4:5] offset:0 sc1
  global_load_dwordx4 v[32:35], v4, s[4:5] offset:1024 sc1
  global_load_dwordx4 v[36:39], v4, s[4:5] offset:2048 sc1
  global_load_dwordx4 v[40:43], v4, s[4:5] offset:3072 sc1
  s_add_u32 s27, s21, 2097152
  s_add_u32 s4, s12, s27
  s_addc_u32 s5, s13, 0
  global_load_dwordx4 v[44:47], v1, s[4:5] offset:0 sc1
  global_load_dwordx4 v[48:51], v1, s[4:5] offset:1024 sc1
  global_load_dwordx4 v[52:55], v1, s[4:5] offset:2048 sc1
  global_load_dwordx4 v[56:59], v1, s[4:5] offset:3072 sc1
  global_load_dwordx4 v[60:63], v4, s[4:5] offset:0 sc1
  global_load_dwordx4 v[64:67], v4, s[4:5] offset:1024 sc1
  global_load_dwordx4 v[68:71], v4, s[4:5] offset:2048 sc1
  global_load_dwordx4 v[72:75], v4, s[4:5] offset:3072 sc1
  s_add_u32 s27, s21, 18874368
  s_add_u32 s4, s12, s27
  s_addc_u32 s5, s13, 0
  global_load_dwordx4 v[76:79], v1, s[4:5] offset:0 sc1
  global_load_dwordx4 v[80:83], v1, s[4:5] offset:1024 sc1
  global_load_dwordx4 v[84:87], v1, s[4:5] offset:2048 sc1
  global_load_dwordx4 v[88:91], v1, s[4:5] offset:3072 sc1
  global_load_dwordx4 v[92:95], v4, s[4:5] offset:0 sc1
  global_load_dwordx4 v[96:99], v4, s[4:5] offset:1024 sc1
  global_load_dwordx4 v[100:103], v4, s[4:5] offset:2048 sc1
  global_load_dwordx4 v[104:107], v4, s[4:5] offset:3072 sc1
  s_lshl_b32 s28, s20, 7
  s_add_u32 s28, s28, 2048
  s_add_u32 s29, s19, 1
  s_sub_u32 s37, s19, 1
  s_cmp_ge_u32 s19, 52
  s_cselect_b32 s29, s37, s29
  v_mov_b32 v2, s28
  s_mov_b32 s27, 0
mega_kernel_pl_17:
  global_load_dword v3, v2, s[14:15] sc1
  s_add_u32 s27, s27, 1
  s_cmp_gt_u32 s27, 50000000
  s_cbranch_scc1 mega_kernel_fail
  s_waitcnt vmcnt(0)
  v_readfirstlane_b32 s26, v3
  s_nop 3
  s_cmp_ge_u32 s26, s29
  s_cbranch_scc1 mega_kernel_pl_17_ok
  s_sleep 2
  s_branch mega_kernel_pl_17
mega_kernel_pl_17_ok:

mega_kernel_at_st:
  s_lshl_b32 s28, s19, 5
  s_add_u32 s28, s28, s20
  s_lshl_b32 s28, s28, 12
  s_add_u32 s27, s28, 56623104
  s_add_u32 s4, s12, s27
  s_addc_u32 s5, s13, 0
  global_load_dwordx4 v[108:111], v1, s[4:5] offset:0 sc1
  global_load_dwordx4 v[112:115], v1, s[4:5] offset:1024 sc1
  global_load_dwordx4 v[116:119], v1, s[4:5] offset:2048 sc1
  global_load_dwordx4 v[120:123], v1, s[4:5] offset:3072 sc1
  s_waitcnt vmcnt(4)
  v_mfma_f32_16x16x32_bf16 v[148:151], v[44:47], v[12:15], 0
  v_mfma_f32_16x16x32_bf16 v[148:151], v[48:51], v[16:19], v[148:151]
  v_mfma_f32_16x16x32_bf16 v[148:151], v[52:55], v[20:23], v[148:151]
  v_mfma_f32_16x16x32_bf16 v[148:151], v[56:59], v[24:27], v[148:151]
  v_mfma_f32_16x16x32_bf16 v[152:155], v[44:47], v[28:31], 0
  v_mfma_f32_16x16x32_bf16 v[152:155], v[48:51], v[32:35], v[152:155]
  v_mfma_f32_16x16x32_bf16 v[152:155], v[52:55], v[36:39], v[152:155]
  v_mfma_f32_16x16x32_bf16 v[152:155], v[56:59], v[40:43], v[152:155]
  v_mfma_f32_16x16x32_bf16 v[156:159], v[60:63], v[28:31], 0
  v_mfma_f32_16x16x32_bf16 v[156:159], v[64:67], v[32:35], v[156:159]
  v_mfma_f32_16x16x32_bf16 v[156:159], v[68:71], v[36:39], v[156:159]
  v_mfma_f32_16x16x32_bf16 v[156:159], v[72:75], v[40:43], v[156:159]
  s_waitcnt vmcnt(0)
  s_cmp_ge_u32 s19, 52
  s_cselect_b64 s[60:61], -1, 0
  v_max3_u32 v196, v108, v109, v110
  v_mov_b32 v197, v111
  v_max3_u32 v196, v196, v112, v113
  v_max3_u32 v197, v197, v114, v115
  v_max3_u32 v196, v196, v116, v117
  v_max3_u32 v197, v197, v118, v119
  v_max3_u32 v196, v196, v120, v121
  v_max3_u32 v197, v197, v122, v123
  v_max_u32 v196, v196, v197
  s_add_u32 s38, s38, 1
  s_cmp_gt_u32 s38, 50000000
  s_cbranch_scc1 mega_kernel_fail
  v_cmp_eq_u32 vcc, -1, v196
  s_nop 3
  s_and_b64 vcc, vcc, s[60:61]
  s_cbranch_vccnz mega_kernel_at_st

  v_add_u32 v196, 0, v11
  ds_write2_b32 v196, v108, v109 offset0:0 offset1:128
  v_add_u32 v196, 1024, v11
  ds_write2_b32 v196, v112, v113 offset0:0 offset1:128
  v_add_u32 v196, 2048, v11
  ds_write2_b32 v196, v116, v117 offset0:0 offset1:128
  v_add_u32 v196, 3072, v11
  ds_write2_b32 v196, v120, v121 offset0:0 offset1:128
  s_waitcnt lgkmcnt(0)
  ds_read_b64_tr_b16 v[124:125], v10 offset:0
  ds_read_b64_tr_b16 v[126:127], v10 offset:128
  ds_read_b64_tr_b16 v[128:129], v10 offset:1024
  ds_read_b64_tr_b16 v[130:131], v10 offset:1152
  ds_read_b64_tr_b16 v[132:133], v10 offset:2048
  ds_read_b64_tr_b16 v[134:135], v10 offset:2176
  ds_read_b64_tr_b16 v[136:137], v10 offset:3072
  ds_read_b64_tr_b16 v[138:139], v10 offset:3200
  v_mov_b32 v197, s25
  v_add_u32 v196, 0, v6
  v_cmp_le_u32 vcc, v196, v5
  s_nop 1
  v_cndmask_b32 v148, v197, v148, vcc
  v_cndmask_b32 v156, v197, v156, vcc
  v_add_u32 v196, 1, v6
  v_cmp_le_u32 vcc, v196, v5
  s_nop 1
  v_cndmask_b32 v149, v197, v149, vcc
  v_cndmask_b32 v157, v197, v157, vcc
  v_add_u32 v196, 2, v6
  v_cmp_le_u32 vcc, v196, v5
  s_nop 1
  v_cndmask_b32 v150, v197, v150, vcc
  v_cndmask_b32 v158, v197, v158, vcc
  v_add_u32 v196, 3, v6
  v_cmp_le_u32 vcc, v196, v5
  s_nop 1
  v_cndmask_b32 v151, v197, v151, vcc
  v_cndmask_b32 v159, v197, v159, vcc
  s_waitcnt lgkmcnt(0)
  v_mfma_f32_16x16x32_bf16 v[140:143], v[124:127], v[12:15], 0
  v_mfma_f32_16x16x32_bf16 v[140:143], v[128:131], v[16:19], v[140:143]
  v_mfma_f32_16x16x32_bf16 v[140:143], v[132:135], v[20:23], v[140:143]
  v_mfma_f32_16x16x32_bf16 v[140:143], v[136:139], v[24:27], v[140:143]
  v_mfma_f32_16x16x32_bf16 v[144:147], v[124:127], v[28:31], 0
  v_mfma_f32_16x16x32_bf16 v[144:147], v[128:131], v[32:35], v[144:147]
  v_mfma_f32_16x16x32_bf16 v[144:147], v[132:135], v[36:39], v[144:147]
  v_mfma_f32_16x16x32_bf16 v[144:147], v[136:139], v[40:43], v[144:147]
  v_max3_f32 v198, v148, v149, v150
  v_max3_f32 v199, v152, v153, v154
  v_max3_f32 v199, v199, v155, v156
  v_max3_f32 v199, v199, v157, v158
  v_max3_f32 v198, v198, v151, v140
  v_max_f32 v198, v198, v141
  s_nop 2
  v_max3_f32 v199, v199, v159, v144
  v_max_f32 v199, v199, v145

  v_mov_b32 v196, v198
  s_nop 1
  v_permlane32_swap_b32 v198, v196
  v_max_f32 v198, v198, v196
  v_mov_b32 v196, v198
  s_nop 1
  v_permlane16_swap_b32 v198, v196
  v_max_f32 v198, v198, v196

  v_mov_b32 v196, v199
  s_nop 1
  v_permlane32_swap_b32 v199, v196
  v_max_f32 v199, v199, v196
  v_mov_b32 v196, v199
  s_nop 1
  v_permlane16_swap_b32 v199, v196
  v_max_f32 v199, v199, v196

  v_mul_f32 v198, s24, v198
  v_mul_f32 v199, s24, v199
  v_fma_f32 v140, v140, s24, -v198
  v_fma_f32 v141, v141, s24, -v198
  v_fma_f32 v148, v148, s24, -v198
  v_fma_f32 v149, v149, s24, -v198
  v_fma_f32 v150, v150, s24, -v198
  v_fma_f32 v151, v151, s24, -v198
  v_fma_f32 v144, v144, s24, -v199
  v_fma_f32 v145, v145, s24, -v199
  v_fma_f32 v152, v152, s24, -v199
  v_fma_f32 v153, v153, s24, -v199
  v_fma_f32 v154, v154, s24, -v199
  v_fma_f32 v155, v155, s24, -v199
  v_fma_f32 v156, v156, s24, -v199
  v_fma_f32 v157, v157, s24, -v199
  v_fma_f32 v158, v158, s24, -v199
  v_fma_f32 v159, v159, s24, -v199
  v_exp_f32 v140, v140
  v_exp_f32 v141, v141
  v_exp_f32 v148, v148
  v_exp_f32 v149, v149
  v_exp_f32 v150, v150
  v_exp_f32 v151, v151
  v_exp_f32 v144, v144
  v_exp_f32 v145, v145
  v_exp_f32 v152, v152
  v_exp_f32 v153, v153
  v_exp_f32 v154, v154
  v_exp_f32 v155, v155
  v_exp_f32 v156, v156
  v_exp_f32 v157, v157
  v_exp_f32 v158, v158
  v_exp_f32 v159, v159
  s_nop 0
  v_cvt_pk_bf16_f32 v160, v140, v141
  v_cvt_pk_bf16_f32 v162, v144, v145
  v_cvt_pk_bf16_f32 v164, v148, v149
  v_cvt_pk_bf16_f32 v165, v150, v151
  v_cvt_pk_bf16_f32 v168, v152, v153
  v_cvt_pk_bf16_f32 v169, v154, v155
  v_cvt_pk_bf16_f32 v170, v156, v157
  v_cvt_pk_bf16_f32 v171, v158, v159
  v_mov_b32 v140, 0x3f803f80
  v_mov_b32 v141, 0x3f803f80
  v_mov_b32 v142, 0x3f803f80
  v_mov_b32 v143, 0x3f803f80

  v_mov_b32 v108, v111
  v_mov_b32 v112, v115
  v_mov_b32 v116, v119
  v_mov_b32 v120, v123
  s_nop 1
  v_mfma_f32_16x16x16_bf16 v[188:191], v[140:141], v[160:161], 0
  v_mfma_f32_16x16x16_bf16 v[192:195], v[140:141], v[162:163], 0
  s_lshl_b32 s28, s19, 18
  s_lshl_b32 s29, s20, 12
  s_add_u32 s28, s28, s29
  s_add_u32 s27, s28, 67108864
  s_add_u32 s4, s12, s27
  s_addc_u32 s5, s13, 0
  s_add_u32 s6, s4, 131072
  s_addc_u32 s7, s5, 0
  v_mfma_f32_16x16x16_bf16 v[172:175], v[110:111], v[160:161], 0
  v_mfma_f32_16x16x16_bf16 v[176:179], v[108:109], v[160:161], 0
  v_mfma_f32_16x16x16_bf16 v[180:183], v[110:111], v[162:163], 0
  v_mfma_f32_16x16x16_bf16 v[184:187], v[108:109], v[162:163], 0
  v_mfma_f32_16x16x32_bf16 v[188:191], v[140:143], v[164:167], v[188:191]
  v_mfma_f32_16x16x32_bf16 v[192:195], v[140:143], v[168:171], v[192:195]
  v_mfma_f32_16x16x32_bf16 v[172:175], v[76:79], v[164:167], v[172:175]
  v_mfma_f32_16x16x32_bf16 v[176:179], v[80:83], v[164:167], v[176:179]
  v_mfma_f32_16x16x32_bf16 v[180:183], v[76:79], v[168:171], v[180:183]
  v_mfma_f32_16x16x32_bf16 v[184:187], v[80:83], v[168:171], v[184:187]
  s_nop 3
  v_rcp_f32 v198, v188
  v_rcp_f32 v199, v192
  s_nop 7
  v_mul_f32 v172, v172, v198
  v_mul_f32 v173, v173, v198
  v_mul_f32 v174, v174, v198
  v_mul_f32 v175, v175, v198
  v_mul_f32 v176, v176, v198
  v_mul_f32 v177, v177, v198
  v_mul_f32 v178, v178, v198
  v_mul_f32 v179, v179, v198
  v_cvt_pk_bf16_f32 v200, v172, v173
  v_cvt_pk_bf16_f32 v201, v174, v175
  v_cvt_pk_bf16_f32 v202, v176, v177
  v_cvt_pk_bf16_f32 v203, v178, v179
  global_store_dwordx4 v1, v[200:203], s[4:5] offset:0 sc1
  v_mul_f32 v180, v180, v199
  v_mul_f32 v181, v181, v199
  v_mul_f32 v182, v182, v199
  v_mul_f32 v183, v183, v199
  v_mul_f32 v184, v184, v199
  v_mul_f32 v185, v185, v199
  v_mul_f32 v186, v186, v199
  v_mul_f32 v187, v187, v199
  v_cvt_pk_bf16_f32 v204, v180, v181
  v_cvt_pk_bf16_f32 v205, v182, v183
  v_cvt_pk_bf16_f32 v206, v184, v185
  v_cvt_pk_bf16_f32 v207, v186, v187
  global_store_dwordx4 v1, v[204:207], s[6:7] offset:0 sc1
  s_nop 1
  v_mfma_f32_16x16x16_bf16 v[172:175], v[114:115], v[160:161], 0
  v_mfma_f32_16x16x16_bf16 v[176:179], v[112:113], v[160:161], 0
  v_mfma_f32_16x16x16_bf16 v[180:183], v[114:115], v[162:163], 0
  v_mfma_f32_16x16x16_bf16 v[184:187], v[112:113], v[162:163], 0
  s_nop 3
  v_mfma_f32_16x16x32_bf16 v[172:175], v[84:87], v[164:167], v[172:175]
  v_mfma_f32_16x16x32_bf16 v[176:179], v[88:91], v[164:167], v[176:179]
  v_mfma_f32_16x16x32_bf16 v[180:183], v[84:87], v[168:171], v[180:183]
  v_mfma_f32_16x16x32_bf16 v[184:187], v[88:91], v[168:171], v[184:187]
  s_nop 7
  v_mul_f32 v172, v172, v198
  v_mul_f32 v173, v173, v198
  v_mul_f32 v174, v174, v198
  v_mul_f32 v175, v175, v198
  v_mul_f32 v176, v176, v198
  v_mul_f32 v177, v177, v198
  v_mul_f32 v178, v178, v198
  v_mul_f32 v179, v179, v198
  v_cvt_pk_bf16_f32 v200, v172, v173
  v_cvt_pk_bf16_f32 v201, v174, v175
  v_cvt_pk_bf16_f32 v202, v176, v177
  v_cvt_pk_bf16_f32 v203, v178, v179
  global_store_dwordx4 v1, v[200:203], s[4:5] offset:1024 sc1
  v_mul_f32 v180, v180, v199
  v_mul_f32 v181, v181, v199
  v_mul_f32 v182, v182, v199
  v_mul_f32 v183, v183, v199
  v_mul_f32 v184, v184, v199
  v_mul_f32 v185, v185, v199
  v_mul_f32 v186, v186, v199
  v_mul_f32 v187, v187, v199
  v_cvt_pk_bf16_f32 v204, v180, v181
  v_cvt_pk_bf16_f32 v205, v182, v183
  v_cvt_pk_bf16_f32 v206, v184, v185
  v_cvt_pk_bf16_f32 v207, v186, v187
  global_store_dwordx4 v1, v[204:207], s[6:7] offset:1024 sc1
  s_nop 1
  v_mfma_f32_16x16x16_bf16 v[172:175], v[118:119], v[160:161], 0
  v_mfma_f32_16x16x16_bf16 v[176:179], v[116:117], v[160:161], 0
  v_mfma_f32_16x16x16_bf16 v[180:183], v[118:119], v[162:163], 0
  v_mfma_f32_16x16x16_bf16 v[184:187], v[116:117], v[162:163], 0
  s_nop 3
  v_mfma_f32_16x16x32_bf16 v[172:175], v[92:95], v[164:167], v[172:175]
  v_mfma_f32_16x16x32_bf16 v[176:179], v[96:99], v[164:167], v[176:179]
  v_mfma_f32_16x16x32_bf16 v[180:183], v[92:95], v[168:171], v[180:183]
  v_mfma_f32_16x16x32_bf16 v[184:187], v[96:99], v[168:171], v[184:187]
  s_nop 7
  v_mul_f32 v172, v172, v198
  v_mul_f32 v173, v173, v198
  v_mul_f32 v174, v174, v198
  v_mul_f32 v175, v175, v198
  v_mul_f32 v176, v176, v198
  v_mul_f32 v177, v177, v198
  v_mul_f32 v178, v178, v198
  v_mul_f32 v179, v179, v198
  v_cvt_pk_bf16_f32 v200, v172, v173
  v_cvt_pk_bf16_f32 v201, v174, v175
  v_cvt_pk_bf16_f32 v202, v176, v177
  v_cvt_pk_bf16_f32 v203, v178, v179
  global_store_dwordx4 v1, v[200:203], s[4:5] offset:2048 sc1
  v_mul_f32 v180, v180, v199
  v_mul_f32 v181, v181, v199
  v_mul_f32 v182, v182, v199
  v_mul_f32 v183, v183, v199
  v_mul_f32 v184, v184, v199
  v_mul_f32 v185, v185, v199
  v_mul_f32 v186, v186, v199
  v_mul_f32 v187, v187, v199
  v_cvt_pk_bf16_f32 v204, v180, v181
  v_cvt_pk_bf16_f32 v205, v182, v183
  v_cvt_pk_bf16_f32 v206, v184, v185
  v_cvt_pk_bf16_f32 v207, v186, v187
  global_store_dwordx4 v1, v[204:207], s[6:7] offset:2048 sc1
  s_nop 1
  v_mfma_f32_16x16x16_bf16 v[172:175], v[122:123], v[160:161], 0
  v_mfma_f32_16x16x16_bf16 v[176:179], v[120:121], v[160:161], 0
  v_mfma_f32_16x16x16_bf16 v[180:183], v[122:123], v[162:163], 0
  v_mfma_f32_16x16x16_bf16 v[184:187], v[120:121], v[162:163], 0
  s_nop 3
  v_mfma_f32_16x16x32_bf16 v[172:175], v[100:103], v[164:167], v[172:175]
  v_mfma_f32_16x16x32_bf16 v[176:179], v[104:107], v[164:167], v[176:179]
  v_mfma_f32_16x16x32_bf16 v[180:183], v[100:103], v[168:171], v[180:183]
  v_mfma_f32_16x16x32_bf16 v[184:187], v[104:107], v[168:171], v[184:187]
  s_nop 7
  v_mul_f32 v172, v172, v198
  v_mul_f32 v173, v173, v198
  v_mul_f32 v174, v174, v198
  v_mul_f32 v175, v175, v198
  v_mul_f32 v176, v176, v198
  v_mul_f32 v177, v177, v198
  v_mul_f32 v178, v178, v198
  v_mul_f32 v179, v179, v198
  v_cvt_pk_bf16_f32 v200, v172, v173
  v_cvt_pk_bf16_f32 v201, v174, v175
  v_cvt_pk_bf16_f32 v202, v176, v177
  v_cvt_pk_bf16_f32 v203, v178, v179
  global_store_dwordx4 v1, v[200:203], s[4:5] offset:3072 sc1
  v_mul_f32 v180, v180, v199
  v_mul_f32 v181, v181, v199
  v_mul_f32 v182, v182, v199
  v_mul_f32 v183, v183, v199
  v_mul_f32 v184, v184, v199
  v_mul_f32 v185, v185, v199
  v_mul_f32 v186, v186, v199
  v_mul_f32 v187, v187, v199
  v_cvt_pk_bf16_f32 v204, v180, v181
  v_cvt_pk_bf16_f32 v205, v182, v183
  v_cvt_pk_bf16_f32 v206, v184, v185
  v_cvt_pk_bf16_f32 v207, v186, v187
  global_store_dwordx4 v1, v[204:207], s[6:7] offset:3072 sc1
  s_nop 1
  s_cmp_eq_u32 s18, 0
  s_cbranch_scc0 mega_kernel_ht_18
  s_lshl_b32 s60, s19, 7
  s_add_u32 s60, s60, 8208
  v_mov_b32 v2, s60
  v_mov_b32 v3, 1
  v_cmp_eq_u32 vcc, 0, v0
  s_and_saveexec_b64 s[62:63], vcc
  global_atomic_add v2, v3, s[14:15]
  s_mov_b64 exec, s[62:63]
mega_kernel_ht_18:

  s_lshl_b32 s28, s19, 7
  s_add_u32 s28, s28, 8192
  s_waitcnt vmcnt(0)
  s_barrier
  s_cmp_eq_u32 s18, 0
  s_cbranch_scc0 mega_kernel_sg_19
  v_mov_b32 v2, s28
  v_mov_b32 v3, 1
  v_cmp_eq_u32 vcc, 0, v0
  s_and_saveexec_b64 s[62:63], vcc
  global_atomic_add v2, v3, s[14:15]

  s_mov_b64 exec, s[62:63]
mega_kernel_sg_19:

  s_add_u32 s19, s19, 3
  s_cmp_lt_u32 s19, 64
  s_cbranch_scc1 mega_kernel_at_tl
  s_branch mega_kernel_end
mega_kernel_rW1:
  s_sub_u32 s26, s17, 184
  s_mul_hi_u32 s20, s26, 429496730
  s_mul_i32 s27, s20, 10
  s_sub_u32 s22, s26, s27
  s_load_dwordx2 s[4:5], s[0:1], 64
  s_load_dwordx2 s[10:11], s[0:1], 0
  s_lshl_b32 s26, s20, 8
  s_lshl_b32 s27, s18, 6
  s_add_u32 s26, s26, s27
  s_waitcnt lgkmcnt(0)
  s_add_u32 s4, s4, s26
  s_addc_u32 s5, s5, 0

  v_lshrrev_b32 v5, 2, v0
  v_mov_b32 v6, 1024
  v_mul_lo_u32 v5, v5, v6
  v_and_b32 v6, 3, v0
  v_lshl_add_u32 v2, v6, 4, v5
  v_and_b32 v5, 15, v0
  v_lshrrev_b32 v6, 4, v0
  v_lshrrev_b32 v7, 2, v5
  v_lshl_add_u32 v7, v6, 3, v7
  v_mul_u32_u24 v7, 64, v7
  v_and_b32 v5, 3, v5
  v_lshl_add_u32 v7, v5, 4, v7
  s_mul_i32 s24, s18, 40960
  s_add_u32 s24, s24, 0
  v_add_u32 v3, s24, v7

  s_add_u32 s8, s4, 0
  s_addc_u32 s9, s5, 0
  s_add_u32 m0, s24, 0
  s_nop 0
  global_load_lds_dwordx4 v2, s[8:9]

  s_add_u32 s8, s4, 16384
  s_addc_u32 s9, s5, 0
  s_add_u32 m0, s24, 1024
  s_nop 0
  global_load_lds_dwordx4 v2, s[8:9]

  s_add_u32 s8, s4, 32768
  s_addc_u32 s9, s5, 0
  s_add_u32 m0, s24, 2048
  s_nop 0
  global_load_lds_dwordx4 v2, s[8:9]

  s_add_u32 s8, s4, 49152
  s_addc_u32 s9, s5, 0
  s_add_u32 m0, s24, 3072
  s_nop 0
  global_load_lds_dwordx4 v2, s[8:9]

  s_add_u32 s8, s4, 65536
  s_addc_u32 s9, s5, 0
  s_add_u32 m0, s24, 4096
  s_nop 0
  global_load_lds_dwordx4 v2, s[8:9]

  s_add_u32 s8, s4, 81920
  s_addc_u32 s9, s5, 0
  s_add_u32 m0, s24, 5120
  s_nop 0
  global_load_lds_dwordx4 v2, s[8:9]

  s_add_u32 s8, s4, 98304
  s_addc_u32 s9, s5, 0
  s_add_u32 m0, s24, 6144
  s_nop 0
  global_load_lds_dwordx4 v2, s[8:9]

  s_add_u32 s8, s4, 114688
  s_addc_u32 s9, s5, 0
  s_add_u32 m0, s24, 7168
  s_nop 0
  global_load_lds_dwordx4 v2, s[8:9]

  s_add_u32 s8, s4, 131072
  s_addc_u32 s9, s5, 0
  s_add_u32 m0, s24, 8192
  s_nop 0
  global_load_lds_dwordx4 v2, s[8:9]

  s_add_u32 s8, s4, 147456
  s_addc_u32 s9, s5, 0
  s_add_u32 m0, s24, 9216
  s_nop 0
  global_load_lds_dwordx4 v2, s[8:9]

  s_add_u32 s8, s4, 163840
  s_addc_u32 s9, s5, 0
  s_add_u32 m0, s24, 10240
  s_nop 0
  global_load_lds_dwordx4 v2, s[8:9]

  s_add_u32 s8, s4, 180224
  s_addc_u32 s9, s5, 0
  s_add_u32 m0, s24, 11264
  s_nop 0
  global_load_lds_dwordx4 v2, s[8:9]

  s_add_u32 s8, s4, 196608
  s_addc_u32 s9, s5, 0
  s_add_u32 m0, s24, 12288
  s_nop 0
  global_load_lds_dwordx4 v2, s[8:9]

  s_add_u32 s8, s4, 212992
  s_addc_u32 s9, s5, 0
  s_add_u32 m0, s24, 13312
  s_nop 0
  global_load_lds_dwordx4 v2, s[8:9]

  s_add_u32 s8, s4, 229376
  s_addc_u32 s9, s5, 0
  s_add_u32 m0, s24, 14336
  s_nop 0
  global_load_lds_dwordx4 v2, s[8:9]

  s_add_u32 s8, s4, 245760
  s_addc_u32 s9, s5, 0
  s_add_u32 m0, s24, 15360
  s_nop 0
  global_load_lds_dwordx4 v2, s[8:9]

  s_add_u32 s8, s4, 262144
  s_addc_u32 s9, s5, 0
  s_add_u32 m0, s24, 16384
  s_nop 0
  global_load_lds_dwordx4 v2, s[8:9]

  s_add_u32 s8, s4, 278528
  s_addc_u32 s9, s5, 0
  s_add_u32 m0, s24, 17408
  s_nop 0
  global_load_lds_dwordx4 v2, s[8:9]

  s_add_u32 s8, s4, 294912
  s_addc_u32 s9, s5, 0
  s_add_u32 m0, s24, 18432
  s_nop 0
  global_load_lds_dwordx4 v2, s[8:9]

  s_add_u32 s8, s4, 311296
  s_addc_u32 s9, s5, 0
  s_add_u32 m0, s24, 19456
  s_nop 0
  global_load_lds_dwordx4 v2, s[8:9]

  s_add_u32 s8, s4, 327680
  s_addc_u32 s9, s5, 0
  s_add_u32 m0, s24, 20480
  s_nop 0
  global_load_lds_dwordx4 v2, s[8:9]

  s_add_u32 s8, s4, 344064
  s_addc_u32 s9, s5, 0
  s_add_u32 m0, s24, 21504
  s_nop 0
  global_load_lds_dwordx4 v2, s[8:9]

  s_add_u32 s8, s4, 360448
  s_addc_u32 s9, s5, 0
  s_add_u32 m0, s24, 22528
  s_nop 0
  global_load_lds_dwordx4 v2, s[8:9]

  s_add_u32 s8, s4, 376832
  s_addc_u32 s9, s5, 0
  s_add_u32 m0, s24, 23552
  s_nop 0
  global_load_lds_dwordx4 v2, s[8:9]

  s_add_u32 s8, s4, 393216
  s_addc_u32 s9, s5, 0
  s_add_u32 m0, s24, 24576
  s_nop 0
  global_load_lds_dwordx4 v2, s[8:9]

  s_add_u32 s8, s4, 409600
  s_addc_u32 s9, s5, 0
  s_add_u32 m0, s24, 25600
  s_nop 0
  global_load_lds_dwordx4 v2, s[8:9]

  s_add_u32 s8, s4, 425984
  s_addc_u32 s9, s5, 0
  s_add_u32 m0, s24, 26624
  s_nop 0
  global_load_lds_dwordx4 v2, s[8:9]

  s_add_u32 s8, s4, 442368
  s_addc_u32 s9, s5, 0
  s_add_u32 m0, s24, 27648
  s_nop 0
  global_load_lds_dwordx4 v2, s[8:9]

  s_add_u32 s8, s4, 458752
  s_addc_u32 s9, s5, 0
  s_add_u32 m0, s24, 28672
  s_nop 0
  global_load_lds_dwordx4 v2, s[8:9]

  s_add_u32 s8, s4, 475136
  s_addc_u32 s9, s5, 0
  s_add_u32 m0, s24, 29696
  s_nop 0
  global_load_lds_dwordx4 v2, s[8:9]

  s_add_u32 s8, s4, 491520
  s_addc_u32 s9, s5, 0
  s_add_u32 m0, s24, 30720
  s_nop 0
  global_load_lds_dwordx4 v2, s[8:9]

  s_add_u32 s8, s4, 507904
  s_addc_u32 s9, s5, 0
  s_add_u32 m0, s24, 31744
  s_nop 0
  global_load_lds_dwordx4 v2, s[8:9]

  s_waitcnt vmcnt(30)
  ds_read_b64_tr_b16 a[0:1], v3 offset:0
  ds_read_b64_tr_b16 a[2:3], v3 offset:256
  ds_read_b64_tr_b16 a[4:5], v3 offset:8
  ds_read_b64_tr_b16 a[6:7], v3 offset:264
  s_waitcnt vmcnt(28)
  ds_read_b64_tr_b16 a[8:9], v3 offset:2048
  ds_read_b64_tr_b16 a[10:11], v3 offset:2304
  ds_read_b64_tr_b16 a[12:13], v3 offset:2056
  ds_read_b64_tr_b16 a[14:15], v3 offset:2312
  s_waitcnt vmcnt(26)
  ds_read_b64_tr_b16 a[16:17], v3 offset:4096
  ds_read_b64_tr_b16 a[18:19], v3 offset:4352
  ds_read_b64_tr_b16 a[20:21], v3 offset:4104
  ds_read_b64_tr_b16 a[22:23], v3 offset:4360
  s_waitcnt vmcnt(24)
  ds_read_b64_tr_b16 a[24:25], v3 offset:6144
  ds_read_b64_tr_b16 a[26:27], v3 offset:6400
  ds_read_b64_tr_b16 a[28:29], v3 offset:6152
  ds_read_b64_tr_b16 a[30:31], v3 offset:6408
  s_waitcnt vmcnt(22)
  ds_read_b64_tr_b16 a[32:33], v3 offset:8192
  ds_read_b64_tr_b16 a[34:35], v3 offset:8448
  ds_read_b64_tr_b16 a[36:37], v3 offset:8200
  ds_read_b64_tr_b16 a[38:39], v3 offset:8456
  s_waitcnt vmcnt(20)
  ds_read_b64_tr_b16 a[40:41], v3 offset:10240
  ds_read_b64_tr_b16 a[42:43], v3 offset:10496
  ds_read_b64_tr_b16 a[44:45], v3 offset:10248
  ds_read_b64_tr_b16 a[46:47], v3 offset:10504
  s_waitcnt vmcnt(18)
  ds_read_b64_tr_b16 a[48:49], v3 offset:12288
  ds_read_b64_tr_b16 a[50:51], v3 offset:12544
  ds_read_b64_tr_b16 a[52:53], v3 offset:12296
  ds_read_b64_tr_b16 a[54:55], v3 offset:12552
  s_waitcnt vmcnt(16)
  ds_read_b64_tr_b16 a[56:57], v3 offset:14336
  ds_read_b64_tr_b16 a[58:59], v3 offset:14592
  ds_read_b64_tr_b16 a[60:61], v3 offset:14344
  ds_read_b64_tr_b16 a[62:63], v3 offset:14600
  s_waitcnt vmcnt(14)
  ds_read_b64_tr_b16 a[64:65], v3 offset:16384
  ds_read_b64_tr_b16 a[66:67], v3 offset:16640
  ds_read_b64_tr_b16 a[68:69], v3 offset:16392
  ds_read_b64_tr_b16 a[70:71], v3 offset:16648
  s_waitcnt vmcnt(12)
  ds_read_b64_tr_b16 a[72:73], v3 offset:18432
  ds_read_b64_tr_b16 a[74:75], v3 offset:18688
  ds_read_b64_tr_b16 a[76:77], v3 offset:18440
  ds_read_b64_tr_b16 a[78:79], v3 offset:18696
  s_waitcnt vmcnt(10)
  ds_read_b64_tr_b16 a[80:81], v3 offset:20480
  ds_read_b64_tr_b16 a[82:83], v3 offset:20736
  ds_read_b64_tr_b16 a[84:85], v3 offset:20488
  ds_read_b64_tr_b16 a[86:87], v3 offset:20744
  s_waitcnt vmcnt(8)
  ds_read_b64_tr_b16 a[88:89], v3 offset:22528
  ds_read_b64_tr_b16 a[90:91], v3 offset:22784
  ds_read_b64_tr_b16 a[92:93], v3 offset:22536
  ds_read_b64_tr_b16 a[94:95], v3 offset:22792
  s_waitcnt vmcnt(6)
  ds_read_b64_tr_b16 a[96:97], v3 offset:24576
  ds_read_b64_tr_b16 a[98:99], v3 offset:24832
  ds_read_b64_tr_b16 a[100:101], v3 offset:24584
  ds_read_b64_tr_b16 a[102:103], v3 offset:24840
  s_waitcnt vmcnt(4)
  ds_read_b64_tr_b16 a[104:105], v3 offset:26624
  ds_read_b64_tr_b16 a[106:107], v3 offset:26880
  ds_read_b64_tr_b16 a[108:109], v3 offset:26632
  ds_read_b64_tr_b16 a[110:111], v3 offset:26888
  s_waitcnt vmcnt(2)
  ds_read_b64_tr_b16 a[112:113], v3 offset:28672
  ds_read_b64_tr_b16 a[114:115], v3 offset:28928
  ds_read_b64_tr_b16 a[116:117], v3 offset:28680
  ds_read_b64_tr_b16 a[118:119], v3 offset:28936
  s_waitcnt vmcnt(0)
  ds_read_b64_tr_b16 a[120:121], v3 offset:30720
  ds_read_b64_tr_b16 a[122:123], v3 offset:30976
  ds_read_b64_tr_b16 a[124:125], v3 offset:30728
  ds_read_b64_tr_b16 a[126:127], v3 offset:30984
  s_waitcnt lgkmcnt(0)
  s_barrier
  v_add_u32 v4, 4096, v1
  s_lshl_b32 s26, s18, 12
  v_add_u32 v6, s26, v1
  v_and_b32 v9, 15, v0
  v_lshlrev_b32 v9, 10, v9
  v_lshrrev_b32 v10, 4, v0
  v_lshl_add_u32 v9, v10, 4, v9
  s_lshl_b32 s26, s18, 8
  v_add_u32 v9, s26, v9
  s_mov_b32 s30, 0xc0135761
  s_mov_b32 s31, 0xbdd2d3e8
  s_lshl_b32 s25, s20, 2
  s_add_u32 s25, s25, s18
  s_lshl_b32 s25, s25, 10

  s_mov_b32 s28, s22
  s_lshl_b32 s28, s28, 14
  s_add_u32 s8, s10, s28
  s_addc_u32 s9, s11, 0
  global_load_dwordx4 v[96:99], v9, s[8:9] offset:0
  global_load_dwordx4 v[100:103], v9, s[8:9] offset:64
  global_load_dwordx4 v[104:107], v9, s[8:9] offset:128
  global_load_dwordx4 v[108:111], v9, s[8:9] offset:192
  s_mov_b32 s19, s22
  s_mov_b32 s38, 0
mega_kernel_w1_tl:
  s_lshl_b32 s29, s19, 15
  s_lshl_b32 s28, s18, 13
  s_add_u32 s29, s29, s28
  s_lshl_b32 s28, s19, 7
  s_add_u32 s28, s28, 24576
  s_mov_b32 s37, 16
  s_cmp_ge_u32 s19, 124
  s_cselect_b32 s36, 16, 0
  s_add_u32 s28, s28, s36
  v_mov_b32 v2, s28
  s_mov_b32 s27, 0
mega_kernel_pl_20:
  global_load_dword v3, v2, s[14:15] sc1
  s_add_u32 s27, s27, 1
  s_cmp_gt_u32 s27, 50000000
  s_cbranch_scc1 mega_kernel_fail
  s_waitcnt vmcnt(0)
  v_readfirstlane_b32 s26, v3
  s_nop 3
  s_cmp_ge_u32 s26, s37
  s_cbranch_scc1 mega_kernel_pl_20_ok
  s_sleep 2
  s_branch mega_kernel_pl_20
mega_kernel_pl_20_ok:

mega_kernel_w1_st:
  s_add_u32 s27, s29, 150994944
  s_add_u32 s8, s12, s27
  s_addc_u32 s9, s13, 0
  global_load_dwordx4 v[32:35], v1, s[8:9] offset:0 sc1
  global_load_dwordx4 v[36:39], v1, s[8:9] offset:1024 sc1
  global_load_dwordx4 v[40:43], v1, s[8:9] offset:2048 sc1
  global_load_dwordx4 v[44:47], v1, s[8:9] offset:3072 sc1
  global_load_dwordx4 v[48:51], v4, s[8:9] offset:0 sc1
  global_load_dwordx4 v[52:55], v4, s[8:9] offset:1024 sc1
  global_load_dwordx4 v[56:59], v4, s[8:9] offset:2048 sc1
  global_load_dwordx4 v[60:63], v4, s[8:9] offset:3072 sc1
  s_add_u32 s27, s29, 155189248
  s_add_u32 s8, s12, s27
  s_addc_u32 s9, s13, 0
  global_load_dwordx4 v[64:67], v1, s[8:9] offset:0 sc1
  global_load_dwordx4 v[68:71], v1, s[8:9] offset:1024 sc1
  global_load_dwordx4 v[72:75], v1, s[8:9] offset:2048 sc1
  global_load_dwordx4 v[76:79], v1, s[8:9] offset:3072 sc1
  global_load_dwordx4 v[80:83], v4, s[8:9] offset:0 sc1
  global_load_dwordx4 v[84:87], v4, s[8:9] offset:1024 sc1
  global_load_dwordx4 v[88:91], v4, s[8:9] offset:2048 sc1
  global_load_dwordx4 v[92:95], v4, s[8:9] offset:3072 sc1
  s_waitcnt vmcnt(0)
  s_cmp_ge_u32 s19, 124
  s_cselect_b64 s[60:61], -1, 0
  v_max3_u32 v112, v32, v33, v34
  v_mov_b32 v113, v35
  v_max3_u32 v112, v112, v36, v37
  v_max3_u32 v113, v113, v38, v39
  v_max3_u32 v112, v112, v40, v41
  v_max3_u32 v113, v113, v42, v43
  v_max3_u32 v112, v112, v44, v45
  v_max3_u32 v113, v113, v46, v47
  v_max3_u32 v112, v112, v48, v49
  v_max3_u32 v113, v113, v50, v51
  v_max3_u32 v112, v112, v52, v53
  v_max3_u32 v113, v113, v54, v55
  v_max3_u32 v112, v112, v56, v57
  v_max3_u32 v113, v113, v58, v59
  v_max3_u32 v112, v112, v60, v61
  v_max3_u32 v113, v113, v62, v63
  v_max3_u32 v112, v112, v64, v65
  v_max3_u32 v113, v113, v66, v67
  v_max3_u32 v112, v112, v68, v69
  v_max3_u32 v113, v113, v70, v71
  v_max3_u32 v112, v112, v72, v73
  v_max3_u32 v113, v113, v74, v75
  v_max3_u32 v112, v112, v76, v77
  v_max3_u32 v113, v113, v78, v79
  v_max3_u32 v112, v112, v80, v81
  v_max3_u32 v113, v113, v82, v83
  v_max3_u32 v112, v112, v84, v85
  v_max3_u32 v113, v113, v86, v87
  v_max3_u32 v112, v112, v88, v89
  v_max3_u32 v113, v113, v90, v91
  v_max3_u32 v112, v112, v92, v93
  v_max3_u32 v113, v113, v94, v95
  v_max_u32 v112, v112, v113
  s_add_u32 s38, s38, 1
  s_cmp_gt_u32 s38, 50000000
  s_cbranch_scc1 mega_kernel_fail
  v_cmp_eq_u32 vcc, -1, v112
  s_nop 3
  s_and_b64 vcc, vcc, s[60:61]
  s_cbranch_vccnz mega_kernel_w1_st

  v_lshlrev_b32 v112, 16, v96
  v_and_b32 v113, 0xffff0000, v96
  v_pk_add_f32 v[32:33], v[32:33], v[112:113]
  v_lshlrev_b32 v112, 16, v97
  v_and_b32 v113, 0xffff0000, v97
  v_pk_add_f32 v[34:35], v[34:35], v[112:113]
  v_lshlrev_b32 v112, 16, v98
  v_and_b32 v113, 0xffff0000, v98
  v_pk_add_f32 v[36:37], v[36:37], v[112:113]
  v_lshlrev_b32 v112, 16, v99
  v_and_b32 v113, 0xffff0000, v99
  v_pk_add_f32 v[38:39], v[38:39], v[112:113]
  v_lshlrev_b32 v112, 16, v100
  v_and_b32 v113, 0xffff0000, v100
  v_pk_add_f32 v[40:41], v[40:41], v[112:113]
  v_lshlrev_b32 v112, 16, v101
  v_and_b32 v113, 0xffff0000, v101
  v_pk_add_f32 v[42:43], v[42:43], v[112:113]
  v_lshlrev_b32 v112, 16, v102
  v_and_b32 v113, 0xffff0000, v102
  v_pk_add_f32 v[44:45], v[44:45], v[112:113]
  v_lshlrev_b32 v112, 16, v103
  v_and_b32 v113, 0xffff0000, v103
  v_pk_add_f32 v[46:47], v[46:47], v[112:113]
  v_lshlrev_b32 v112, 16, v104
  v_and_b32 v113, 0xffff0000, v104
  v_pk_add_f32 v[48:49], v[48:49], v[112:113]
  v_lshlrev_b32 v112, 16, v105
  v_and_b32 v113, 0xffff0000, v105
  v_pk_add_f32 v[50:51], v[50:51], v[112:113]
  v_lshlrev_b32 v112, 16, v106
  v_and_b32 v113, 0xffff0000, v106
  v_pk_add_f32 v[52:53], v[52:53], v[112:113]
  v_lshlrev_b32 v112, 16, v107
  v_and_b32 v113, 0xffff0000, v107
  v_pk_add_f32 v[54:55], v[54:55], v[112:113]
  v_lshlrev_b32 v112, 16, v108
  v_and_b32 v113, 0xffff0000, v108
  v_pk_add_f32 v[56:57], v[56:57], v[112:113]
  v_lshlrev_b32 v112, 16, v109
  v_and_b32 v113, 0xffff0000, v109
  v_pk_add_f32 v[58:59], v[58:59], v[112:113]
  v_lshlrev_b32 v112, 16, v110
  v_and_b32 v113, 0xffff0000, v110
  v_pk_add_f32 v[60:61], v[60:61], v[112:113]
  v_lshlrev_b32 v112, 16, v111
  v_and_b32 v113, 0xffff0000, v111
  v_pk_add_f32 v[62:63], v[62:63], v[112:113]
  s_add_u32 s28, s19, 10
  s_min_u32 s28, s28, 127
  s_lshl_b32 s28, s28, 14
  s_add_u32 s8, s10, s28
  s_addc_u32 s9, s11, 0
  global_load_dwordx4 v[96:99], v9, s[8:9] offset:0
  global_load_dwordx4 v[100:103], v9, s[8:9] offset:64
  global_load_dwordx4 v[104:107], v9, s[8:9] offset:128
  global_load_dwordx4 v[108:111], v9, s[8:9] offset:192
  v_pk_add_f32 v[32:33], v[32:33], v[64:65]
  v_pk_add_f32 v[34:35], v[34:35], v[66:67]
  v_pk_add_f32 v[36:37], v[36:37], v[68:69]
  v_pk_add_f32 v[38:39], v[38:39], v[70:71]
  v_pk_add_f32 v[40:41], v[40:41], v[72:73]
  v_pk_add_f32 v[42:43], v[42:43], v[74:75]
  v_pk_add_f32 v[44:45], v[44:45], v[76:77]
  v_pk_add_f32 v[46:47], v[46:47], v[78:79]
  v_pk_add_f32 v[48:49], v[48:49], v[80:81]
  v_pk_add_f32 v[50:51], v[50:51], v[82:83]
  v_pk_add_f32 v[52:53], v[52:53], v[84:85]
  v_pk_add_f32 v[54:55], v[54:55], v[86:87]
  v_pk_add_f32 v[56:57], v[56:57], v[88:89]
  v_pk_add_f32 v[58:59], v[58:59], v[90:91]
  v_pk_add_f32 v[60:61], v[60:61], v[92:93]
  v_pk_add_f32 v[62:63], v[62:63], v[94:95]
  s_add_u32 s27, s29, 100663296
  s_add_u32 s8, s12, s27
  s_addc_u32 s9, s13, 0
  s_cmp_eq_u32 s20, 0
  s_cbranch_scc0 mega_kernel_w1_nh0
  global_store_dwordx4 v1, v[32:35], s[8:9] offset:0 sc1
  global_store_dwordx4 v1, v[36:39], s[8:9] offset:1024 sc1
mega_kernel_w1_nh0:
  s_cmp_eq_u32 s20, 1
  s_cbranch_scc0 mega_kernel_w1_nh1
  global_store_dwordx4 v1, v[40:43], s[8:9] offset:2048 sc1
  global_store_dwordx4 v1, v[44:47], s[8:9] offset:3072 sc1
mega_kernel_w1_nh1:
  s_cmp_eq_u32 s20, 2
  s_cbranch_scc0 mega_kernel_w1_nh2
  global_store_dwordx4 v4, v[48:51], s[8:9] offset:0 sc1
  global_store_dwordx4 v4, v[52:55], s[8:9] offset:1024 sc1
mega_kernel_w1_nh2:
  s_cmp_eq_u32 s20, 3
  s_cbranch_scc0 mega_kernel_w1_nh3
  global_store_dwordx4 v4, v[56:59], s[8:9] offset:2048 sc1
  global_store_dwordx4 v4, v[60:63], s[8:9] offset:3072 sc1
mega_kernel_w1_nh3:
  s_nop 1
  v_pk_add_f32 v[112:113], v[32:33], v[34:35]
  v_pk_add_f32 v[114:115], v[36:37], v[38:39]
  v_pk_add_f32 v[112:113], v[112:113], v[40:41]
  v_pk_add_f32 v[114:115], v[114:115], v[42:43]
  v_pk_add_f32 v[112:113], v[112:113], v[44:45]
  v_pk_add_f32 v[114:115], v[114:115], v[46:47]
  v_pk_add_f32 v[112:113], v[112:113], v[48:49]
  v_pk_add_f32 v[114:115], v[114:115], v[50:51]
  v_pk_add_f32 v[112:113], v[112:113], v[52:53]
  v_pk_add_f32 v[114:115], v[114:115], v[54:55]
  v_pk_add_f32 v[112:113], v[112:113], v[56:57]
  v_pk_add_f32 v[114:115], v[114:115], v[58:59]
  v_pk_add_f32 v[112:113], v[112:113], v[60:61]
  v_pk_add_f32 v[114:115], v[114:115], v[62:63]
  v_pk_add_f32 v[112:113], v[112:113], v[114:115]
  v_add_f32 v112, v112, v113
  v_mov_b32 v113, v112
  s_nop 1
  v_permlane32_swap_b32 v112, v113
  v_add_f32 v112, v112, v113
  v_mov_b32 v113, v112
  s_nop 1
  v_permlane16_swap_b32 v112, v113
  v_add_f32 v112, v112, v113

  v_mul_f32 v112, 0x3c000000, v112
  v_pk_add_f32 v[32:33], v[32:33], v[112:113] op_sel_hi:[1,0] neg_lo:[0,1] neg_hi:[0,1]
  v_pk_add_f32 v[34:35], v[34:35], v[112:113] op_sel_hi:[1,0] neg_lo:[0,1] neg_hi:[0,1]
  v_pk_add_f32 v[36:37], v[36:37], v[112:113] op_sel_hi:[1,0] neg_lo:[0,1] neg_hi:[0,1]
  v_pk_add_f32 v[38:39], v[38:39], v[112:113] op_sel_hi:[1,0] neg_lo:[0,1] neg_hi:[0,1]
  v_pk_add_f32 v[40:41], v[40:41], v[112:113] op_sel_hi:[1,0] neg_lo:[0,1] neg_hi:[0,1]
  v_pk_add_f32 v[42:43], v[42:43], v[112:113] op_sel_hi:[1,0] neg_lo:[0,1] neg_hi:[0,1]
  v_pk_add_f32 v[44:45], v[44:45], v[112:113] op_sel_hi:[1,0] neg_lo:[0,1] neg_hi:[0,1]
  v_pk_add_f32 v[46:47], v[46:47], v[112:113] op_sel_hi:[1,0] neg_lo:[0,1] neg_hi:[0,1]
  v_pk_add_f32 v[48:49], v[48:49], v[112:113] op_sel_hi:[1,0] neg_lo:[0,1] neg_hi:[0,1]
  v_pk_add_f32 v[50:51], v[50:51], v[112:113] op_sel_hi:[1,0] neg_lo:[0,1] neg_hi:[0,1]
  v_pk_add_f32 v[52:53], v[52:53], v[112:113] op_sel_hi:[1,0] neg_lo:[0,1] neg_hi:[0,1]
  v_pk_add_f32 v[54:55], v[54:55], v[112:113] op_sel_hi:[1,0] neg_lo:[0,1] neg_hi:[0,1]
  v_pk_add_f32 v[56:57], v[56:57], v[112:113] op_sel_hi:[1,0] neg_lo:[0,1] neg_hi:[0,1]
  v_pk_add_f32 v[58:59], v[58:59], v[112:113] op_sel_hi:[1,0] neg_lo:[0,1] neg_hi:[0,1]
  v_pk_add_f32 v[60:61], v[60:61], v[112:113] op_sel_hi:[1,0] neg_lo:[0,1] neg_hi:[0,1]
  v_pk_add_f32 v[62:63], v[62:63], v[112:113] op_sel_hi:[1,0] neg_lo:[0,1] neg_hi:[0,1]
  v_pk_mul_f32 v[114:115], v[32:33], v[32:33]
  v_pk_mul_f32 v[116:117], v[34:35], v[34:35]
  v_pk_fma_f32 v[114:115], v[36:37], v[36:37], v[114:115]
  v_pk_fma_f32 v[116:117], v[38:39], v[38:39], v[116:117]
  v_pk_fma_f32 v[114:115], v[40:41], v[40:41], v[114:115]
  v_pk_fma_f32 v[116:117], v[42:43], v[42:43], v[116:117]
  v_pk_fma_f32 v[114:115], v[44:45], v[44:45], v[114:115]
  v_pk_fma_f32 v[116:117], v[46:47], v[46:47], v[116:117]
  v_pk_fma_f32 v[114:115], v[48:49], v[48:49], v[114:115]
  v_pk_fma_f32 v[116:117], v[50:51], v[50:51], v[116:117]
  v_pk_fma_f32 v[114:115], v[52:53], v[52:53], v[114:115]
  v_pk_fma_f32 v[116:117], v[54:55], v[54:55], v[116:117]
  v_pk_fma_f32 v[114:115], v[56:57], v[56:57], v[114:115]
  v_pk_fma_f32 v[116:117], v[58:59], v[58:59], v[116:117]
  v_pk_fma_f32 v[114:115], v[60:61], v[60:61], v[114:115]
  v_pk_fma_f32 v[116:117], v[62:63], v[62:63], v[116:117]
  v_pk_add_f32 v[114:115], v[114:115], v[116:117]
  v_add_f32 v113, v114, v115
  v_mov_b32 v114, v113
  s_nop 1
  v_permlane32_swap_b32 v113, v114
  v_add_f32 v113, v113, v114
  v_mov_b32 v114, v113
  s_nop 1
  v_permlane16_swap_b32 v113, v114
  v_add_f32 v113, v113, v114

  v_and_b32 v114, 15, v0
  v_lshlrev_b32 v114, 5, v114
  s_lshl_b32 s26, s18, 3
  v_add_u32 v115, s26, v114
  ds_write_b64 v115, v[112:113] offset:16384
  s_waitcnt lgkmcnt(0)
  s_barrier
  ds_read_b128 v[116:119], v114 offset:16384
  ds_read_b128 v[120:123], v114 offset:16400
  s_waitcnt lgkmcnt(0)
  v_add_f32 v113, v116, v118
  v_add_f32 v114, v120, v122
  v_add_f32 v113, v113, v114
  v_mul_f32 v113, 0.25, v113
  v_add_f32 v117, v117, v119
  v_add_f32 v121, v121, v123
  v_add_f32 v117, v117, v121
  v_sub_f32 v116, v116, v113
  v_sub_f32 v118, v118, v113
  v_sub_f32 v120, v120, v113
  v_sub_f32 v122, v122, v113
  v_mul_f32 v116, v116, v116
  v_fmac_f32 v116, v118, v118
  v_fmac_f32 v116, v120, v120
  v_fmac_f32 v116, v122, v122
  v_fmac_f32 v117, 0x43000000, v116
  v_mul_f32 v117, 0x3b000000, v117
  v_add_f32 v118, 0x3727c5ac, v117
  v_rsq_f32 v118, v118
  v_sub_f32 v112, v112, v113
  v_mul_f32 v112, v112, v118

  v_pk_fma_f32 v[32:33], v[32:33], v[118:119], v[112:113] op_sel_hi:[1,0,0]
  v_pk_fma_f32 v[34:35], v[34:35], v[118:119], v[112:113] op_sel_hi:[1,0,0]
  v_pk_fma_f32 v[36:37], v[36:37], v[118:119], v[112:113] op_sel_hi:[1,0,0]
  v_pk_fma_f32 v[38:39], v[38:39], v[118:119], v[112:113] op_sel_hi:[1,0,0]
  v_pk_fma_f32 v[40:41], v[40:41], v[118:119], v[112:113] op_sel_hi:[1,0,0]
  v_pk_fma_f32 v[42:43], v[42:43], v[118:119], v[112:113] op_sel_hi:[1,0,0]
  v_pk_fma_f32 v[44:45], v[44:45], v[118:119], v[112:113] op_sel_hi:[1,0,0]
  v_pk_fma_f32 v[46:47], v[46:47], v[118:119], v[112:113] op_sel_hi:[1,0,0]
  v_pk_fma_f32 v[48:49], v[48:49], v[118:119], v[112:113] op_sel_hi:[1,0,0]
  v_pk_fma_f32 v[50:51], v[50:51], v[118:119], v[112:113] op_sel_hi:[1,0,0]
  v_pk_fma_f32 v[52:53], v[52:53], v[118:119], v[112:113] op_sel_hi:[1,0,0]
  v_pk_fma_f32 v[54:55], v[54:55], v[118:119], v[112:113] op_sel_hi:[1,0,0]
  v_pk_fma_f32 v[56:57], v[56:57], v[118:119], v[112:113] op_sel_hi:[1,0,0]
  v_pk_fma_f32 v[58:59], v[58:59], v[118:119], v[112:113] op_sel_hi:[1,0,0]
  v_pk_fma_f32 v[60:61], v[60:61], v[118:119], v[112:113] op_sel_hi:[1,0,0]
  v_pk_fma_f32 v[62:63], v[62:63], v[118:119], v[112:113] op_sel_hi:[1,0,0]
  v_mul_f32 v117, v117, v118
  v_mul_f32 v117, v117, v118
  v_add_f32 v117, 0x3727c5ac, v117
  v_rsq_f32 v114, v117
  s_nop 0

  s_add_u32 s27, s29, 104857600
  s_add_u32 s8, s12, s27
  s_addc_u32 s9, s13, 0
  s_cmp_eq_u32 s20, 0
  s_cbranch_scc0 mega_kernel_w1_ny0
  global_store_dwordx4 v1, v[32:35], s[8:9] offset:0 sc1
  global_store_dwordx4 v1, v[36:39], s[8:9] offset:1024 sc1
mega_kernel_w1_ny0:
  s_cmp_eq_u32 s20, 1
  s_cbranch_scc0 mega_kernel_w1_ny1
  global_store_dwordx4 v1, v[40:43], s[8:9] offset:2048 sc1
  global_store_dwordx4 v1, v[44:47], s[8:9] offset:3072 sc1
mega_kernel_w1_ny1:
  s_cmp_eq_u32 s20, 2
  s_cbranch_scc0 mega_kernel_w1_ny2
  global_store_dwordx4 v4, v[48:51], s[8:9] offset:0 sc1
  global_store_dwordx4 v4, v[52:55], s[8:9] offset:1024 sc1
mega_kernel_w1_ny2:
  s_cmp_eq_u32 s20, 3
  s_cbranch_scc0 mega_kernel_w1_ny3
  global_store_dwordx4 v4, v[56:59], s[8:9] offset:2048 sc1
  global_store_dwordx4 v4, v[60:63], s[8:9] offset:3072 sc1
mega_kernel_w1_ny3:
  s_nop 1
  v_pk_mul_f32 v[32:33], v[32:33], v[114:115] op_sel_hi:[1,0]
  v_pk_mul_f32 v[34:35], v[34:35], v[114:115] op_sel_hi:[1,0]
  v_pk_mul_f32 v[36:37], v[36:37], v[114:115] op_sel_hi:[1,0]
  v_pk_mul_f32 v[38:39], v[38:39], v[114:115] op_sel_hi:[1,0]
  v_pk_mul_f32 v[40:41], v[40:41], v[114:115] op_sel_hi:[1,0]
  v_pk_mul_f32 v[42:43], v[42:43], v[114:115] op_sel_hi:[1,0]
  v_pk_mul_f32 v[44:45], v[44:45], v[114:115] op_sel_hi:[1,0]
  v_pk_mul_f32 v[46:47], v[46:47], v[114:115] op_sel_hi:[1,0]
  v_pk_mul_f32 v[48:49], v[48:49], v[114:115] op_sel_hi:[1,0]
  v_pk_mul_f32 v[50:51], v[50:51], v[114:115] op_sel_hi:[1,0]
  v_pk_mul_f32 v[52:53], v[52:53], v[114:115] op_sel_hi:[1,0]
  v_pk_mul_f32 v[54:55], v[54:55], v[114:115] op_sel_hi:[1,0]
  v_pk_mul_f32 v[56:57], v[56:57], v[114:115] op_sel_hi:[1,0]
  v_pk_mul_f32 v[58:59], v[58:59], v[114:115] op_sel_hi:[1,0]
  v_pk_mul_f32 v[60:61], v[60:61], v[114:115] op_sel_hi:[1,0]
  v_pk_mul_f32 v[62:63], v[62:63], v[114:115] op_sel_hi:[1,0]
  v_cvt_pk_bf16_f32 v64, v32, v33
  v_cvt_pk_bf16_f32 v65, v34, v35
  v_cvt_pk_bf16_f32 v66, v36, v37
  v_cvt_pk_bf16_f32 v67, v38, v39
  v_cvt_pk_bf16_f32 v68, v40, v41
  v_cvt_pk_bf16_f32 v69, v42, v43
  v_cvt_pk_bf16_f32 v70, v44, v45
  v_cvt_pk_bf16_f32 v71, v46, v47
  v_cvt_pk_bf16_f32 v72, v48, v49
  v_cvt_pk_bf16_f32 v73, v50, v51
  v_cvt_pk_bf16_f32 v74, v52, v53
  v_cvt_pk_bf16_f32 v75, v54, v55
  v_cvt_pk_bf16_f32 v76, v56, v57
  v_cvt_pk_bf16_f32 v77, v58, v59
  v_cvt_pk_bf16_f32 v78, v60, v61
  v_cvt_pk_bf16_f32 v79, v62, v63
  ds_write_b128 v6, v[64:67] offset:0
  ds_write_b128 v6, v[68:71] offset:1024
  ds_write_b128 v6, v[72:75] offset:2048
  ds_write_b128 v6, v[76:79] offset:3072
  s_waitcnt lgkmcnt(0)
  s_barrier
  ds_read_b128 v[128:131], v1 offset:0
  ds_read_b128 v[132:135], v1 offset:1024
  ds_read_b128 v[136:139], v1 offset:2048
  ds_read_b128 v[140:143], v1 offset:3072
  ds_read_b128 v[144:147], v1 offset:4096
  ds_read_b128 v[148:151], v1 offset:5120
  ds_read_b128 v[152:155], v1 offset:6144
  ds_read_b128 v[156:159], v1 offset:7168
  ds_read_b128 v[160:163], v1 offset:8192
  ds_read_b128 v[164:167], v1 offset:9216
  ds_read_b128 v[168:171], v1 offset:10240
  ds_read_b128 v[172:175], v1 offset:11264
  ds_read_b128 v[176:179], v1 offset:12288
  ds_read_b128 v[180:183], v1 offset:13312
  ds_read_b128 v[184:187], v1 offset:14336
  ds_read_b128 v[188:191], v1 offset:15360
  s_waitcnt lgkmcnt(15)
  v_mfma_f32_16x16x32_bf16 v[192:195], a[0:3], v[128:131], 0
  v_mfma_f32_16x16x32_bf16 v[196:199], a[4:7], v[128:131], 0
  s_waitcnt lgkmcnt(14)
  v_mfma_f32_16x16x32_bf16 v[192:195], a[8:11], v[132:135], v[192:195]
  v_mfma_f32_16x16x32_bf16 v[196:199], a[12:15], v[132:135], v[196:199]
  s_waitcnt lgkmcnt(13)
  v_mfma_f32_16x16x32_bf16 v[192:195], a[16:19], v[136:139], v[192:195]
  v_mfma_f32_16x16x32_bf16 v[196:199], a[20:23], v[136:139], v[196:199]
  s_waitcnt lgkmcnt(12)
  v_mfma_f32_16x16x32_bf16 v[192:195], a[24:27], v[140:143], v[192:195]
  v_mfma_f32_16x16x32_bf16 v[196:199], a[28:31], v[140:143], v[196:199]
  s_waitcnt lgkmcnt(11)
  v_mfma_f32_16x16x32_bf16 v[192:195], a[32:35], v[144:147], v[192:195]
  v_mfma_f32_16x16x32_bf16 v[196:199], a[36:39], v[144:147], v[196:199]
  s_waitcnt lgkmcnt(10)
  v_mfma_f32_16x16x32_bf16 v[192:195], a[40:43], v[148:151], v[192:195]
  v_mfma_f32_16x16x32_bf16 v[196:199], a[44:47], v[148:151], v[196:199]
  s_waitcnt lgkmcnt(9)
  v_mfma_f32_16x16x32_bf16 v[192:195], a[48:51], v[152:155], v[192:195]
  v_mfma_f32_16x16x32_bf16 v[196:199], a[52:55], v[152:155], v[196:199]
  s_waitcnt lgkmcnt(8)
  v_mfma_f32_16x16x32_bf16 v[192:195], a[56:59], v[156:159], v[192:195]
  v_mfma_f32_16x16x32_bf16 v[196:199], a[60:63], v[156:159], v[196:199]
  s_waitcnt lgkmcnt(7)
  v_mfma_f32_16x16x32_bf16 v[192:195], a[64:67], v[160:163], v[192:195]
  v_mfma_f32_16x16x32_bf16 v[196:199], a[68:71], v[160:163], v[196:199]
  s_waitcnt lgkmcnt(6)
  v_mfma_f32_16x16x32_bf16 v[192:195], a[72:75], v[164:167], v[192:195]
  v_mfma_f32_16x16x32_bf16 v[196:199], a[76:79], v[164:167], v[196:199]
  s_waitcnt lgkmcnt(5)
  v_mfma_f32_16x16x32_bf16 v[192:195], a[80:83], v[168:171], v[192:195]
  v_mfma_f32_16x16x32_bf16 v[196:199], a[84:87], v[168:171], v[196:199]
  s_waitcnt lgkmcnt(4)
  v_mfma_f32_16x16x32_bf16 v[192:195], a[88:91], v[172:175], v[192:195]
  v_mfma_f32_16x16x32_bf16 v[196:199], a[92:95], v[172:175], v[196:199]
  s_waitcnt lgkmcnt(3)
  v_mfma_f32_16x16x32_bf16 v[192:195], a[96:99], v[176:179], v[192:195]
  v_mfma_f32_16x16x32_bf16 v[196:199], a[100:103], v[176:179], v[196:199]
  s_waitcnt lgkmcnt(2)
  v_mfma_f32_16x16x32_bf16 v[192:195], a[104:107], v[180:183], v[192:195]
  v_mfma_f32_16x16x32_bf16 v[196:199], a[108:111], v[180:183], v[196:199]
  s_waitcnt lgkmcnt(1)
  v_mfma_f32_16x16x32_bf16 v[192:195], a[112:115], v[184:187], v[192:195]
  v_mfma_f32_16x16x32_bf16 v[196:199], a[116:119], v[184:187], v[196:199]
  s_waitcnt lgkmcnt(0)
  v_mfma_f32_16x16x32_bf16 v[192:195], a[120:123], v[188:191], v[192:195]
  v_mfma_f32_16x16x32_bf16 v[196:199], a[124:127], v[188:191], v[196:199]
  s_nop 7
  s_lshl_b32 s28, s19, 14
  s_add_u32 s28, s28, s25
  s_add_u32 s27, s28, 83902464
  s_add_u32 s8, s12, s27
  s_addc_u32 s9, s13, 0
  v_mul_f32 v112, v192, v192
  v_mul_f32 v113, v193, v193
  v_mul_f32 v114, v194, v194
  v_mul_f32 v115, v195, v195
  v_mul_f32 v116, v196, v196
  v_mul_f32 v117, v197, v197
  v_mul_f32 v118, v198, v198
  v_mul_f32 v119, v199, v199
  v_mov_b32 v120, s30
  v_fma_f32 v112, v112, s31, v120
  v_fma_f32 v113, v113, s31, v120
  v_fma_f32 v114, v114, s31, v120
  v_fma_f32 v115, v115, s31, v120
  v_fma_f32 v116, v116, s31, v120
  v_fma_f32 v117, v117, s31, v120
  v_fma_f32 v118, v118, s31, v120
  v_fma_f32 v119, v119, s31, v120
  v_mul_f32 v112, v112, v192
  v_mul_f32 v113, v113, v193
  v_mul_f32 v114, v114, v194
  v_mul_f32 v115, v115, v195
  v_mul_f32 v116, v116, v196
  v_mul_f32 v117, v117, v197
  v_mul_f32 v118, v118, v198
  v_mul_f32 v119, v119, v199
  v_exp_f32 v112, v112
  v_exp_f32 v113, v113
  v_exp_f32 v114, v114
  v_exp_f32 v115, v115
  v_exp_f32 v116, v116
  v_exp_f32 v117, v117
  v_exp_f32 v118, v118
  v_exp_f32 v119, v119
  v_add_f32 v112, 1.0, v112
  v_add_f32 v113, 1.0, v113
  v_add_f32 v114, 1.0, v114
  v_add_f32 v115, 1.0, v115
  v_add_f32 v116, 1.0, v116
  v_add_f32 v117, 1.0, v117
  v_add_f32 v118, 1.0, v118
  v_add_f32 v119, 1.0, v119
  v_rcp_f32 v112, v112
  v_rcp_f32 v113, v113
  v_rcp_f32 v114, v114
  v_rcp_f32 v115, v115
  v_rcp_f32 v116, v116
  v_rcp_f32 v117, v117
  v_rcp_f32 v118, v118
  v_rcp_f32 v119, v119
  v_mul_f32 v192, v192, v112
  v_mul_f32 v193, v193, v113
  v_mul_f32 v194, v194, v114
  v_mul_f32 v195, v195, v115
  v_mul_f32 v196, v196, v116
  v_mul_f32 v197, v197, v117
  v_mul_f32 v198, v198, v118
  v_mul_f32 v199, v199, v119
  v_cvt_pk_bf16_f32 v64, v192, v193
  v_cvt_pk_bf16_f32 v65, v194, v195
  v_cvt_pk_bf16_f32 v66, v196, v197
  v_cvt_pk_bf16_f32 v67, v198, v199
  global_store_dwordx4 v1, v[64:67], s[8:9] offset:0 sc1
  s_cmp_eq_u32 s18, 0
  s_cbranch_scc0 mega_kernel_ht_21
  s_lshl_b32 s60, s19, 7
  s_add_u32 s60, s60, 40976
  v_mov_b32 v2, s60
  v_mov_b32 v3, 1
  v_cmp_eq_u32 vcc, 0, v0
  s_and_saveexec_b64 s[62:63], vcc
  global_atomic_add v2, v3, s[14:15]
  s_mov_b64 exec, s[62:63]
mega_kernel_ht_21:

  s_lshl_b32 s28, s19, 7
  s_add_u32 s28, s28, 40960
  s_waitcnt vmcnt(0)
  s_barrier
  s_cmp_eq_u32 s18, 0
  s_cbranch_scc0 mega_kernel_sg_22
  v_mov_b32 v2, s28
  v_mov_b32 v3, 1
  v_cmp_eq_u32 vcc, 0, v0
  s_and_saveexec_b64 s[62:63], vcc
  global_atomic_add v2, v3, s[14:15]

  s_mov_b64 exec, s[62:63]
mega_kernel_sg_22:

  s_add_u32 s19, s19, 10
  s_cmp_lt_u32 s19, 128
  s_cbranch_scc1 mega_kernel_w1_tl
  s_branch mega_kernel_end
mega_kernel_rW2:
  s_sub_u32 s26, s17, 75
  s_mul_hi_u32 s20, s26, 858993460
  s_mul_i32 s27, s20, 5
  s_sub_u32 s22, s26, s27
  s_load_dwordx2 s[4:5], s[0:1], 72
  s_lshl_b32 s26, s20, 8
  s_lshl_b32 s27, s18, 6
  s_add_u32 s26, s26, s27
  s_waitcnt lgkmcnt(0)
  s_add_u32 s4, s4, s26
  s_addc_u32 s5, s5, 0

  v_lshrrev_b32 v5, 2, v0
  v_mov_b32 v6, 1024
  v_mul_lo_u32 v5, v5, v6
  v_and_b32 v6, 3, v0
  v_lshl_add_u32 v2, v6, 4, v5
  v_and_b32 v5, 15, v0
  v_lshrrev_b32 v6, 4, v0
  v_lshrrev_b32 v7, 2, v5
  v_lshl_add_u32 v7, v6, 3, v7
  v_mul_u32_u24 v7, 64, v7
  v_and_b32 v5, 3, v5
  v_lshl_add_u32 v7, v5, 4, v7
  s_mul_i32 s24, s18, 32768
  s_add_u32 s24, s24, 0
  v_add_u32 v3, s24, v7

  s_add_u32 s8, s4, 0
  s_addc_u32 s9, s5, 0
  s_add_u32 m0, s24, 0
  s_nop 0
  global_load_lds_dwordx4 v2, s[8:9]

  s_add_u32 s8, s4, 16384
  s_addc_u32 s9, s5, 0
  s_add_u32 m0, s24, 1024
  s_nop 0
  global_load_lds_dwordx4 v2, s[8:9]

  s_add_u32 s8, s4, 32768
  s_addc_u32 s9, s5, 0
  s_add_u32 m0, s24, 2048
  s_nop 0
  global_load_lds_dwordx4 v2, s[8:9]

  s_add_u32 s8, s4, 49152
  s_addc_u32 s9, s5, 0
  s_add_u32 m0, s24, 3072
  s_nop 0
  global_load_lds_dwordx4 v2, s[8:9]

  s_add_u32 s8, s4, 65536
  s_addc_u32 s9, s5, 0
  s_add_u32 m0, s24, 4096
  s_nop 0
  global_load_lds_dwordx4 v2, s[8:9]

  s_add_u32 s8, s4, 81920
  s_addc_u32 s9, s5, 0
  s_add_u32 m0, s24, 5120
  s_nop 0
  global_load_lds_dwordx4 v2, s[8:9]

  s_add_u32 s8, s4, 98304
  s_addc_u32 s9, s5, 0
  s_add_u32 m0, s24, 6144
  s_nop 0
  global_load_lds_dwordx4 v2, s[8:9]

  s_add_u32 s8, s4, 114688
  s_addc_u32 s9, s5, 0
  s_add_u32 m0, s24, 7168
  s_nop 0
  global_load_lds_dwordx4 v2, s[8:9]

  s_add_u32 s8, s4, 131072
  s_addc_u32 s9, s5, 0
  s_add_u32 m0, s24, 8192
  s_nop 0
  global_load_lds_dwordx4 v2, s[8:9]

  s_add_u32 s8, s4, 147456
  s_addc_u32 s9, s5, 0
  s_add_u32 m0, s24, 9216
  s_nop 0
  global_load_lds_dwordx4 v2, s[8:9]

  s_add_u32 s8, s4, 163840
  s_addc_u32 s9, s5, 0
  s_add_u32 m0, s24, 10240
  s_nop 0
  global_load_lds_dwordx4 v2, s[8:9]

  s_add_u32 s8, s4, 180224
  s_addc_u32 s9, s5, 0
  s_add_u32 m0, s24, 11264
  s_nop 0
  global_load_lds_dwordx4 v2, s[8:9]

  s_add_u32 s8, s4, 196608
  s_addc_u32 s9, s5, 0
  s_add_u32 m0, s24, 12288
  s_nop 0
  global_load_lds_dwordx4 v2, s[8:9]

  s_add_u32 s8, s4, 212992
  s_addc_u32 s9, s5, 0
  s_add_u32 m0, s24, 13312
  s_nop 0
  global_load_lds_dwordx4 v2, s[8:9]

  s_add_u32 s8, s4, 229376
  s_addc_u32 s9, s5, 0
  s_add_u32 m0, s24, 14336
  s_nop 0
  global_load_lds_dwordx4 v2, s[8:9]

  s_add_u32 s8, s4, 245760
  s_addc_u32 s9, s5, 0
  s_add_u32 m0, s24, 15360
  s_nop 0
  global_load_lds_dwordx4 v2, s[8:9]

  s_add_u32 s8, s4, 262144
  s_addc_u32 s9, s5, 0
  s_add_u32 m0, s24, 16384
  s_nop 0
  global_load_lds_dwordx4 v2, s[8:9]

  s_add_u32 s8, s4, 278528
  s_addc_u32 s9, s5, 0
  s_add_u32 m0, s24, 17408
  s_nop 0
  global_load_lds_dwordx4 v2, s[8:9]

  s_add_u32 s8, s4, 294912
  s_addc_u32 s9, s5, 0
  s_add_u32 m0, s24, 18432
  s_nop 0
  global_load_lds_dwordx4 v2, s[8:9]

  s_add_u32 s8, s4, 311296
  s_addc_u32 s9, s5, 0
  s_add_u32 m0, s24, 19456
  s_nop 0
  global_load_lds_dwordx4 v2, s[8:9]

  s_add_u32 s8, s4, 327680
  s_addc_u32 s9, s5, 0
  s_add_u32 m0, s24, 20480
  s_nop 0
  global_load_lds_dwordx4 v2, s[8:9]

  s_add_u32 s8, s4, 344064
  s_addc_u32 s9, s5, 0
  s_add_u32 m0, s24, 21504
  s_nop 0
  global_load_lds_dwordx4 v2, s[8:9]

  s_add_u32 s8, s4, 360448
  s_addc_u32 s9, s5, 0
  s_add_u32 m0, s24, 22528
  s_nop 0
  global_load_lds_dwordx4 v2, s[8:9]

  s_add_u32 s8, s4, 376832
  s_addc_u32 s9, s5, 0
  s_add_u32 m0, s24, 23552
  s_nop 0
  global_load_lds_dwordx4 v2, s[8:9]

  s_add_u32 s8, s4, 393216
  s_addc_u32 s9, s5, 0
  s_add_u32 m0, s24, 24576
  s_nop 0
  global_load_lds_dwordx4 v2, s[8:9]

  s_add_u32 s8, s4, 409600
  s_addc_u32 s9, s5, 0
  s_add_u32 m0, s24, 25600
  s_nop 0
  global_load_lds_dwordx4 v2, s[8:9]

  s_add_u32 s8, s4, 425984
  s_addc_u32 s9, s5, 0
  s_add_u32 m0, s24, 26624
  s_nop 0
  global_load_lds_dwordx4 v2, s[8:9]

  s_add_u32 s8, s4, 442368
  s_addc_u32 s9, s5, 0
  s_add_u32 m0, s24, 27648
  s_nop 0
  global_load_lds_dwordx4 v2, s[8:9]

  s_add_u32 s8, s4, 458752
  s_addc_u32 s9, s5, 0
  s_add_u32 m0, s24, 28672
  s_nop 0
  global_load_lds_dwordx4 v2, s[8:9]

  s_add_u32 s8, s4, 475136
  s_addc_u32 s9, s5, 0
  s_add_u32 m0, s24, 29696
  s_nop 0
  global_load_lds_dwordx4 v2, s[8:9]

  s_add_u32 s8, s4, 491520
  s_addc_u32 s9, s5, 0
  s_add_u32 m0, s24, 30720
  s_nop 0
  global_load_lds_dwordx4 v2, s[8:9]

  s_add_u32 s8, s4, 507904
  s_addc_u32 s9, s5, 0
  s_add_u32 m0, s24, 31744
  s_nop 0
  global_load_lds_dwordx4 v2, s[8:9]

  s_waitcnt vmcnt(30)
  ds_read_b64_tr_b16 a[0:1], v3 offset:0
  ds_read_b64_tr_b16 a[2:3], v3 offset:256
  ds_read_b64_tr_b16 a[4:5], v3 offset:8
  ds_read_b64_tr_b16 a[6:7], v3 offset:264
  s_waitcnt vmcnt(28)
  ds_read_b64_tr_b16 a[8:9], v3 offset:2048
  ds_read_b64_tr_b16 a[10:11], v3 offset:2304
  ds_read_b64_tr_b16 a[12:13], v3 offset:2056
  ds_read_b64_tr_b16 a[14:15], v3 offset:2312
  s_waitcnt vmcnt(26)
  ds_read_b64_tr_b16 a[16:17], v3 offset:4096
  ds_read_b64_tr_b16 a[18:19], v3 offset:4352
  ds_read_b64_tr_b16 a[20:21], v3 offset:4104
  ds_read_b64_tr_b16 a[22:23], v3 offset:4360
  s_waitcnt vmcnt(24)
  ds_read_b64_tr_b16 a[24:25], v3 offset:6144
  ds_read_b64_tr_b16 a[26:27], v3 offset:6400
  ds_read_b64_tr_b16 a[28:29], v3 offset:6152
  ds_read_b64_tr_b16 a[30:31], v3 offset:6408
  s_waitcnt vmcnt(22)
  ds_read_b64_tr_b16 a[32:33], v3 offset:8192
  ds_read_b64_tr_b16 a[34:35], v3 offset:8448
  ds_read_b64_tr_b16 a[36:37], v3 offset:8200
  ds_read_b64_tr_b16 a[38:39], v3 offset:8456
  s_waitcnt vmcnt(20)
  ds_read_b64_tr_b16 a[40:41], v3 offset:10240
  ds_read_b64_tr_b16 a[42:43], v3 offset:10496
  ds_read_b64_tr_b16 a[44:45], v3 offset:10248
  ds_read_b64_tr_b16 a[46:47], v3 offset:10504
  s_waitcnt vmcnt(18)
  ds_read_b64_tr_b16 a[48:49], v3 offset:12288
  ds_read_b64_tr_b16 a[50:51], v3 offset:12544
  ds_read_b64_tr_b16 a[52:53], v3 offset:12296
  ds_read_b64_tr_b16 a[54:55], v3 offset:12552
  s_waitcnt vmcnt(16)
  ds_read_b64_tr_b16 a[56:57], v3 offset:14336
  ds_read_b64_tr_b16 a[58:59], v3 offset:14592
  ds_read_b64_tr_b16 a[60:61], v3 offset:14344
  ds_read_b64_tr_b16 a[62:63], v3 offset:14600
  s_waitcnt vmcnt(14)
  ds_read_b64_tr_b16 a[64:65], v3 offset:16384
  ds_read_b64_tr_b16 a[66:67], v3 offset:16640
  ds_read_b64_tr_b16 a[68:69], v3 offset:16392
  ds_read_b64_tr_b16 a[70:71], v3 offset:16648
  s_waitcnt vmcnt(12)
  ds_read_b64_tr_b16 a[72:73], v3 offset:18432
  ds_read_b64_tr_b16 a[74:75], v3 offset:18688
  ds_read_b64_tr_b16 a[76:77], v3 offset:18440
  ds_read_b64_tr_b16 a[78:79], v3 offset:18696
  s_waitcnt vmcnt(10)
  ds_read_b64_tr_b16 a[80:81], v3 offset:20480
  ds_read_b64_tr_b16 a[82:83], v3 offset:20736
  ds_read_b64_tr_b16 a[84:85], v3 offset:20488
  ds_read_b64_tr_b16 a[86:87], v3 offset:20744
  s_waitcnt vmcnt(8)
  ds_read_b64_tr_b16 a[88:89], v3 offset:22528
  ds_read_b64_tr_b16 a[90:91], v3 offset:22784
  ds_read_b64_tr_b16 a[92:93], v3 offset:22536
  ds_read_b64_tr_b16 a[94:95], v3 offset:22792
  s_waitcnt vmcnt(6)
  ds_read_b64_tr_b16 a[96:97], v3 offset:24576
  ds_read_b64_tr_b16 a[98:99], v3 offset:24832
  ds_read_b64_tr_b16 a[100:101], v3 offset:24584
  ds_read_b64_tr_b16 a[102:103], v3 offset:24840
  s_waitcnt vmcnt(4)
  ds_read_b64_tr_b16 a[104:105], v3 offset:26624
  ds_read_b64_tr_b16 a[106:107], v3 offset:26880
  ds_read_b64_tr_b16 a[108:109], v3 offset:26632
  ds_read_b64_tr_b16 a[110:111], v3 offset:26888
  s_waitcnt vmcnt(2)
  ds_read_b64_tr_b16 a[112:113], v3 offset:28672
  ds_read_b64_tr_b16 a[114:115], v3 offset:28928
  ds_read_b64_tr_b16 a[116:117], v3 offset:28680
  ds_read_b64_tr_b16 a[118:119], v3 offset:28936
  s_waitcnt vmcnt(0)
  ds_read_b64_tr_b16 a[120:121], v3 offset:30720
  ds_read_b64_tr_b16 a[122:123], v3 offset:30976
  ds_read_b64_tr_b16 a[124:125], v3 offset:30728
  ds_read_b64_tr_b16 a[126:127], v3 offset:30984
  s_waitcnt lgkmcnt(0)
  s_barrier
  s_lshr_b32 s27, s18, 1
  s_add_u32 s27, s27, 1
  s_and_b32 s28, s18, 1
  s_sub_u32 s29, 0, s27
  s_cmp_eq_u32 s28, 1
  s_cselect_b32 s27, s27, s29
  v_and_b32 v5, 15, v0
  v_add_u32 v5, s27, v5
  v_add_u32 v5, 16, v5
  v_lshrrev_b32 v6, 4, v5
  v_lshlrev_b32 v6, 14, v6
  v_and_b32 v5, 15, v5
  v_and_b32 v7, 48, v0
  v_add_u32 v5, v5, v7
  v_lshl_add_u32 v4, v5, 4, v6
  s_lshl_b32 s25, s18, 12
  s_lshl_b32 s24, s20, 13
  s_lshl_b32 s26, s18, 11
  s_add_u32 s24, s24, s26

  s_mov_b32 s19, s22
  s_mov_b32 s38, 0
mega_kernel_w2_tl:
  s_mov_b32 s37, 4
  s_cmp_ge_u32 s19, 125
  s_cselect_b32 s36, 16, 0
  s_add_u32 s28, s28, s36
  v_and_b32 v2, 3, v0
  v_add_u32 v2, s19, v2
  v_subrev_u32 v2, 1, v2
  v_mov_b32 v3, s19
  v_cmp_gt_u32 vcc, 128, v2
  s_mov_b32 s27, 0
  v_cndmask_b32 v2, v3, v2, vcc
  v_and_b32 v8, 3, v0
  v_cmp_gt_u32 vcc, 3, v8
  s_nop 1
  v_cndmask_b32 v2, v3, v2, vcc
  v_lshlrev_b32 v2, 7, v2
  v_add_u32 v2, 40960, v2
  v_add_u32 v2, s36, v2
mega_kernel_w2_pl:
  global_load_dword v3, v2, s[14:15] sc1
  s_add_u32 s27, s27, 1
  s_cmp_gt_u32 s27, 50000000
  s_cbranch_scc1 mega_kernel_fail
  s_waitcnt vmcnt(0)
  v_cmp_gt_u32 vcc, s37, v3
  s_cbranch_vccz mega_kernel_w2_plok
  s_sleep 2
  s_branch mega_kernel_w2_pl
mega_kernel_w2_plok:

  s_lshl_b32 s28, s19, 14
  s_add_u32 s28, s28, s25
  s_add_u32 s27, s28, 83886080
  s_add_u32 s6, s12, s27
  s_addc_u32 s7, s13, 0
  s_mov_b32 m0, s25
  s_nop 0
  global_load_lds_dwordx4 v4, s[6:7] offset:0 sc1
  global_load_lds_dwordx4 v4, s[6:7] offset:1024 sc1
  global_load_lds_dwordx4 v4, s[6:7] offset:2048 sc1
  global_load_lds_dwordx4 v4, s[6:7] offset:3072 sc1
  s_lshl_b32 s29, s19, 15
  s_add_u32 s29, s29, s24
  s_add_u32 s27, s29, 104857600
  s_add_u32 s8, s12, s27
  s_addc_u32 s9, s13, 0
  global_load_dwordx4 v[32:35], v1, s[8:9] offset:0 sc1
  global_load_dwordx4 v[36:39], v1, s[8:9] offset:1024 sc1
  s_add_u32 s27, s29, 100663296
  s_add_u32 s8, s12, s27
  s_addc_u32 s9, s13, 0
  global_load_dwordx4 v[40:43], v1, s[8:9] offset:0 sc1
  global_load_dwordx4 v[44:47], v1, s[8:9] offset:1024 sc1
  s_waitcnt vmcnt(4)
  s_barrier
  ds_read_b128 v[128:131], v1 offset:0
  ds_read_b128 v[132:135], v1 offset:1024
  ds_read_b128 v[136:139], v1 offset:2048
  ds_read_b128 v[140:143], v1 offset:3072
  ds_read_b128 v[144:147], v1 offset:4096
  ds_read_b128 v[148:151], v1 offset:5120
  ds_read_b128 v[152:155], v1 offset:6144
  ds_read_b128 v[156:159], v1 offset:7168
  ds_read_b128 v[160:163], v1 offset:8192
  ds_read_b128 v[164:167], v1 offset:9216
  ds_read_b128 v[168:171], v1 offset:10240
  ds_read_b128 v[172:175], v1 offset:11264
  ds_read_b128 v[176:179], v1 offset:12288
  ds_read_b128 v[180:183], v1 offset:13312
  ds_read_b128 v[184:187], v1 offset:14336
  ds_read_b128 v[188:191], v1 offset:15360
  s_waitcnt lgkmcnt(15)
  v_mfma_f32_16x16x32_bf16 v[112:115], a[0:3], v[128:131], 0
  v_mfma_f32_16x16x32_bf16 v[116:119], a[4:7], v[128:131], 0
  s_waitcnt lgkmcnt(14)
  v_mfma_f32_16x16x32_bf16 v[112:115], a[8:11], v[132:135], v[112:115]
  v_mfma_f32_16x16x32_bf16 v[116:119], a[12:15], v[132:135], v[116:119]
  s_waitcnt lgkmcnt(13)
  v_mfma_f32_16x16x32_bf16 v[112:115], a[16:19], v[136:139], v[112:115]
  v_mfma_f32_16x16x32_bf16 v[116:119], a[20:23], v[136:139], v[116:119]
  s_waitcnt lgkmcnt(12)
  v_mfma_f32_16x16x32_bf16 v[112:115], a[24:27], v[140:143], v[112:115]
  v_mfma_f32_16x16x32_bf16 v[116:119], a[28:31], v[140:143], v[116:119]
  s_waitcnt lgkmcnt(11)
  v_mfma_f32_16x16x32_bf16 v[112:115], a[32:35], v[144:147], v[112:115]
  v_mfma_f32_16x16x32_bf16 v[116:119], a[36:39], v[144:147], v[116:119]
  s_waitcnt lgkmcnt(10)
  v_mfma_f32_16x16x32_bf16 v[112:115], a[40:43], v[148:151], v[112:115]
  v_mfma_f32_16x16x32_bf16 v[116:119], a[44:47], v[148:151], v[116:119]
  s_waitcnt lgkmcnt(9)
  v_mfma_f32_16x16x32_bf16 v[112:115], a[48:51], v[152:155], v[112:115]
  v_mfma_f32_16x16x32_bf16 v[116:119], a[52:55], v[152:155], v[116:119]
  s_waitcnt lgkmcnt(8)
  v_mfma_f32_16x16x32_bf16 v[112:115], a[56:59], v[156:159], v[112:115]
  v_mfma_f32_16x16x32_bf16 v[116:119], a[60:63], v[156:159], v[116:119]
  s_waitcnt lgkmcnt(7)
  v_mfma_f32_16x16x32_bf16 v[112:115], a[64:67], v[160:163], v[112:115]
  v_mfma_f32_16x16x32_bf16 v[116:119], a[68:71], v[160:163], v[116:119]
  s_waitcnt lgkmcnt(6)
  v_mfma_f32_16x16x32_bf16 v[112:115], a[72:75], v[164:167], v[112:115]
  v_mfma_f32_16x16x32_bf16 v[116:119], a[76:79], v[164:167], v[116:119]
  s_waitcnt lgkmcnt(5)
  v_mfma_f32_16x16x32_bf16 v[112:115], a[80:83], v[168:171], v[112:115]
  v_mfma_f32_16x16x32_bf16 v[116:119], a[84:87], v[168:171], v[116:119]
  s_waitcnt lgkmcnt(4)
  v_mfma_f32_16x16x32_bf16 v[112:115], a[88:91], v[172:175], v[112:115]
  v_mfma_f32_16x16x32_bf16 v[116:119], a[92:95], v[172:175], v[116:119]
  s_waitcnt lgkmcnt(3)
  v_mfma_f32_16x16x32_bf16 v[112:115], a[96:99], v[176:179], v[112:115]
  v_mfma_f32_16x16x32_bf16 v[116:119], a[100:103], v[176:179], v[116:119]
  s_waitcnt lgkmcnt(2)
  v_mfma_f32_16x16x32_bf16 v[112:115], a[104:107], v[180:183], v[112:115]
  v_mfma_f32_16x16x32_bf16 v[116:119], a[108:111], v[180:183], v[116:119]
  s_waitcnt lgkmcnt(1)
  v_mfma_f32_16x16x32_bf16 v[112:115], a[112:115], v[184:187], v[112:115]
  v_mfma_f32_16x16x32_bf16 v[116:119], a[116:119], v[184:187], v[116:119]
  s_waitcnt lgkmcnt(0)
  v_mfma_f32_16x16x32_bf16 v[112:115], a[120:123], v[188:191], v[112:115]
  v_mfma_f32_16x16x32_bf16 v[116:119], a[124:127], v[188:191], v[116:119]
  s_nop 7
  s_barrier
  s_cmp_ge_u32 s19, 125
  s_cselect_b64 s[60:61], -1, 0
  v_max3_u32 v48, v128, v129, v130
  v_mov_b32 v49, v131
  v_max3_u32 v48, v48, v132, v133
  v_max3_u32 v49, v49, v134, v135
  v_max3_u32 v48, v48, v136, v137
  v_max3_u32 v49, v49, v138, v139
  v_max3_u32 v48, v48, v140, v141
  v_max3_u32 v49, v49, v142, v143
  v_max3_u32 v48, v48, v144, v145
  v_max3_u32 v49, v49, v146, v147
  v_max3_u32 v48, v48, v148, v149
  v_max3_u32 v49, v49, v150, v151
  v_max3_u32 v48, v48, v152, v153
  v_max3_u32 v49, v49, v154, v155
  v_max3_u32 v48, v48, v156, v157
  v_max3_u32 v49, v49, v158, v159
  v_max3_u32 v48, v48, v160, v161
  v_max3_u32 v49, v49, v162, v163
  v_max3_u32 v48, v48, v164, v165
  v_max3_u32 v49, v49, v166, v167
  v_max3_u32 v48, v48, v168, v169
  v_max3_u32 v49, v49, v170, v171
  v_max3_u32 v48, v48, v172, v173
  v_max3_u32 v49, v49, v174, v175
  v_max3_u32 v48, v48, v176, v177
  v_max3_u32 v49, v49, v178, v179
  v_max3_u32 v48, v48, v180, v181
  v_max3_u32 v49, v49, v182, v183
  v_max3_u32 v48, v48, v184, v185
  v_max3_u32 v49, v49, v186, v187
  v_max3_u32 v48, v48, v188, v189
  v_max3_u32 v49, v49, v190, v191
  v_max_u32 v48, v48, v49
  s_add_u32 s38, s38, 1
  s_cmp_gt_u32 s38, 50000000
  s_cbranch_scc1 mega_kernel_fail
  v_cmp_eq_u32 vcc, -1, v48
  s_nop 3
  s_and_b64 vcc, vcc, s[60:61]
  s_cbranch_vccnz mega_kernel_w2_plok

  s_waitcnt vmcnt(0)
  s_branch mega_kernel_w2_yc
mega_kernel_w2_yr:
  s_add_u32 s27, s29, 104857600
  s_add_u32 s8, s12, s27
  s_addc_u32 s9, s13, 0
  global_load_dwordx4 v[32:35], v1, s[8:9] offset:0 sc1
  global_load_dwordx4 v[36:39], v1, s[8:9] offset:1024 sc1
  s_add_u32 s27, s29, 100663296
  s_add_u32 s8, s12, s27
  s_addc_u32 s9, s13, 0
  global_load_dwordx4 v[40:43], v1, s[8:9] offset:0 sc1
  global_load_dwordx4 v[44:47], v1, s[8:9] offset:1024 sc1
  s_waitcnt vmcnt(0)
mega_kernel_w2_yc:
  s_cmp_ge_u32 s19, 125
  s_cselect_b64 s[60:61], -1, 0
  v_max3_u32 v48, v32, v33, v34
  v_mov_b32 v49, v35
  v_max3_u32 v48, v48, v36, v37
  v_max3_u32 v49, v49, v38, v39
  v_max3_u32 v48, v48, v40, v41
  v_max3_u32 v49, v49, v42, v43
  v_max3_u32 v48, v48, v44, v45
  v_max3_u32 v49, v49, v46, v47
  v_max_u32 v48, v48, v49
  s_add_u32 s38, s38, 1
  s_cmp_gt_u32 s38, 50000000
  s_cbranch_scc1 mega_kernel_fail
  v_cmp_eq_u32 vcc, -1, v48
  s_nop 3
  s_and_b64 vcc, vcc, s[60:61]
  s_cbranch_vccnz mega_kernel_w2_yr

  v_pk_add_f32 v[32:33], v[32:33], v[112:113]
  v_pk_add_f32 v[34:35], v[34:35], v[114:115]
  v_pk_add_f32 v[36:37], v[36:37], v[116:117]
  v_pk_add_f32 v[38:39], v[38:39], v[118:119]
  v_pk_add_f32 v[40:41], v[40:41], v[32:33]
  v_pk_add_f32 v[42:43], v[42:43], v[34:35]
  v_pk_add_f32 v[44:45], v[44:45], v[36:37]
  v_pk_add_f32 v[46:47], v[46:47], v[38:39]
  s_add_u32 s27, s29, 113246208
  s_add_u32 s8, s12, s27
  s_addc_u32 s9, s13, 0
  global_store_dwordx4 v1, v[32:35], s[8:9] offset:0 sc1
  global_store_dwordx4 v1, v[36:39], s[8:9] offset:1024 sc1
  s_add_u32 s27, s29, 119537664
  s_add_u32 s8, s12, s27
  s_addc_u32 s9, s13, 0
  global_store_dwordx4 v1, v[40:43], s[8:9] offset:0 sc1
  global_store_dwordx4 v1, v[44:47], s[8:9] offset:1024 sc1
  s_cmp_eq_u32 s18, 0
  s_cbranch_scc0 mega_kernel_ht_23
  s_lshl_b32 s60, s19, 7
  s_add_u32 s60, s60, 57360
  v_mov_b32 v2, s60
  v_mov_b32 v3, 1
  v_cmp_eq_u32 vcc, 0, v0
  s_and_saveexec_b64 s[62:63], vcc
  global_atomic_add v2, v3, s[14:15]
  s_mov_b64 exec, s[62:63]
mega_kernel_ht_23:

  s_lshl_b32 s28, s19, 7
  s_add_u32 s28, s28, 57344
  s_waitcnt vmcnt(0)
  s_barrier
  s_cmp_eq_u32 s18, 0
  s_cbranch_scc0 mega_kernel_sg_24
  v_mov_b32 v2, s28
  v_mov_b32 v3, 1
  v_cmp_eq_u32 vcc, 0, v0
  s_and_saveexec_b64 s[62:63], vcc
  global_atomic_add v2, v3, s[14:15]

  s_mov_b64 exec, s[62:63]
mega_kernel_sg_24:

  s_add_u32 s19, s19, 5
  s_cmp_lt_u32 s19, 128
  s_cbranch_scc1 mega_kernel_w2_tl
  s_branch mega_kernel_end
.section .rodata,"a"
.p2align 6
.amdhsa_kernel mega_kernel
  .amdhsa_next_free_vgpr 512
  .amdhsa_next_free_sgpr 102
  .amdhsa_accum_offset 256
  .amdhsa_group_segment_fixed_size 0
  .amdhsa_kernarg_size 120
  .amdhsa_user_sgpr_count 2
  .amdhsa_user_sgpr_kernarg_segment_ptr 1
  .amdhsa_system_sgpr_workgroup_id_x 1

.end_amdhsa_kernel
.text
```
